```python
import torch

def _softmax(x, axis=-1):
    return torch.softmax(x, dim=axis)
def _gelu(x):
    return torch.nn.functional.gelu(x, approximate="tanh")
def _silu(x):
    return torch.nn.functional.silu(x)
def _sigmoid(x):
    return torch.sigmoid(x)
def _layernorm(x, axis=-1, eps=1e-5):
    m = x.mean(dim=axis, keepdim=True)
    v = x.var(dim=axis, keepdim=True, unbiased=False)
    return (x - m) / torch.sqrt(v + eps)
def _scatter_add(tgt, idx, src, axis=0):
    return tgt.clone().index_add_(axis, idx, src)
def _segment_sum(src, seg, n):
    out = torch.zeros((n,) + src.shape[1:], dtype=src.dtype)
    return out.index_add_(0, seg, src)
def _pad(x, pw):
    flat = tuple(v for pair in reversed(pw) for v in pair)
    return torch.nn.functional.pad(x, flat)

kernel_name = 'concat_heads__gqa_block_cached__mha_block_cached__near_ridge'

def setup_inputs():

    _w = (lambda a: (lambda t: t.to(torch.bfloat16) if t.is_floating_point() else t)(torch.as_tensor(a)))
    def _A_setup():
        B, Sq, D = 8, 128, 448
        Hq, Hkv, Sk, Dh = 16, 8, 512, 256
        assert Hq % Hkv == 0, (Hq, Hkv)
        return {
            "x": _w((lambda *s: torch.randn(*s, dtype=torch.bfloat16) * 0.8)(B, Sq, D)),
            "k_cache": _w((lambda *s: torch.randn(*s, dtype=torch.bfloat16) * 0.8)(B, Hkv, Sk, Dh)),
            "v_cache": _w((lambda *s: torch.randn(*s, dtype=torch.bfloat16) * 0.05)(B, Hkv, Sk, Dh)),
            "wq": _w((lambda *s: torch.randn(*s, dtype=torch.bfloat16) * 0.8)(D, Hq * Dh) * (D ** -0.5)),
            "wo": _w((lambda *s: torch.randn(*s, dtype=torch.bfloat16) * 0.05)(Hq * Dh, D) * ((Hq * Dh) ** -0.5)),
        }
    _A_in = _A_setup()

    def _B_setup():
        B, Sq, D = 8, 128, 448
        H, Sk, Dh = 16, 512, 256
        return {
            "x": _w((lambda *s: torch.randn(*s, dtype=torch.bfloat16) * 0.8)(B, Sq, D)),
            "k_cache": _w((lambda *s: torch.randn(*s, dtype=torch.bfloat16) * 0.8)(B, H, Sk, Dh)),
            "v_cache": _w((lambda *s: torch.randn(*s, dtype=torch.bfloat16) * 0.05)(B, H, Sk, Dh)),
            "wq": _w((lambda *s: torch.randn(*s, dtype=torch.bfloat16) * 0.8)(D, H * Dh) * (D ** -0.5)),
            "wo": _w((lambda *s: torch.randn(*s, dtype=torch.bfloat16) * 0.05)(H * Dh, D) * ((H * Dh) ** -0.5)),
        }
    _B_in = _B_setup()

    return {
        "A_x": _A_in["x"],
        "A_k_cache": _A_in["k_cache"],
        "A_v_cache": _A_in["v_cache"],
        "A_wq": _A_in["wq"],
        "A_wo": _A_in["wo"],
        "B_x": _B_in["x"],
        "B_k_cache": _B_in["k_cache"],
        "B_v_cache": _B_in["v_cache"],
        "B_wq": _B_in["wq"],
        "B_wo": _B_in["wo"],
    }

def reference(A_x, A_k_cache, A_v_cache, A_wq, A_wo, B_x, B_k_cache, B_v_cache, B_wq, B_wo):
    def _A_ref(x, k_cache, v_cache, wq, wo):
        B, Sq, D = x.shape
        Hq, Dh = 16, 256
        Hkv = k_cache.shape[1]
        rep = Hq // Hkv
        q = (lambda x, *d: x.permute(*d))((x @ wq).reshape(B, Sq, Hq, Dh), 0, 2, 1, 3)
        k = (lambda x, n, axis: torch.repeat_interleave(x, n, dim=axis))(k_cache, rep, axis=1)
        v = (lambda x, n, axis: torch.repeat_interleave(x, n, dim=axis))(v_cache, rep, axis=1)
        scores = torch.einsum("bhqd,bhkd->bhqk", q, k) * (Dh ** -0.5)
        p = _softmax(scores, axis=-1)
        o = torch.einsum("bhqk,bhkd->bhqd", p, v)
        return (lambda x, *d: x.permute(*d))(o, 0, 2, 1, 3).reshape(B, Sq, Hq * Dh) @ wo

    def _B_ref(x, k_cache, v_cache, wq, wo):
        B, Sq, D = x.shape
        H, Dh = 16, 256
        q = (lambda x, *d: x.permute(*d))((x @ wq).reshape(B, Sq, H, Dh), 0, 2, 1, 3)
        scores = torch.einsum("bhqd,bhkd->bhqk", q, k_cache) * (Dh ** -0.5)
        p = _softmax(scores, axis=-1)
        o = torch.einsum("bhqk,bhkd->bhqd", p, v_cache)
        return (lambda x, *d: x.permute(*d))(o, 0, 2, 1, 3).reshape(B, Sq, H * Dh) @ wo

    a = _A_ref(A_x, A_k_cache, A_v_cache, A_wq, A_wo)
    b = _B_ref(B_x, B_k_cache, B_v_cache, B_wq, B_wo)
    return torch.concatenate([a, b], axis=-1)
```

```asm
; @launch grid=(256,1,1) block=(256,1,1) lds=163840
.amdgcn_target "amdgcn-amd-amdhsa--gfx950"
.text
.globl concat_heads__gqa_block_cached__mha_block_cached__near_ridge_kernel
.p2align 8
.type concat_heads__gqa_block_cached__mha_block_cached__near_ridge_kernel,@function
concat_heads__gqa_block_cached__mha_block_cached__near_ridge_kernel:
s_cmp_ge_u32 s2, 256
s_cbranch_scc1 LA_end
s_lshr_b32 s3, s2, 7
s_mul_i32 s4, s3, 40
s_add_u32 s4, s0, s4
s_addc_u32 s5, s1, 0
s_load_dwordx2 s[8:9], s[4:5], 0
s_load_dwordx2 s[20:21], s[4:5], 24
s_load_dwordx2 s[12:13], s[4:5], 8
s_load_dwordx2 s[16:17], s[4:5], 16
LA_start:
v_lshrrev_b32 v1, 6, v0
v_and_b32 v0, 63, v0
v_readfirstlane_b32 s6, v1
s_bfe_u32 s73, s2, 0x30003
s_and_b32 s72, s2, 7
s_bfe_u32 s76, s2, 0x10006
s_lshl_b32 s75, s72, 1
s_add_u32 s75, s75, s76
s_mul_i32 s78, s73, 114688
s_lshl_b32 s79, s75, 9
s_mul_i32 s7, s76, 4
s_and_b32 s63, s73, 3
s_add_u32 s7, s7, s63
s_add_u32 s7, s7, s72
s_cmp_ge_u32 s7, 7
s_cselect_b32 s63, 7, 0
s_sub_u32 s7, s7, s63
s_cmp_ge_u32 s7, 7
s_cselect_b32 s63, 7, 0
s_sub_u32 s7, s7, s63
s_lshl_b32 s40, s7, 19
s_lshl_b32 s48, s7, 7
s_lshl_b32 s32, s6, 12
s_lshr_b32 s101, s75, 2
s_xor_b32 s101, s101, s6
s_mov_b32 s10, 114688
s_mov_b32 s11, 0x20000
s_sub_u32 s22, 3670016, s79
s_mov_b32 s23, 0x20000
v_lshrrev_b32 v61, 4, v0
v_lshrrev_b32 v62, 3, v0
s_lshl_b32 s100, s101, 5
v_add_u32 v62, s100, v62
v_mul_u32_u24 v62, 896, v62
v_and_b32 v63, 7, v0
v_xor_b32 v63, v63, v61
v_lshl_add_u32 v80, v63, 4, v62
v_xor_b32 v63, 4, v63
v_lshl_add_u32 v81, v63, 4, v62
v_add_u32 v82, 12288, v80
v_add_u32 v83, 18432, v81
v_add_u32 v81, 6144, v81
v_lshrrev_b32 v2, 5, v0
v_and_b32 v3, 31, v0
s_and_b32 s100, s6, 1
s_lshl_b32 s100, s100, 4
s_lshr_b32 s63, s6, 1
s_lshl_b32 s63, s63, 2
s_add_u32 s100, s100, s63
v_add_u32 v56, s100, v2
v_lshlrev_b32 v56, 13, v56
v_lshlrev_b32 v57, 1, v2
v_xor_b32 v57, v57, v3
v_lshl_add_u32 v12, v57, 4, v56
v_xor_b32 v13, 64, v12
v_add_u32 v13, 15360, v13
v_xor_b32 v14, 128, v12
v_add_u32 v14, 63488, v14
v_xor_b32 v15, 192, v12
v_add_u32 v15, 78848, v15
s_waitcnt lgkmcnt(0)
s_add_u32 s8, s8, s78
s_addc_u32 s9, s9, 0
s_add_u32 s20, s20, s79
s_addc_u32 s21, s21, 0
s_add_u32 m0, s32, 0
s_nop 0
buffer_load_dwordx4 v80, s[8:11], s48 offen offset:0 lds
buffer_load_dwordx4 v81, s[8:11], s48 offen offset:1024 lds
buffer_load_dwordx4 v82, s[8:11], s48 offen offset:2048 lds
buffer_load_dwordx4 v83, s[8:11], s48 offen offset:3072 lds
s_add_u32 m0, s32, 16384
s_add_u32 s33, s40, 0
buffer_load_dwordx4 v12, s[20:23], s33 offen offset:0 lds
buffer_load_dwordx4 v13, s[20:23], s33 offen offset:1024 lds
buffer_load_dwordx4 v14, s[20:23], s33 offen offset:2048 lds
buffer_load_dwordx4 v15, s[20:23], s33 offen offset:3072 lds
s_add_u32 m0, s32, 32768
s_add_u32 s33, s40, 262144
buffer_load_dwordx4 v12, s[20:23], s33 offen offset:0 lds
buffer_load_dwordx4 v13, s[20:23], s33 offen offset:1024 lds
buffer_load_dwordx4 v14, s[20:23], s33 offen offset:2048 lds
buffer_load_dwordx4 v15, s[20:23], s33 offen offset:3072 lds
s_load_dwordx2 s[24:25], s[4:5], 32
s_load_dwordx2 s[68:69], s[0:1], 80
s_load_dwordx2 s[64:65], s[0:1], 88
s_load_dwordx2 s[28:29], s[0:1], 96
s_memrealtime s[80:81]
s_add_u32 s7, s7, 1
s_cmp_eq_u32 s7, 7
s_cselect_b32 s7, 0, s7
s_lshl_b32 s41, s7, 19
s_lshl_b32 s49, s7, 7
s_add_u32 s7, s7, 1
s_cmp_eq_u32 s7, 7
s_cselect_b32 s7, 0, s7
s_lshl_b32 s42, s7, 19
s_lshl_b32 s50, s7, 7
s_add_u32 s7, s7, 1
s_cmp_eq_u32 s7, 7
s_cselect_b32 s7, 0, s7
s_lshl_b32 s43, s7, 19
s_lshl_b32 s51, s7, 7
s_add_u32 s7, s7, 1
s_cmp_eq_u32 s7, 7
s_cselect_b32 s7, 0, s7
s_lshl_b32 s44, s7, 19
s_lshl_b32 s52, s7, 7
s_add_u32 s7, s7, 1
s_cmp_eq_u32 s7, 7
s_cselect_b32 s7, 0, s7
s_lshl_b32 s45, s7, 19
s_lshl_b32 s53, s7, 7
s_add_u32 s7, s7, 1
s_cmp_eq_u32 s7, 7
s_cselect_b32 s7, 0, s7
s_lshl_b32 s46, s7, 19
s_lshl_b32 s54, s7, 7
s_waitcnt lgkmcnt(0)
s_getpc_b64 s[96:97]
LA_pc:
s_lshr_b32 s98, s2, 3
s_lshl_b32 s98, s98, 2
s_add_u32 s98, s98, s6
s_and_b32 s98, s98, 63
s_lshl_b32 s98, s98, 6
s_add_u32 s96, s96, s98
s_addc_u32 s97, s97, 0
s_load_dword s98, s[96:97], 0
s_load_dword s98, s[96:97], 4096
s_load_dword s98, s[96:97], 8192
s_load_dword s98, s[96:97], 12288
s_load_dword s98, s[96:97], 16384
s_lshl_b32 s77, s73, 3
s_add_u32 s77, s77, s72
s_lshl_b32 s63, s73, 4
s_add_u32 s63, s63, s75
s_cmp_eq_u32 s3, 0
s_cselect_b32 s77, s77, s63
s_lshl_b32 s77, s77, 18
s_mov_b32 s14, 262144
s_mov_b32 s15, 0x20000
s_mov_b32 s18, 262144
s_mov_b32 s19, 0x20000
s_mul_i32 s99, s76, 0
v_lshlrev_b32 v58, 9, v2
v_add_u32 v58, s32, v58
v_lshl_add_u32 v16, v57, 4, v58
v_xor_b32 v17, 64, v16
v_xor_b32 v18, 128, v16
v_xor_b32 v19, 192, v16
s_add_u32 s12, s12, s77
s_addc_u32 s13, s13, 0
s_add_u32 s16, s16, s77
s_addc_u32 s17, s17, 0
v_and_b32 v60, 15, v0
v_lshrrev_b32 v56, 1, v60
v_xor_b32 v56, v56, v61
v_lshlrev_b32 v56, 4, v56
v_lshl_or_b32 v56, v60, 7, v56
v_add_u32 v56, s32, v56
s_and_b32 s63, s75, 2
s_lshl_b32 s63, s63, 10
v_xor_b32 v56, s63, v56
v_xor_b32 v84, 0x0, v56
v_xor_b32 v85, 0x40, v56
v_xor_b32 v86, 0x10000, v56
v_xor_b32 v87, 0x10040, v56
v_xor_b32 v88, 0x20000, v56
v_xor_b32 v89, 0x20040, v56
v_xor_b32 v90, 0x800, v56
v_xor_b32 v91, 0x840, v56
v_xor_b32 v92, 0x10800, v56
v_xor_b32 v93, 0x10840, v56
v_xor_b32 v94, 0x20800, v56
v_xor_b32 v95, 0x20840, v56
v_lshrrev_b32 v56, 2, v0
v_and_b32 v57, 3, v0
v_and_b32 v58, 1, v57
v_lshrrev_b32 v59, 1, v57
v_lshl_or_b32 v57, v58, 1, v59
v_and_b32 v58, 7, v56
v_lshlrev_b32 v58, 5, v58
v_lshl_or_b32 v58, v56, 9, v58
v_lshl_or_b32 v58, v57, 3, v58
v_xor_b32 v32, 0x0, v58
v_xor_b32 v33, 0x20, v58
v_xor_b32 v34, 0x40, v58
v_xor_b32 v35, 0x60, v58
v_xor_b32 v36, 0x80, v58
v_xor_b32 v37, 0xa0, v58
v_xor_b32 v38, 0xc0, v58
v_xor_b32 v39, 0xe0, v58
v_xor_b32 v40, 0x10000, v58
v_xor_b32 v41, 0x10020, v58
v_xor_b32 v42, 0x10040, v58
v_xor_b32 v43, 0x10060, v58
v_xor_b32 v44, 0x10080, v58
v_xor_b32 v45, 0x100a0, v58
v_xor_b32 v46, 0x100c0, v58
v_xor_b32 v47, 0x100e0, v58
v_xor_b32 v48, 0x20000, v58
v_xor_b32 v49, 0x20020, v58
v_xor_b32 v50, 0x20040, v58
v_xor_b32 v51, 0x20060, v58
v_xor_b32 v52, 0x20080, v58
v_xor_b32 v53, 0x200a0, v58
v_xor_b32 v54, 0x200c0, v58
v_xor_b32 v55, 0x200e0, v58
s_mul_i32 s63, s75, 229376
s_add_u32 s24, s24, s63
s_addc_u32 s25, s25, 0
s_lshl_b32 s74, s3, 3
s_add_u32 s74, s74, s73
s_mul_i32 s63, s74, 1851392
s_add_u32 s28, s28, s63
s_addc_u32 s29, s29, 0
s_mov_b32 s63, 1851388
s_cmp_lg_u32 s6, 0
s_cbranch_scc1 LA_tw0
s_load_dword s98, s[12:13], 0
s_load_dword s98, s[24:25], 0
LA_tw0:
s_cmp_lg_u32 s6, 1
s_cbranch_scc1 LA_tw1
s_load_dword s98, s[16:17], 0
s_load_dword s98, s[24:25], 229372
LA_tw1:
s_cmp_lg_u32 s6, 2
s_cbranch_scc1 LA_tw2
s_load_dword s98, s[28:29], 8192
s_load_dword s98, s[68:69], 0
LA_tw2:
s_cmp_lg_u32 s6, 3
s_cbranch_scc1 LA_tw3
s_load_dword s98, s[28:29], s63
s_load_dword s98, s[64:65], 192
LA_tw3:
s_waitcnt vmcnt(8)
ds_read_b128 a[64:67], v84 offset:0
ds_read_b128 a[68:71], v90 offset:0
ds_read_b128 a[72:75], v85 offset:0
ds_read_b128 a[76:79], v91 offset:0
s_waitcnt vmcnt(4)
s_barrier
ds_read_b64_tr_b16 a[192:193], v32 offset:16384
ds_read_b64_tr_b16 a[194:195], v32 offset:24576
ds_read_b64_tr_b16 a[196:197], v33 offset:16384
ds_read_b64_tr_b16 a[198:199], v33 offset:24576
ds_read_b64_tr_b16 a[200:201], v34 offset:16384
ds_read_b64_tr_b16 a[202:203], v34 offset:24576
ds_read_b64_tr_b16 a[204:205], v35 offset:16384
ds_read_b64_tr_b16 a[206:207], v35 offset:24576
s_waitcnt lgkmcnt(6)
ds_read_b64_tr_b16 a[208:209], v36 offset:16384
ds_read_b64_tr_b16 a[210:211], v36 offset:24576
v_mfma_f32_16x16x32_bf16 v[128:131], a[192:195], a[64:67], 0
s_add_u32 m0, s32, 49152
ds_read_b64_tr_b16 a[212:213], v37 offset:16384
v_bfe_u32 v58, v56, 1, 2
v_mfma_f32_16x16x32_bf16 v[136:139], a[192:195], a[68:71], 0
s_waitcnt lgkmcnt(7)
buffer_load_dwordx4 v80, s[8:11], s49 offen offset:0 lds
v_mfma_f32_16x16x32_bf16 v[132:135], a[196:199], a[64:67], 0
ds_read_b64_tr_b16 a[214:215], v37 offset:24576
v_lshlrev_b32 v58, 5, v58
v_mfma_f32_16x16x32_bf16 v[140:143], a[196:199], a[68:71], 0
s_waitcnt lgkmcnt(6)
buffer_load_dwordx4 v81, s[8:11], s49 offen offset:1024 lds
v_mfma_f32_16x16x32_bf16 v[144:147], a[200:203], a[64:67], 0
ds_read_b64_tr_b16 a[216:217], v38 offset:16384
v_lshl_or_b32 v58, v56, 7, v58
v_mfma_f32_16x16x32_bf16 v[152:155], a[200:203], a[68:71], 0
s_waitcnt lgkmcnt(2)
buffer_load_dwordx4 v82, s[8:11], s49 offen offset:2048 lds
v_mfma_f32_16x16x32_bf16 v[148:151], a[204:207], a[64:67], 0
ds_read_b64_tr_b16 a[218:219], v38 offset:24576
v_lshl_or_b32 v5, v57, 3, v58
v_mfma_f32_16x16x32_bf16 v[156:159], a[204:207], a[68:71], 0
buffer_load_dwordx4 v83, s[8:11], s49 offen offset:3072 lds
v_mfma_f32_16x16x32_bf16 v[160:163], a[208:211], a[64:67], 0
s_add_u32 m0, s32, 65536
ds_read_b64_tr_b16 a[220:221], v39 offset:16384
ds_read_b64_tr_b16 a[222:223], v39 offset:24576
v_mfma_f32_16x16x32_bf16 v[168:171], a[208:211], a[68:71], 0
s_waitcnt lgkmcnt(3)
ds_read_b64_tr_b16 a[224:225], v32 offset:16640
v_and_b32 v58, 7, v60
v_mfma_f32_16x16x32_bf16 v[164:167], a[212:215], a[64:67], 0
s_add_u32 s33, s41, 0
ds_read_b64_tr_b16 a[226:227], v32 offset:24832
v_lshlrev_b32 v58, 1, v58
v_mfma_f32_16x16x32_bf16 v[172:175], a[212:215], a[68:71], 0
s_waitcnt lgkmcnt(4)
buffer_load_dwordx4 v12, s[20:23], s33 offen offset:0 lds
v_mfma_f32_16x16x32_bf16 v[176:179], a[216:219], a[64:67], 0
ds_read_b64_tr_b16 a[228:229], v33 offset:16640
ds_read_b64_tr_b16 a[230:231], v33 offset:24832
v_mfma_f32_16x16x32_bf16 v[184:187], a[216:219], a[68:71], 0
s_waitcnt lgkmcnt(4)
buffer_load_dwordx4 v13, s[20:23], s33 offen offset:1024 lds
v_mfma_f32_16x16x32_bf16 v[180:183], a[220:223], a[64:67], 0
ds_read_b64_tr_b16 a[232:233], v34 offset:16640
ds_read_b64_tr_b16 a[234:235], v34 offset:24832
v_mfma_f32_16x16x32_bf16 v[188:191], a[220:223], a[68:71], 0
s_waitcnt lgkmcnt(4)
buffer_load_dwordx4 v14, s[20:23], s33 offen offset:2048 lds
v_mfma_f32_16x16x32_bf16 v[192:195], a[224:227], a[64:67], 0
ds_read_b64_tr_b16 a[236:237], v35 offset:16640
ds_read_b64_tr_b16 a[238:239], v35 offset:24832
v_mfma_f32_16x16x32_bf16 v[200:203], a[224:227], a[68:71], 0
s_waitcnt lgkmcnt(4)
buffer_load_dwordx4 v15, s[20:23], s33 offen offset:3072 lds
v_mfma_f32_16x16x32_bf16 v[196:199], a[228:231], a[64:67], 0
s_add_u32 m0, s32, 81920
ds_read_b64_tr_b16 a[192:193], v36 offset:16640
ds_read_b64_tr_b16 a[194:195], v36 offset:24832
v_mfma_f32_16x16x32_bf16 v[204:207], a[228:231], a[68:71], 0
s_waitcnt lgkmcnt(4)
ds_read_b64_tr_b16 a[196:197], v37 offset:16640
v_xor_b32 v58, v58, v61
v_mfma_f32_16x16x32_bf16 v[208:211], a[232:235], a[64:67], 0
s_xor_b32 s33, s99, 0
ds_read_b64_tr_b16 a[198:199], v37 offset:24832
v_lshlrev_b32 v58, 4, v58
v_mfma_f32_16x16x32_bf16 v[216:219], a[232:235], a[68:71], 0
s_waitcnt lgkmcnt(4)
buffer_load_dwordx4 v16, s[12:15], s33 offen offset:0 nt lds
v_mfma_f32_16x16x32_bf16 v[212:215], a[236:239], a[64:67], 0
ds_read_b64_tr_b16 a[200:201], v38 offset:16640
ds_read_b64_tr_b16 a[202:203], v38 offset:24832
v_mfma_f32_16x16x32_bf16 v[220:223], a[236:239], a[68:71], 0
s_waitcnt lgkmcnt(4)
ds_read_b64_tr_b16 a[204:205], v39 offset:16640
v_lshl_or_b32 v58, v60, 9, v58
v_mfma_f32_16x16x32_bf16 v[224:227], a[192:195], a[64:67], 0
s_waitcnt vmcnt(9)
ds_read_b64_tr_b16 a[206:207], v39 offset:24832
v_xor_b32 v20, 0x0, v58
v_mfma_f32_16x16x32_bf16 v[232:235], a[192:195], a[68:71], 0
s_waitcnt lgkmcnt(4)
buffer_load_dwordx4 v17, s[12:15], s33 offen offset:1024 nt lds
v_mfma_f32_16x16x32_bf16 v[228:231], a[196:199], a[64:67], 0
s_barrier
ds_read_b64_tr_b16 a[208:209], v32 offset:32768
ds_read_b64_tr_b16 a[210:211], v32 offset:40960
v_mfma_f32_16x16x32_bf16 v[236:239], a[196:199], a[68:71], 0
s_waitcnt lgkmcnt(4)
ds_read_b64_tr_b16 a[212:213], v33 offset:32768
v_xor_b32 v21, 0x40, v58
v_mfma_f32_16x16x32_bf16 v[240:243], a[200:203], a[64:67], 0
ds_read_b64_tr_b16 a[214:215], v33 offset:40960
v_xor_b32 v22, 0x80, v58
v_mfma_f32_16x16x32_bf16 v[248:251], a[200:203], a[68:71], 0
s_waitcnt lgkmcnt(4)
buffer_load_dwordx4 v18, s[12:15], s33 offen offset:2048 nt lds
v_mfma_f32_16x16x32_bf16 v[244:247], a[204:207], a[64:67], 0
ds_read_b64_tr_b16 a[216:217], v34 offset:32768
ds_read_b64_tr_b16 a[218:219], v34 offset:40960
v_mfma_f32_16x16x32_bf16 v[252:255], a[204:207], a[68:71], 0
s_waitcnt lgkmcnt(4)
ds_read_b64_tr_b16 a[220:221], v35 offset:32768
v_xor_b32 v23, 0xc0, v58
v_mfma_f32_16x16x32_bf16 v[128:131], a[208:211], a[72:75], v[128:131]
ds_read_b64_tr_b16 a[222:223], v35 offset:40960
v_xor_b32 v24, 0x10000, v58
v_mfma_f32_16x16x32_bf16 v[136:139], a[208:211], a[76:79], v[136:139]
s_waitcnt lgkmcnt(4)
buffer_load_dwordx4 v19, s[12:15], s33 offen offset:3072 nt lds
v_mfma_f32_16x16x32_bf16 v[132:135], a[212:215], a[72:75], v[132:135]
s_add_u32 m0, s32, 98304
ds_read_b64_tr_b16 a[224:225], v36 offset:32768
ds_read_b64_tr_b16 a[226:227], v36 offset:40960
v_mfma_f32_16x16x32_bf16 v[140:143], a[212:215], a[76:79], v[140:143]
s_waitcnt lgkmcnt(4)
ds_read_b64_tr_b16 a[228:229], v37 offset:32768
v_xor_b32 v25, 0x10040, v58
v_mfma_f32_16x16x32_bf16 v[144:147], a[216:219], a[72:75], v[144:147]
s_add_u32 s33, s41, 262144
ds_read_b64_tr_b16 a[230:231], v37 offset:40960
v_xor_b32 v26, 0x10080, v58
v_mfma_f32_16x16x32_bf16 v[152:155], a[216:219], a[76:79], v[152:155]
s_waitcnt lgkmcnt(4)
buffer_load_dwordx4 v12, s[20:23], s33 offen offset:0 lds
v_mfma_f32_16x16x32_bf16 v[148:151], a[220:223], a[72:75], v[148:151]
ds_read_b64_tr_b16 a[232:233], v38 offset:32768
ds_read_b64_tr_b16 a[234:235], v38 offset:40960
v_mfma_f32_16x16x32_bf16 v[156:159], a[220:223], a[76:79], v[156:159]
s_waitcnt lgkmcnt(4)
buffer_load_dwordx4 v13, s[20:23], s33 offen offset:1024 lds
v_mfma_f32_16x16x32_bf16 v[160:163], a[224:227], a[72:75], v[160:163]
ds_read_b64_tr_b16 a[236:237], v39 offset:32768
ds_read_b64_tr_b16 a[238:239], v39 offset:40960
v_mfma_f32_16x16x32_bf16 v[168:171], a[224:227], a[76:79], v[168:171]
s_waitcnt lgkmcnt(4)
buffer_load_dwordx4 v14, s[20:23], s33 offen offset:2048 lds
v_mfma_f32_16x16x32_bf16 v[164:167], a[228:231], a[72:75], v[164:167]
ds_read_b64_tr_b16 a[192:193], v32 offset:33024
ds_read_b64_tr_b16 a[194:195], v32 offset:41216
v_mfma_f32_16x16x32_bf16 v[172:175], a[228:231], a[76:79], v[172:175]
s_waitcnt lgkmcnt(4)
buffer_load_dwordx4 v15, s[20:23], s33 offen offset:3072 lds
v_mfma_f32_16x16x32_bf16 v[176:179], a[232:235], a[72:75], v[176:179]
s_add_u32 m0, s32, 114688
ds_read_b64_tr_b16 a[196:197], v33 offset:33024
ds_read_b64_tr_b16 a[198:199], v33 offset:41216
v_mfma_f32_16x16x32_bf16 v[184:187], a[232:235], a[76:79], v[184:187]
s_waitcnt lgkmcnt(4)
buffer_load_dwordx4 v80, s[8:11], s50 offen offset:0 lds
v_mfma_f32_16x16x32_bf16 v[180:183], a[236:239], a[72:75], v[180:183]
ds_read_b64_tr_b16 a[200:201], v34 offset:33024
ds_read_b64_tr_b16 a[202:203], v34 offset:41216
v_mfma_f32_16x16x32_bf16 v[188:191], a[236:239], a[76:79], v[188:191]
s_waitcnt lgkmcnt(4)
buffer_load_dwordx4 v81, s[8:11], s50 offen offset:1024 lds
v_mfma_f32_16x16x32_bf16 v[192:195], a[192:195], a[72:75], v[192:195]
ds_read_b64_tr_b16 a[204:205], v35 offset:33024
ds_read_b64_tr_b16 a[206:207], v35 offset:41216
v_mfma_f32_16x16x32_bf16 v[200:203], a[192:195], a[76:79], v[200:203]
s_waitcnt lgkmcnt(4)
buffer_load_dwordx4 v82, s[8:11], s50 offen offset:2048 lds
v_mfma_f32_16x16x32_bf16 v[196:199], a[196:199], a[72:75], v[196:199]
ds_read_b64_tr_b16 a[208:209], v36 offset:33024
ds_read_b64_tr_b16 a[210:211], v36 offset:41216
v_mfma_f32_16x16x32_bf16 v[204:207], a[196:199], a[76:79], v[204:207]
s_waitcnt lgkmcnt(4)
buffer_load_dwordx4 v83, s[8:11], s50 offen offset:3072 lds
v_mfma_f32_16x16x32_bf16 v[208:211], a[200:203], a[72:75], v[208:211]
s_add_u32 m0, s32, 131072
ds_read_b64_tr_b16 a[212:213], v37 offset:33024
ds_read_b64_tr_b16 a[214:215], v37 offset:41216
v_mfma_f32_16x16x32_bf16 v[216:219], a[200:203], a[76:79], v[216:219]
s_waitcnt lgkmcnt(4)
ds_read_b64_tr_b16 a[216:217], v38 offset:33024
v_xor_b32 v27, 0x100c0, v58
v_mfma_f32_16x16x32_bf16 v[212:215], a[204:207], a[72:75], v[212:215]
s_add_u32 s33, s42, 0
ds_read_b64_tr_b16 a[218:219], v38 offset:41216
v_xor_b32 v28, 0x20000, v58
v_mfma_f32_16x16x32_bf16 v[220:223], a[204:207], a[76:79], v[220:223]
s_waitcnt lgkmcnt(4)
buffer_load_dwordx4 v12, s[20:23], s33 offen offset:0 lds
v_mfma_f32_16x16x32_bf16 v[224:227], a[208:211], a[72:75], v[224:227]
ds_read_b64_tr_b16 a[220:221], v39 offset:33024
ds_read_b64_tr_b16 a[222:223], v39 offset:41216
v_mfma_f32_16x16x32_bf16 v[232:235], a[208:211], a[76:79], v[232:235]
s_waitcnt lgkmcnt(4)
buffer_load_dwordx4 v13, s[20:23], s33 offen offset:1024 lds
v_mfma_f32_16x16x32_bf16 v[228:231], a[212:215], a[72:75], v[228:231]
s_waitcnt vmcnt(18)
ds_read_b128 a[80:83], v84 offset:49152
ds_read_b128 a[84:87], v90 offset:49152
v_mfma_f32_16x16x32_bf16 v[236:239], a[212:215], a[76:79], v[236:239]
s_waitcnt lgkmcnt(4)
ds_read_b128 a[88:91], v85 offset:49152
ds_read_b128 a[92:95], v91 offset:49152
v_mfma_f32_16x16x32_bf16 v[240:243], a[216:219], a[72:75], v[240:243]
s_waitcnt vmcnt(14)
buffer_load_dwordx4 v14, s[20:23], s33 offen offset:2048 lds
v_mfma_f32_16x16x32_bf16 v[248:251], a[216:219], a[76:79], v[248:251]
s_waitcnt lgkmcnt(4)
v_xor_b32 v29, 0x20040, v58
v_xor_b32 v30, 0x20080, v58
v_mfma_f32_16x16x32_bf16 v[244:247], a[220:223], a[72:75], v[244:247]
s_barrier
ds_read_b64_tr_b16 a[224:225], v40 offset:0
ds_read_b64_tr_b16 a[226:227], v40 offset:8192
v_mfma_f32_16x16x32_bf16 v[252:255], a[220:223], a[76:79], v[252:255]
s_waitcnt lgkmcnt(0)
ds_read_b64_tr_b16 a[228:229], v41 offset:0
ds_read_b64_tr_b16 a[230:231], v41 offset:8192
v_mfma_f32_16x16x32_bf16 v[128:131], a[224:227], a[80:83], v[128:131]
LA_t2:
s_load_dword s98, s[96:97], 18740
ds_read_b64_tr_b16 a[232:233], v42 offset:0
ds_read_b64_tr_b16 a[234:235], v42 offset:8192
v_mfma_f32_16x16x32_bf16 v[136:139], a[224:227], a[84:87], v[136:139]
s_waitcnt lgkmcnt(2)
ds_read_b64_tr_b16 a[236:237], v43 offset:0
ds_read_b64_tr_b16 a[238:239], v43 offset:8192
v_mfma_f32_16x16x32_bf16 v[132:135], a[228:231], a[80:83], v[132:135]
ds_read_b64_tr_b16 a[192:193], v44 offset:0
ds_read_b64_tr_b16 a[194:195], v44 offset:8192
v_mfma_f32_16x16x32_bf16 v[140:143], a[228:231], a[84:87], v[140:143]
s_waitcnt lgkmcnt(4)
buffer_load_dwordx4 v15, s[20:23], s33 offen offset:3072 lds
v_mfma_f32_16x16x32_bf16 v[144:147], a[232:235], a[80:83], v[144:147]
s_add_u32 m0, s32, 147456
ds_read_b64_tr_b16 a[196:197], v45 offset:0
ds_read_b64_tr_b16 a[198:199], v45 offset:8192
v_mfma_f32_16x16x32_bf16 v[152:155], a[232:235], a[84:87], v[152:155]
s_waitcnt lgkmcnt(4)
ds_read_b64_tr_b16 a[200:201], v46 offset:0
v_xor_b32 v31, 0x200c0, v58
v_mfma_f32_16x16x32_bf16 v[148:151], a[236:239], a[80:83], v[148:151]
s_add_u32 s33, s42, 262144
ds_read_b64_tr_b16 a[202:203], v46 offset:8192
ds_read_b64_tr_b16 a[204:205], v47 offset:0
v_mfma_f32_16x16x32_bf16 v[156:159], a[236:239], a[84:87], v[156:159]
s_waitcnt lgkmcnt(5)
buffer_load_dwordx4 v12, s[20:23], s33 offen offset:0 lds
v_mfma_f32_16x16x32_bf16 v[160:163], a[192:195], a[80:83], v[160:163]
s_mov_b32 s35, 0x3db8aa3b
ds_read_b64_tr_b16 a[206:207], v47 offset:8192
ds_read_b64_tr_b16 a[208:209], v40 offset:256
v_mfma_f32_16x16x32_bf16 v[168:171], a[192:195], a[84:87], v[168:171]
s_waitcnt lgkmcnt(5)
buffer_load_dwordx4 v13, s[20:23], s33 offen offset:1024 lds
v_mfma_f32_16x16x32_bf16 v[164:167], a[196:199], a[80:83], v[164:167]
s_mov_b32 s36, 1073758208
ds_read_b64_tr_b16 a[210:211], v40 offset:8448
ds_read_b64_tr_b16 a[212:213], v41 offset:256
v_mfma_f32_16x16x32_bf16 v[172:175], a[196:199], a[84:87], v[172:175]
s_waitcnt lgkmcnt(4)
buffer_load_dwordx4 v14, s[20:23], s33 offen offset:2048 lds
v_mfma_f32_16x16x32_bf16 v[176:179], a[200:203], a[80:83], v[176:179]
s_mov_b32 s37, 0xc1000000
ds_read_b64_tr_b16 a[214:215], v41 offset:8448
ds_read_b64_tr_b16 a[216:217], v42 offset:256
v_mfma_f32_16x16x32_bf16 v[184:187], a[200:203], a[84:87], v[184:187]
s_waitcnt lgkmcnt(4)
buffer_load_dwordx4 v15, s[20:23], s33 offen offset:3072 lds
v_mfma_f32_16x16x32_bf16 v[180:183], a[204:207], a[80:83], v[180:183]
s_add_u32 m0, s32, 0
ds_read_b64_tr_b16 a[218:219], v42 offset:8448
ds_read_b64_tr_b16 a[220:221], v43 offset:256
v_mfma_f32_16x16x32_bf16 v[188:191], a[204:207], a[84:87], v[188:191]
s_waitcnt lgkmcnt(4)
buffer_load_dwordx4 v80, s[8:11], s51 offen offset:0 lds
v_mfma_f32_16x16x32_bf16 v[192:195], a[208:211], a[80:83], v[192:195]
s_mov_b32 s26, 229376
ds_read_b64_tr_b16 a[222:223], v43 offset:8448
ds_read_b64_tr_b16 a[224:225], v44 offset:256
v_mfma_f32_16x16x32_bf16 v[200:203], a[208:211], a[84:87], v[200:203]
s_waitcnt lgkmcnt(4)
buffer_load_dwordx4 v81, s[8:11], s51 offen offset:1024 lds
v_mfma_f32_16x16x32_bf16 v[196:199], a[212:215], a[80:83], v[196:199]
s_mov_b32 s27, 0x20000
ds_read_b64_tr_b16 a[226:227], v44 offset:8448
ds_read_b64_tr_b16 a[228:229], v45 offset:256
v_mfma_f32_16x16x32_bf16 v[204:207], a[212:215], a[84:87], v[204:207]
s_waitcnt lgkmcnt(4)
buffer_load_dwordx4 v82, s[8:11], s51 offen offset:2048 lds
v_mfma_f32_16x16x32_bf16 v[208:211], a[216:219], a[80:83], v[208:211]
s_mov_b32 s30, 1851392
ds_read_b64_tr_b16 a[230:231], v45 offset:8448
ds_read_b64_tr_b16 a[232:233], v46 offset:256
v_mfma_f32_16x16x32_bf16 v[216:219], a[216:219], a[84:87], v[216:219]
s_waitcnt lgkmcnt(4)
buffer_load_dwordx4 v83, s[8:11], s51 offen offset:3072 lds
v_mfma_f32_16x16x32_bf16 v[212:215], a[220:223], a[80:83], v[212:215]
s_add_u32 m0, s32, 16384
ds_read_b64_tr_b16 a[234:235], v46 offset:8448
ds_read_b64_tr_b16 a[236:237], v47 offset:256
v_mfma_f32_16x16x32_bf16 v[220:223], a[220:223], a[84:87], v[220:223]
s_waitcnt lgkmcnt(4)
ds_read_b64_tr_b16 a[238:239], v47 offset:8448
v_mfma_f32_16x16x32_bf16 v[224:227], a[224:227], a[80:83], v[224:227]
s_waitcnt vmcnt(16)
v_mfma_f32_16x16x32_bf16 v[232:235], a[224:227], a[84:87], v[232:235]
s_waitcnt lgkmcnt(3)
v_mfma_f32_16x16x32_bf16 v[228:231], a[228:231], a[80:83], v[228:231]
s_barrier
ds_read_b64_tr_b16 a[192:193], v40 offset:32768
ds_read_b64_tr_b16 a[194:195], v40 offset:40960
v_mfma_f32_16x16x32_bf16 v[236:239], a[228:231], a[84:87], v[236:239]
s_waitcnt lgkmcnt(3)
ds_read_b64_tr_b16 a[196:197], v41 offset:32768
ds_read_b64_tr_b16 a[198:199], v41 offset:40960
v_mfma_f32_16x16x32_bf16 v[240:243], a[232:235], a[80:83], v[240:243]
s_add_u32 s33, s43, 0
buffer_load_dwordx4 v12, s[20:23], s33 offen offset:0 lds
v_mfma_f32_16x16x32_bf16 v[248:251], a[232:235], a[84:87], v[248:251]
s_waitcnt lgkmcnt(4)
ds_read_b64_tr_b16 a[200:201], v42 offset:32768
ds_read_b64_tr_b16 a[202:203], v42 offset:40960
v_mfma_f32_16x16x32_bf16 v[244:247], a[236:239], a[80:83], v[244:247]
s_mov_b32 s31, 0x20000
buffer_load_dwordx4 v13, s[20:23], s33 offen offset:1024 lds
v_mfma_f32_16x16x32_bf16 v[252:255], a[236:239], a[84:87], v[252:255]
s_waitcnt lgkmcnt(4)
ds_read_b64_tr_b16 a[204:205], v43 offset:32768
ds_read_b64_tr_b16 a[206:207], v43 offset:40960
v_mfma_f32_16x16x32_bf16 v[128:131], a[192:195], a[88:91], v[128:131]
s_lshl_b32 s63, s74, 3
buffer_load_dwordx4 v14, s[20:23], s33 offen offset:2048 lds
v_mfma_f32_16x16x32_bf16 v[136:139], a[192:195], a[92:95], v[136:139]
s_waitcnt lgkmcnt(4)
ds_read_b64_tr_b16 a[208:209], v44 offset:32768
ds_read_b64_tr_b16 a[210:211], v44 offset:40960
v_mfma_f32_16x16x32_bf16 v[132:135], a[196:199], a[88:91], v[132:135]
s_add_u32 s64, s64, s63
s_addc_u32 s65, s65, 0
buffer_load_dwordx4 v15, s[20:23], s33 offen offset:3072 lds
v_mfma_f32_16x16x32_bf16 v[140:143], a[196:199], a[92:95], v[140:143]
s_waitcnt lgkmcnt(4)
ds_read_b64_tr_b16 a[212:213], v45 offset:32768
ds_read_b64_tr_b16 a[214:215], v45 offset:40960
v_mfma_f32_16x16x32_bf16 v[144:147], a[200:203], a[88:91], v[144:147]
s_add_u32 m0, s32, 32768
ds_read_b64_tr_b16 a[216:217], v46 offset:32768
ds_read_b64_tr_b16 a[218:219], v46 offset:40960
v_mfma_f32_16x16x32_bf16 v[152:155], a[200:203], a[92:95], v[152:155]
s_waitcnt lgkmcnt(6)
buffer_load_dwordx4 v80, s[8:11], s52 offen offset:0 lds
v_mfma_f32_16x16x32_bf16 v[148:151], a[204:207], a[88:91], v[148:151]
s_mov_b32 s66, 8
ds_read_b64_tr_b16 a[220:221], v47 offset:32768
ds_read_b64_tr_b16 a[222:223], v47 offset:40960
v_mfma_f32_16x16x32_bf16 v[156:159], a[204:207], a[92:95], v[156:159]
s_waitcnt lgkmcnt(6)
buffer_load_dwordx4 v81, s[8:11], s52 offen offset:1024 lds
v_mfma_f32_16x16x32_bf16 v[160:163], a[208:211], a[88:91], v[160:163]
s_mov_b32 s67, 0x20000
ds_read_b64_tr_b16 a[224:225], v40 offset:33024
ds_read_b64_tr_b16 a[226:227], v40 offset:41216
v_mfma_f32_16x16x32_bf16 v[168:171], a[208:211], a[92:95], v[168:171]
s_waitcnt lgkmcnt(4)
buffer_load_dwordx4 v82, s[8:11], s52 offen offset:2048 lds
v_mfma_f32_16x16x32_bf16 v[164:167], a[212:215], a[88:91], v[164:167]
s_mov_b32 s70, 1835008
ds_read_b64_tr_b16 a[228:229], v41 offset:33024
ds_read_b64_tr_b16 a[230:231], v41 offset:41216
v_mfma_f32_16x16x32_bf16 v[172:175], a[212:215], a[92:95], v[172:175]
s_mov_b32 s71, 0x20000
buffer_load_dwordx4 v83, s[8:11], s52 offen offset:3072 lds
v_mfma_f32_16x16x32_bf16 v[176:179], a[216:219], a[88:91], v[176:179]
s_add_u32 m0, s32, 49152
ds_read_b64_tr_b16 a[232:233], v42 offset:33024
v_lshrrev_b32 v56, 3, v0
v_mfma_f32_16x16x32_bf16 v[184:187], a[216:219], a[92:95], v[184:187]
s_waitcnt lgkmcnt(3)
ds_read_b64_tr_b16 a[234:235], v42 offset:41216
v_and_b32 v57, 3, v56
v_mfma_f32_16x16x32_bf16 v[180:183], a[220:223], a[88:91], v[180:183]
s_add_u32 s33, s43, 262144
buffer_load_dwordx4 v12, s[20:23], s33 offen offset:0 lds
v_mfma_f32_16x16x32_bf16 v[188:191], a[220:223], a[92:95], v[188:191]
ds_read_b64_tr_b16 a[236:237], v43 offset:33024
v_lshrrev_b32 v58, 2, v56
v_mfma_f32_16x16x32_bf16 v[192:195], a[224:227], a[88:91], v[192:195]
ds_read_b64_tr_b16 a[238:239], v43 offset:41216
v_lshl_or_b32 v57, v58, 3, v57
v_mfma_f32_16x16x32_bf16 v[200:203], a[224:227], a[92:95], v[200:203]
s_waitcnt lgkmcnt(3)
buffer_load_dwordx4 v13, s[20:23], s33 offen offset:1024 lds
v_mfma_f32_16x16x32_bf16 v[196:199], a[228:231], a[88:91], v[196:199]
s_lshl_b32 s7, s6, 5
ds_read_b64_tr_b16 a[192:193], v44 offset:33024
ds_read_b64_tr_b16 a[194:195], v44 offset:41216
v_mfma_f32_16x16x32_bf16 v[204:207], a[228:231], a[92:95], v[204:207]
s_waitcnt lgkmcnt(4)
buffer_load_dwordx4 v14, s[20:23], s33 offen offset:2048 lds
v_mfma_f32_16x16x32_bf16 v[208:211], a[232:235], a[88:91], v[208:211]
ds_read_b64_tr_b16 a[196:197], v45 offset:33024
ds_read_b64_tr_b16 a[198:199], v45 offset:41216
v_mfma_f32_16x16x32_bf16 v[216:219], a[232:235], a[92:95], v[216:219]
s_waitcnt lgkmcnt(4)
buffer_load_dwordx4 v15, s[20:23], s33 offen offset:3072 lds
v_mfma_f32_16x16x32_bf16 v[212:215], a[236:239], a[88:91], v[212:215]
ds_read_b64_tr_b16 a[200:201], v46 offset:33024
ds_read_b64_tr_b16 a[202:203], v46 offset:41216
v_mfma_f32_16x16x32_bf16 v[220:223], a[236:239], a[92:95], v[220:223]
s_waitcnt lgkmcnt(4)
ds_read_b64_tr_b16 a[204:205], v47 offset:33024
v_add_u32 v57, s7, v57
v_mfma_f32_16x16x32_bf16 v[224:227], a[192:195], a[88:91], v[224:227]
ds_read_b64_tr_b16 a[206:207], v47 offset:41216
v_mul_u32_u24 v57, 896, v57
v_mfma_f32_16x16x32_bf16 v[232:235], a[192:195], a[92:95], v[232:235]
s_waitcnt lgkmcnt(4)
v_and_b32 v58, 6, v56
v_and_b32 v59, 7, v0
v_mfma_f32_16x16x32_bf16 v[228:231], a[196:199], a[88:91], v[228:231]
s_waitcnt vmcnt(24)
ds_read_b128 a[96:99], v86 offset:49152
ds_read_b128 a[100:103], v92 offset:49152
v_mfma_f32_16x16x32_bf16 v[236:239], a[196:199], a[92:95], v[236:239]
s_waitcnt lgkmcnt(4)
ds_read_b128 a[104:107], v87 offset:49152
ds_read_b128 a[108:111], v93 offset:49152
v_mfma_f32_16x16x32_bf16 v[240:243], a[200:203], a[88:91], v[240:243]
s_waitcnt vmcnt(20)
v_xor_b32 v58, v58, v59
v_mfma_f32_16x16x32_bf16 v[248:251], a[200:203], a[92:95], v[248:251]
s_waitcnt lgkmcnt(4)
v_mfma_f32_16x16x32_bf16 v[244:247], a[204:207], a[88:91], v[244:247]
s_barrier
ds_read_b64_tr_b16 a[208:209], v48 offset:0
ds_read_b64_tr_b16 a[210:211], v48 offset:8192
v_mfma_f32_16x16x32_bf16 v[252:255], a[204:207], a[92:95], v[252:255]
s_waitcnt lgkmcnt(0)
ds_read_b64_tr_b16 a[212:213], v49 offset:0
ds_read_b64_tr_b16 a[214:215], v49 offset:8192
v_mfma_f32_16x16x32_bf16 v[128:131], a[208:211], a[96:99], v[128:131]
LA_t4:
s_load_dword s98, s[96:97], 20320
ds_read_b64_tr_b16 a[216:217], v50 offset:0
ds_read_b64_tr_b16 a[218:219], v50 offset:8192
v_mfma_f32_16x16x32_bf16 v[136:139], a[208:211], a[100:103], v[136:139]
s_waitcnt lgkmcnt(2)
ds_read_b64_tr_b16 a[220:221], v51 offset:0
ds_read_b64_tr_b16 a[222:223], v51 offset:8192
v_mfma_f32_16x16x32_bf16 v[132:135], a[212:215], a[96:99], v[132:135]
s_add_u32 m0, s32, 65536
ds_read_b64_tr_b16 a[224:225], v52 offset:0
ds_read_b64_tr_b16 a[226:227], v52 offset:8192
v_mfma_f32_16x16x32_bf16 v[140:143], a[212:215], a[100:103], v[140:143]
s_waitcnt lgkmcnt(4)
buffer_load_dwordx4 v80, s[8:11], s53 offen offset:0 lds
v_mfma_f32_16x16x32_bf16 v[144:147], a[216:219], a[96:99], v[144:147]
s_and_b32 s63, s75, 1
ds_read_b64_tr_b16 a[228:229], v53 offset:0
ds_read_b64_tr_b16 a[230:231], v53 offset:8192
v_mfma_f32_16x16x32_bf16 v[152:155], a[216:219], a[100:103], v[152:155]
s_waitcnt lgkmcnt(4)
buffer_load_dwordx4 v81, s[8:11], s53 offen offset:1024 lds
v_mfma_f32_16x16x32_bf16 v[148:151], a[220:223], a[96:99], v[148:151]
s_lshl_b32 s63, s63, 2
ds_read_b64_tr_b16 a[232:233], v54 offset:0
ds_read_b64_tr_b16 a[234:235], v54 offset:8192
v_mfma_f32_16x16x32_bf16 v[156:159], a[220:223], a[100:103], v[156:159]
s_waitcnt lgkmcnt(4)
buffer_load_dwordx4 v82, s[8:11], s53 offen offset:2048 lds
v_mfma_f32_16x16x32_bf16 v[160:163], a[224:227], a[96:99], v[160:163]
ds_read_b64_tr_b16 a[236:237], v55 offset:0
ds_read_b64_tr_b16 a[238:239], v55 offset:8192
v_mfma_f32_16x16x32_bf16 v[168:171], a[224:227], a[100:103], v[168:171]
s_waitcnt lgkmcnt(4)
buffer_load_dwordx4 v83, s[8:11], s53 offen offset:3072 lds
v_mfma_f32_16x16x32_bf16 v[164:167], a[228:231], a[96:99], v[164:167]
s_add_u32 m0, s32, 98304
ds_read_b64_tr_b16 a[192:193], v48 offset:256
ds_read_b64_tr_b16 a[194:195], v48 offset:8448
v_mfma_f32_16x16x32_bf16 v[172:175], a[228:231], a[100:103], v[172:175]
s_waitcnt lgkmcnt(4)
buffer_load_dwordx4 v80, s[8:11], s54 offen offset:0 lds
v_mfma_f32_16x16x32_bf16 v[176:179], a[232:235], a[96:99], v[176:179]
ds_read_b64_tr_b16 a[196:197], v49 offset:256
ds_read_b64_tr_b16 a[198:199], v49 offset:8448
v_mfma_f32_16x16x32_bf16 v[184:187], a[232:235], a[100:103], v[184:187]
s_waitcnt lgkmcnt(4)
buffer_load_dwordx4 v81, s[8:11], s54 offen offset:1024 lds
v_mfma_f32_16x16x32_bf16 v[180:183], a[236:239], a[96:99], v[180:183]
ds_read_b64_tr_b16 a[200:201], v50 offset:256
ds_read_b64_tr_b16 a[202:203], v50 offset:8448
v_mfma_f32_16x16x32_bf16 v[188:191], a[236:239], a[100:103], v[188:191]
s_waitcnt lgkmcnt(4)
buffer_load_dwordx4 v82, s[8:11], s54 offen offset:2048 lds
v_mfma_f32_16x16x32_bf16 v[192:195], a[192:195], a[96:99], v[192:195]
ds_read_b64_tr_b16 a[204:205], v51 offset:256
ds_read_b64_tr_b16 a[206:207], v51 offset:8448
v_mfma_f32_16x16x32_bf16 v[200:203], a[192:195], a[100:103], v[200:203]
s_waitcnt lgkmcnt(4)
buffer_load_dwordx4 v83, s[8:11], s54 offen offset:3072 lds
v_mfma_f32_16x16x32_bf16 v[196:199], a[196:199], a[96:99], v[196:199]
s_add_u32 m0, s32, 114688
ds_read_b64_tr_b16 a[208:209], v52 offset:256
ds_read_b64_tr_b16 a[210:211], v52 offset:8448
v_mfma_f32_16x16x32_bf16 v[204:207], a[196:199], a[100:103], v[204:207]
s_waitcnt lgkmcnt(4)
ds_read_b64_tr_b16 a[212:213], v53 offset:256
v_xor_b32 v58, s63, v58
v_mfma_f32_16x16x32_bf16 v[208:211], a[200:203], a[96:99], v[208:211]
s_xor_b32 s33, s99, 16384
ds_read_b64_tr_b16 a[214:215], v53 offset:8448
v_lshl_add_u32 v8, v58, 4, v57
v_mfma_f32_16x16x32_bf16 v[216:219], a[200:203], a[100:103], v[216:219]
s_waitcnt lgkmcnt(4)
buffer_load_dwordx4 v16, s[12:15], s33 offen offset:0 nt lds
v_mfma_f32_16x16x32_bf16 v[212:215], a[204:207], a[96:99], v[212:215]
ds_read_b64_tr_b16 a[216:217], v54 offset:256
ds_read_b64_tr_b16 a[218:219], v54 offset:8448
v_mfma_f32_16x16x32_bf16 v[220:223], a[204:207], a[100:103], v[220:223]
s_waitcnt lgkmcnt(4)
ds_read_b64_tr_b16 a[220:221], v55 offset:256
v_add_u32 v9, 2560, v8
v_mfma_f32_16x16x32_bf16 v[224:227], a[208:211], a[96:99], v[224:227]
s_waitcnt vmcnt(25)
ds_read_b64_tr_b16 a[222:223], v55 offset:8448
v_add_u32 v10, 12288, v8
v_mfma_f32_16x16x32_bf16 v[232:235], a[208:211], a[100:103], v[232:235]
s_waitcnt lgkmcnt(4)
buffer_load_dwordx4 v17, s[12:15], s33 offen offset:1024 nt lds
v_mfma_f32_16x16x32_bf16 v[228:231], a[212:215], a[96:99], v[228:231]
s_barrier
ds_read_b64_tr_b16 a[224:225], v48 offset:16384
ds_read_b64_tr_b16 a[226:227], v48 offset:24576
v_mfma_f32_16x16x32_bf16 v[236:239], a[212:215], a[100:103], v[236:239]
s_waitcnt lgkmcnt(4)
ds_read_b64_tr_b16 a[228:229], v49 offset:16384
v_add_u32 v11, 14848, v8
v_mfma_f32_16x16x32_bf16 v[240:243], a[216:219], a[96:99], v[240:243]
s_cmp_eq_u32 s73, 7
s_cselect_b32 s7, 0, s73
ds_read_b64_tr_b16 a[230:231], v49 offset:24576
ds_read_b64_tr_b16 a[232:233], v50 offset:16384
v_mfma_f32_16x16x32_bf16 v[248:251], a[216:219], a[100:103], v[248:251]
s_waitcnt lgkmcnt(5)
buffer_load_dwordx4 v18, s[12:15], s33 offen offset:2048 nt lds
v_mfma_f32_16x16x32_bf16 v[244:247], a[220:223], a[96:99], v[244:247]
s_lshl_b32 s56, s7, 7
ds_read_b64_tr_b16 a[234:235], v50 offset:24576
ds_read_b64_tr_b16 a[236:237], v51 offset:16384
v_mfma_f32_16x16x32_bf16 v[252:255], a[220:223], a[100:103], v[252:255]
s_waitcnt lgkmcnt(5)
ds_read_b64_tr_b16 a[238:239], v51 offset:24576
ds_read_b64_tr_b16 a[192:193], v52 offset:16384
v_mfma_f32_16x16x32_bf16 v[128:131], a[224:227], a[104:107], v[128:131]
s_add_u32 s7, s7, 1
buffer_load_dwordx4 v19, s[12:15], s33 offen offset:3072 nt lds
v_mfma_f32_16x16x32_bf16 v[136:139], a[224:227], a[108:111], v[136:139]
s_waitcnt lgkmcnt(4)
ds_read_b64_tr_b16 a[194:195], v52 offset:24576
ds_read_b64_tr_b16 a[196:197], v53 offset:16384
v_mfma_f32_16x16x32_bf16 v[132:135], a[228:231], a[104:107], v[132:135]
s_cmp_eq_u32 s7, 7
s_cselect_b32 s7, 0, s7
ds_read_b64_tr_b16 a[198:199], v53 offset:24576
ds_read_b64_tr_b16 a[200:201], v54 offset:16384
v_mfma_f32_16x16x32_bf16 v[140:143], a[228:231], a[108:111], v[140:143]
s_waitcnt lgkmcnt(6)
ds_read_b64_tr_b16 a[202:203], v54 offset:24576
ds_read_b64_tr_b16 a[204:205], v55 offset:16384
v_mfma_f32_16x16x32_bf16 v[144:147], a[232:235], a[104:107], v[144:147]
s_lshl_b32 s57, s7, 7
ds_read_b64_tr_b16 a[206:207], v55 offset:24576
ds_read_b64_tr_b16 a[208:209], v48 offset:16640
v_mfma_f32_16x16x32_bf16 v[152:155], a[232:235], a[108:111], v[152:155]
s_waitcnt lgkmcnt(8)
ds_read_b64_tr_b16 a[210:211], v48 offset:24832
ds_read_b64_tr_b16 a[212:213], v49 offset:16640
v_mfma_f32_16x16x32_bf16 v[148:151], a[236:239], a[104:107], v[148:151]
s_add_u32 s7, s7, 1
ds_read_b64_tr_b16 a[214:215], v49 offset:24832
ds_read_b64_tr_b16 a[216:217], v50 offset:16640
v_mfma_f32_16x16x32_bf16 v[156:159], a[236:239], a[108:111], v[156:159]
s_waitcnt lgkmcnt(8)
ds_read_b64_tr_b16 a[218:219], v50 offset:24832
ds_read_b64_tr_b16 a[220:221], v51 offset:16640
v_mfma_f32_16x16x32_bf16 v[160:163], a[192:195], a[104:107], v[160:163]
s_cmp_eq_u32 s7, 7
s_cselect_b32 s7, 0, s7
ds_read_b64_tr_b16 a[222:223], v51 offset:24832
ds_read_b64_tr_b16 a[224:225], v52 offset:16640
v_mfma_f32_16x16x32_bf16 v[168:171], a[192:195], a[108:111], v[168:171]
s_lshl_b32 s58, s7, 7
ds_read_b64_tr_b16 a[226:227], v52 offset:24832
ds_read_b64_tr_b16 a[228:229], v53 offset:16640
v_mfma_f32_16x16x32_bf16 v[164:167], a[196:199], a[104:107], v[164:167]
s_add_u32 s7, s7, 1
ds_read_b64_tr_b16 a[230:231], v53 offset:24832
ds_read_b64_tr_b16 a[232:233], v54 offset:16640
v_mfma_f32_16x16x32_bf16 v[172:175], a[196:199], a[108:111], v[172:175]
s_waitcnt lgkmcnt(8)
ds_read_b64_tr_b16 a[234:235], v54 offset:24832
ds_read_b64_tr_b16 a[236:237], v55 offset:16640
v_mfma_f32_16x16x32_bf16 v[176:179], a[200:203], a[104:107], v[176:179]
s_cmp_eq_u32 s7, 7
s_cselect_b32 s7, 0, s7
ds_read_b64_tr_b16 a[238:239], v55 offset:24832
v_mfma_f32_16x16x32_bf16 v[184:187], a[200:203], a[108:111], v[184:187]
s_waitcnt vmcnt(24)
ds_read_b128 a[112:115], v84 offset:0
ds_read_b128 a[116:119], v90 offset:0
v_mfma_f32_16x16x32_bf16 v[180:183], a[204:207], a[104:107], v[180:183]
s_waitcnt vmcnt(20)
ds_read_b128 a[120:123], v85 offset:0
ds_read_b128 a[124:127], v91 offset:0
v_mfma_f32_16x16x32_bf16 v[188:191], a[204:207], a[108:111], v[188:191]
s_barrier
ds_read_b64_tr_b16 a[192:193], v32 offset:16384
ds_read_b64_tr_b16 a[194:195], v32 offset:24576
v_mfma_f32_16x16x32_bf16 v[192:195], a[208:211], a[104:107], v[192:195]
LA_t6:
s_load_dword s98, s[96:97], 21572
ds_read_b64_tr_b16 a[196:197], v33 offset:16384
ds_read_b64_tr_b16 a[198:199], v33 offset:24576
v_mfma_f32_16x16x32_bf16 v[200:203], a[208:211], a[108:111], v[200:203]
s_add_u32 m0, s32, 131072
ds_read_b64_tr_b16 a[200:201], v34 offset:16384
ds_read_b64_tr_b16 a[202:203], v34 offset:24576
v_mfma_f32_16x16x32_bf16 v[196:199], a[212:215], a[104:107], v[196:199]
s_xor_b32 s33, s99, 0
buffer_load_dwordx4 v16, s[16:19], s33 offen offset:0 nt lds
v_mfma_f32_16x16x32_bf16 v[204:207], a[212:215], a[108:111], v[204:207]
s_waitcnt lgkmcnt(6)
ds_read_b64_tr_b16 a[204:205], v35 offset:16384
ds_read_b64_tr_b16 a[206:207], v35 offset:24576
v_mfma_f32_16x16x32_bf16 v[208:211], a[216:219], a[104:107], v[208:211]
s_lshl_b32 s59, s7, 7
ds_read_b64_tr_b16 a[208:209], v36 offset:16384
ds_read_b64_tr_b16 a[210:211], v36 offset:24576
v_mfma_f32_16x16x32_bf16 v[216:219], a[216:219], a[108:111], v[216:219]
s_add_u32 s7, s7, 1
buffer_load_dwordx4 v17, s[16:19], s33 offen offset:1024 nt lds
v_mfma_f32_16x16x32_bf16 v[212:215], a[220:223], a[104:107], v[212:215]
s_cmp_eq_u32 s7, 7
s_cselect_b32 s7, 0, s7
ds_read_b64_tr_b16 a[212:213], v37 offset:16384
ds_read_b64_tr_b16 a[214:215], v37 offset:24576
v_mfma_f32_16x16x32_bf16 v[220:223], a[220:223], a[108:111], v[220:223]
s_lshl_b32 s60, s7, 7
ds_read_b64_tr_b16 a[216:217], v38 offset:16384
ds_read_b64_tr_b16 a[218:219], v38 offset:24576
v_mfma_f32_16x16x32_bf16 v[224:227], a[224:227], a[104:107], v[224:227]
s_add_u32 s7, s7, 1
buffer_load_dwordx4 v18, s[16:19], s33 offen offset:2048 nt lds
v_mfma_f32_16x16x32_bf16 v[232:235], a[224:227], a[108:111], v[232:235]
s_cmp_eq_u32 s7, 7
s_cselect_b32 s7, 0, s7
ds_read_b64_tr_b16 a[220:221], v39 offset:16384
ds_read_b64_tr_b16 a[222:223], v39 offset:24576
v_mfma_f32_16x16x32_bf16 v[228:231], a[228:231], a[104:107], v[228:231]
s_lshl_b32 s61, s7, 7
ds_read_b64_tr_b16 a[224:225], v32 offset:16640
ds_read_b64_tr_b16 a[226:227], v32 offset:24832
v_mfma_f32_16x16x32_bf16 v[236:239], a[228:231], a[108:111], v[236:239]
s_add_u32 s7, s7, 1
buffer_load_dwordx4 v19, s[16:19], s33 offen offset:3072 nt lds
v_mfma_f32_16x16x32_bf16 v[240:243], a[232:235], a[104:107], v[240:243]
s_add_u32 m0, s32, 0
ds_read_b64_tr_b16 a[228:229], v33 offset:16640
ds_read_b64_tr_b16 a[230:231], v33 offset:24832
v_mfma_f32_16x16x32_bf16 v[248:251], a[232:235], a[108:111], v[248:251]
s_add_u32 s33, s44, 0
buffer_load_dwordx4 v12, s[20:23], s33 offen offset:0 lds
v_mfma_f32_16x16x32_bf16 v[244:247], a[236:239], a[104:107], v[244:247]
s_cmp_eq_u32 s7, 7
s_cselect_b32 s7, 0, s7
ds_read_b64_tr_b16 a[232:233], v34 offset:16640
ds_read_b64_tr_b16 a[234:235], v34 offset:24832
v_mfma_f32_16x16x32_bf16 v[252:255], a[236:239], a[108:111], v[252:255]
s_waitcnt lgkmcnt(4)
buffer_load_dwordx4 v13, s[20:23], s33 offen offset:1024 lds
v_mfma_f32_16x16x32_bf16 v[128:131], a[192:195], a[112:115], v[128:131]
s_lshl_b32 s62, s7, 7
ds_read_b64_tr_b16 a[236:237], v35 offset:16640
ds_read_b64_tr_b16 a[238:239], v35 offset:24832
v_mfma_f32_16x16x32_bf16 v[136:139], a[192:195], a[116:119], v[136:139]
s_lshl_b32 s7, s6, 12
buffer_load_dwordx4 v14, s[20:23], s33 offen offset:2048 lds
v_mfma_f32_16x16x32_bf16 v[132:135], a[196:199], a[112:115], v[132:135]
s_mul_i32 s63, s75, 114688
ds_read_b64_tr_b16 a[192:193], v36 offset:16640
ds_read_b64_tr_b16 a[194:195], v36 offset:24832
v_mfma_f32_16x16x32_bf16 v[140:143], a[196:199], a[116:119], v[140:143]
s_add_u32 s7, s7, s63
buffer_load_dwordx4 v15, s[20:23], s33 offen offset:3072 lds
v_mfma_f32_16x16x32_bf16 v[144:147], a[200:203], a[112:115], v[144:147]
ds_read_b64_tr_b16 a[196:197], v37 offset:16640
v_lshlrev_b32 v56, 4, v0
v_mfma_f32_16x16x32_bf16 v[152:155], a[200:203], a[116:119], v[152:155]
ds_read_b64_tr_b16 a[198:199], v37 offset:24832
v_add_u32 v4, s7, v56
v_mfma_f32_16x16x32_bf16 v[148:151], a[204:207], a[112:115], v[148:151]
s_lshl_b32 s7, s6, 14
ds_read_b64_tr_b16 a[200:201], v38 offset:16640
v_add_u32 v58, s7, v56
v_mfma_f32_16x16x32_bf16 v[156:159], a[204:207], a[116:119], v[156:159]
ds_read_b64_tr_b16 a[202:203], v38 offset:24832
v_accvgpr_write_b32 a180, v58
v_mfma_f32_16x16x32_bf16 v[160:163], a[208:211], a[112:115], v[160:163]
ds_read_b64_tr_b16 a[204:205], v39 offset:16640
v_cmp_eq_u32 vcc, 0, v0
v_mfma_f32_16x16x32_bf16 v[168:171], a[208:211], a[116:119], v[168:171]
s_lshl_b32 s7, s101, 10
ds_read_b64_tr_b16 a[206:207], v39 offset:24832
v_mfma_f32_16x16x32_bf16 v[164:167], a[212:215], a[112:115], v[164:167]
s_waitcnt vmcnt(24)
ds_read_b128 a[128:131], v84 offset:32768
ds_read_b128 a[132:135], v90 offset:32768
v_mfma_f32_16x16x32_bf16 v[172:175], a[212:215], a[116:119], v[172:175]
s_waitcnt vmcnt(20)
ds_read_b128 a[136:139], v85 offset:32768
ds_read_b128 a[140:143], v91 offset:32768
v_mfma_f32_16x16x32_bf16 v[176:179], a[216:219], a[112:115], v[176:179]
s_barrier
ds_read_b64_tr_b16 a[208:209], v32 offset:49152
ds_read_b64_tr_b16 a[210:211], v32 offset:57344
v_mfma_f32_16x16x32_bf16 v[184:187], a[216:219], a[116:119], v[184:187]
s_add_u32 m0, s32, 147456
ds_read_b64_tr_b16 a[212:213], v33 offset:49152
ds_read_b64_tr_b16 a[214:215], v33 offset:57344
v_mfma_f32_16x16x32_bf16 v[180:183], a[220:223], a[112:115], v[180:183]
s_add_u32 s33, s44, 262144
buffer_load_dwordx4 v12, s[20:23], s33 offen offset:0 lds
v_mfma_f32_16x16x32_bf16 v[188:191], a[220:223], a[116:119], v[188:191]
s_lshl_b32 s63, s75, 3
ds_read_b64_tr_b16 a[216:217], v34 offset:49152
ds_read_b64_tr_b16 a[218:219], v34 offset:57344
v_mfma_f32_16x16x32_bf16 v[192:195], a[224:227], a[112:115], v[192:195]
s_add_u32 s7, s7, s63
buffer_load_dwordx4 v13, s[20:23], s33 offen offset:1024 lds
v_mfma_f32_16x16x32_bf16 v[200:203], a[224:227], a[116:119], v[200:203]
s_waitcnt lgkmcnt(4)
ds_read_b64_tr_b16 a[220:221], v35 offset:49152
v_mov_b32 v57, 0x40000000
v_mfma_f32_16x16x32_bf16 v[196:199], a[228:231], a[112:115], v[196:199]
buffer_load_dwordx4 v14, s[20:23], s33 offen offset:2048 lds
v_mfma_f32_16x16x32_bf16 v[204:207], a[228:231], a[116:119], v[204:207]
ds_read_b64_tr_b16 a[222:223], v35 offset:57344
v_mov_b32 v56, s7
v_mfma_f32_16x16x32_bf16 v[208:211], a[232:235], a[112:115], v[208:211]
buffer_load_dwordx4 v15, s[20:23], s33 offen offset:3072 lds
v_mfma_f32_16x16x32_bf16 v[216:219], a[232:235], a[116:119], v[216:219]
s_add_u32 m0, s32, 32768
ds_read_b64_tr_b16 a[224:225], v36 offset:49152
v_cndmask_b32 v56, v57, v56, vcc
v_mfma_f32_16x16x32_bf16 v[212:215], a[236:239], a[112:115], v[212:215]
s_add_u32 s33, s45, 0
buffer_load_dwordx4 v12, s[20:23], s33 offen offset:0 lds
v_mfma_f32_16x16x32_bf16 v[220:223], a[236:239], a[116:119], v[220:223]
ds_read_b64_tr_b16 a[226:227], v36 offset:57344
v_accvgpr_write_b32 a181, v56
v_mfma_f32_16x16x32_bf16 v[224:227], a[192:195], a[112:115], v[224:227]
s_cmp_eq_u32 s6, 0
s_cselect_b32 s7, 0, 0x40000000
buffer_load_dwordx4 v13, s[20:23], s33 offen offset:1024 lds
v_mfma_f32_16x16x32_bf16 v[232:235], a[192:195], a[116:119], v[232:235]
s_nop 0
ds_read_b64_tr_b16 a[228:229], v37 offset:49152
v_mov_b32 v56, s7
v_mfma_f32_16x16x32_bf16 v[228:231], a[196:199], a[112:115], v[228:231]
buffer_load_dwordx4 v14, s[20:23], s33 offen offset:2048 lds
v_mfma_f32_16x16x32_bf16 v[236:239], a[196:199], a[116:119], v[236:239]
ds_read_b64_tr_b16 a[230:231], v37 offset:57344
v_cndmask_b32 v1, v57, v56, vcc
v_mfma_f32_16x16x32_bf16 v[240:243], a[200:203], a[112:115], v[240:243]
buffer_load_dwordx4 v15, s[20:23], s33 offen offset:3072 lds
v_mfma_f32_16x16x32_bf16 v[248:251], a[200:203], a[116:119], v[248:251]
ds_read_b64_tr_b16 a[232:233], v38 offset:49152
v_cmp_gt_u32 vcc, 32, v0
v_mfma_f32_16x16x32_bf16 v[244:247], a[204:207], a[112:115], v[244:247]
s_lshr_b32 s7, s75, 2
ds_read_b64_tr_b16 a[234:235], v38 offset:57344
ds_read_b64_tr_b16 a[236:237], v39 offset:49152
v_mfma_f32_16x16x32_bf16 v[252:255], a[204:207], a[116:119], v[252:255]
s_lshl_b32 s7, s7, 10
ds_read_b64_tr_b16 a[238:239], v39 offset:57344
v_lshlrev_b32 v56, 3, v60
v_mfma_f32_16x16x32_bf16 v[128:131], a[208:211], a[120:123], v[128:131]
ds_read_b64_tr_b16 a[192:193], v32 offset:49408
v_add_u32 v56, s7, v56
v_mfma_f32_16x16x32_bf16 v[136:139], a[208:211], a[124:127], v[136:139]
s_waitcnt lgkmcnt(5)
ds_read_b64_tr_b16 a[194:195], v32 offset:57600
v_accvgpr_write_b32 a182, v56
v_mfma_f32_16x16x32_bf16 v[132:135], a[212:215], a[120:123], v[132:135]
s_lshl_b32 s7, s73, 7
ds_read_b64_tr_b16 a[196:197], v33 offset:49408
ds_read_b64_tr_b16 a[198:199], v33 offset:57600
v_mfma_f32_16x16x32_bf16 v[140:143], a[212:215], a[124:127], v[140:143]
s_lshr_b32 s63, s75, 2
ds_read_b64_tr_b16 a[200:201], v34 offset:49408
ds_read_b64_tr_b16 a[202:203], v34 offset:57600
v_mfma_f32_16x16x32_bf16 v[144:147], a[216:219], a[120:123], v[144:147]
s_lshl_b32 s63, s63, 5
ds_read_b64_tr_b16 a[204:205], v35 offset:49408
ds_read_b64_tr_b16 a[206:207], v35 offset:57600
v_mfma_f32_16x16x32_bf16 v[152:155], a[216:219], a[124:127], v[152:155]
s_add_u32 s7, s7, s63
ds_read_b64_tr_b16 a[208:209], v36 offset:49408
ds_read_b64_tr_b16 a[210:211], v36 offset:57600
v_mfma_f32_16x16x32_bf16 v[148:151], a[220:223], a[120:123], v[148:151]
s_and_b32 s63, s75, 2
ds_read_b64_tr_b16 a[212:213], v37 offset:49408
ds_read_b64_tr_b16 a[214:215], v37 offset:57600
v_mfma_f32_16x16x32_bf16 v[156:159], a[220:223], a[124:127], v[156:159]
s_lshl_b32 s63, s63, 3
ds_read_b64_tr_b16 a[216:217], v38 offset:49408
ds_read_b64_tr_b16 a[218:219], v38 offset:57600
v_mfma_f32_16x16x32_bf16 v[160:163], a[224:227], a[120:123], v[160:163]
s_add_u32 s7, s7, s63
ds_read_b64_tr_b16 a[220:221], v39 offset:49408
v_add_u32 v56, s7, v60
v_mfma_f32_16x16x32_bf16 v[168:171], a[224:227], a[124:127], v[168:171]
ds_read_b64_tr_b16 a[222:223], v39 offset:57600
v_mul_u32_u24 v56, 1792, v56
v_mfma_f32_16x16x32_bf16 v[164:167], a[228:231], a[120:123], v[164:167]
s_waitcnt vmcnt(24)
ds_read_b128 a[144:147], v86 offset:0
ds_read_b128 a[148:151], v92 offset:0
v_mfma_f32_16x16x32_bf16 v[172:175], a[228:231], a[124:127], v[172:175]
s_waitcnt lgkmcnt(6)
ds_read_b128 a[152:155], v87 offset:0
ds_read_b128 a[156:159], v93 offset:0
v_mfma_f32_16x16x32_bf16 v[176:179], a[232:235], a[120:123], v[176:179]
s_waitcnt vmcnt(20)
ds_read_b128 a[160:163], v86 offset:32768
ds_read_b128 a[164:167], v92 offset:32768
v_mfma_f32_16x16x32_bf16 v[184:187], a[232:235], a[124:127], v[184:187]
s_waitcnt vmcnt(8)
ds_read_b128 a[168:171], v87 offset:32768
ds_read_b128 a[172:175], v93 offset:32768
v_mfma_f32_16x16x32_bf16 v[180:183], a[236:239], a[120:123], v[180:183]
s_barrier
ds_read_b64_tr_b16 a[224:225], v32 offset:0
ds_read_b64_tr_b16 a[226:227], v32 offset:8192
v_mfma_f32_16x16x32_bf16 v[188:191], a[236:239], a[124:127], v[188:191]
LA_t8:
s_load_dword s98, s[96:97], 23132
ds_read_b64_tr_b16 a[228:229], v33 offset:0
ds_read_b64_tr_b16 a[230:231], v33 offset:8192
v_mfma_f32_16x16x32_bf16 v[192:195], a[192:195], a[120:123], v[192:195]
s_add_u32 m0, s32, 16384
ds_read_b64_tr_b16 a[232:233], v34 offset:0
ds_read_b64_tr_b16 a[234:235], v34 offset:8192
v_mfma_f32_16x16x32_bf16 v[200:203], a[192:195], a[124:127], v[200:203]
s_add_u32 s33, s45, 262144
buffer_load_dwordx4 v12, s[20:23], s33 offen offset:0 lds
v_mfma_f32_16x16x32_bf16 v[196:199], a[196:199], a[120:123], v[196:199]
s_mul_i32 s7, s3, 896
ds_read_b64_tr_b16 a[236:237], v35 offset:0
ds_read_b64_tr_b16 a[238:239], v35 offset:8192
v_mfma_f32_16x16x32_bf16 v[204:207], a[196:199], a[124:127], v[204:207]
s_and_b32 s63, s75, 1
buffer_load_dwordx4 v13, s[20:23], s33 offen offset:1024 lds
v_mfma_f32_16x16x32_bf16 v[208:211], a[200:203], a[120:123], v[208:211]
s_lshl_b32 s63, s63, 6
ds_read_b64_tr_b16 a[192:193], v36 offset:0
ds_read_b64_tr_b16 a[194:195], v36 offset:8192
v_mfma_f32_16x16x32_bf16 v[216:219], a[200:203], a[124:127], v[216:219]
s_add_u32 s7, s7, s63
buffer_load_dwordx4 v14, s[20:23], s33 offen offset:2048 lds
v_mfma_f32_16x16x32_bf16 v[212:215], a[204:207], a[120:123], v[212:215]
ds_read_b64_tr_b16 a[196:197], v37 offset:0
v_and_b32 v58, 1, v61
v_mfma_f32_16x16x32_bf16 v[220:223], a[204:207], a[124:127], v[220:223]
buffer_load_dwordx4 v15, s[20:23], s33 offen offset:3072 lds
v_mfma_f32_16x16x32_bf16 v[224:227], a[208:211], a[120:123], v[224:227]
ds_read_b64_tr_b16 a[198:199], v37 offset:8192
v_lshl_add_u32 v56, v58, 5, v56
v_mfma_f32_16x16x32_bf16 v[232:235], a[208:211], a[124:127], v[232:235]
ds_read_b64_tr_b16 a[200:201], v38 offset:0
v_lshrrev_b32 v58, 1, v61
v_mfma_f32_16x16x32_bf16 v[228:231], a[212:215], a[120:123], v[228:231]
ds_read_b64_tr_b16 a[202:203], v38 offset:8192
v_lshl_add_u32 v56, v58, 4, v56
v_mfma_f32_16x16x32_bf16 v[236:239], a[212:215], a[124:127], v[236:239]
s_waitcnt lgkmcnt(3)
ds_read_b64_tr_b16 a[204:205], v39 offset:0
v_add_u32 v56, s7, v56
v_mfma_f32_16x16x32_bf16 v[240:243], a[216:219], a[120:123], v[240:243]
s_add_u32 m0, s32, 65536
ds_read_b64_tr_b16 a[206:207], v39 offset:8192
v_accvgpr_write_b32 a183, v56
v_mfma_f32_16x16x32_bf16 v[248:251], a[216:219], a[124:127], v[248:251]
s_xor_b32 s33, s99, 32768
buffer_load_dwordx4 v16, s[12:15], s33 offen offset:0 nt lds
v_mfma_f32_16x16x32_bf16 v[244:247], a[220:223], a[120:123], v[244:247]
ds_read_b64_tr_b16 a[208:209], v32 offset:256
v_lshlrev_b32 v56, 4, v60
v_mfma_f32_16x16x32_bf16 v[252:255], a[220:223], a[124:127], v[252:255]
ds_read_b64_tr_b16 a[210:211], v32 offset:8448
v_mov_b32 v58, 0x3f80
v_mfma_f32_16x16x32_bf16 v[128:131], a[224:227], a[128:131], v[128:131]
buffer_load_dwordx4 v17, s[12:15], s33 offen offset:1024 nt lds
v_mfma_f32_16x16x32_bf16 v[136:139], a[224:227], a[132:135], v[136:139]
ds_read_b64_tr_b16 a[212:213], v33 offset:256
v_mov_b32 v59, 0
v_mfma_f32_16x16x32_bf16 v[132:135], a[228:231], a[128:131], v[132:135]
ds_read_b64_tr_b16 a[214:215], v33 offset:8448
v_lshlrev_b64 v[62:63], v56, v[58:59]
v_mfma_f32_16x16x32_bf16 v[140:143], a[228:231], a[132:135], v[140:143]
buffer_load_dwordx4 v18, s[12:15], s33 offen offset:2048 nt lds
v_mfma_f32_16x16x32_bf16 v[144:147], a[232:235], a[128:131], v[144:147]
ds_read_b64_tr_b16 a[216:217], v34 offset:256
v_lshrrev_b32 v57, 2, v60
v_mfma_f32_16x16x32_bf16 v[152:155], a[232:235], a[132:135], v[152:155]
ds_read_b64_tr_b16 a[218:219], v34 offset:8448
v_lshlrev_b32 v58, 1, v61
v_mfma_f32_16x16x32_bf16 v[148:151], a[236:239], a[128:131], v[148:151]
buffer_load_dwordx4 v19, s[12:15], s33 offen offset:3072 nt lds
v_mfma_f32_16x16x32_bf16 v[156:159], a[236:239], a[132:135], v[156:159]
s_add_u32 m0, s32, 98304
ds_read_b64_tr_b16 a[220:221], v35 offset:256
v_sub_u32 v57, v57, v58
v_mfma_f32_16x16x32_bf16 v[160:163], a[192:195], a[128:131], v[160:163]
s_add_u32 s33, s46, 0
buffer_load_dwordx4 v12, s[20:23], s33 offen offset:0 lds
v_mfma_f32_16x16x32_bf16 v[168:171], a[192:195], a[132:135], v[168:171]
s_waitcnt lgkmcnt(2)
ds_read_b64_tr_b16 a[222:223], v35 offset:8448
v_cmp_eq_i32 vcc, 0, v57
s_nop 1
v_mfma_f32_16x16x32_bf16 v[164:167], a[196:199], a[128:131], v[164:167]
buffer_load_dwordx4 v13, s[20:23], s33 offen offset:1024 lds
v_mfma_f32_16x16x32_bf16 v[172:175], a[196:199], a[132:135], v[172:175]
ds_read_b64_tr_b16 a[224:225], v36 offset:256
v_cndmask_b32 v56, 0, v62, vcc
v_mfma_f32_16x16x32_bf16 v[176:179], a[200:203], a[128:131], v[176:179]
buffer_load_dwordx4 v14, s[20:23], s33 offen offset:2048 lds
v_mfma_f32_16x16x32_bf16 v[184:187], a[200:203], a[132:135], v[184:187]
ds_read_b64_tr_b16 a[226:227], v36 offset:8448
v_accvgpr_write_b32 a184, v56
v_mfma_f32_16x16x32_bf16 v[180:183], a[204:207], a[128:131], v[180:183]
buffer_load_dwordx4 v15, s[20:23], s33 offen offset:3072 lds
v_mfma_f32_16x16x32_bf16 v[188:191], a[204:207], a[132:135], v[188:191]
ds_read_b64_tr_b16 a[228:229], v37 offset:256
v_cndmask_b32 v56, 0, v63, vcc
v_mfma_f32_16x16x32_bf16 v[192:195], a[208:211], a[128:131], v[192:195]
ds_read_b64_tr_b16 a[230:231], v37 offset:8448
v_accvgpr_write_b32 a185, v56
v_mfma_f32_16x16x32_bf16 v[200:203], a[208:211], a[132:135], v[200:203]
ds_read_b64_tr_b16 a[232:233], v38 offset:256
v_cmp_eq_i32 vcc, 1, v57
s_nop 1
v_mfma_f32_16x16x32_bf16 v[196:199], a[212:215], a[128:131], v[196:199]
ds_read_b64_tr_b16 a[234:235], v38 offset:8448
v_cndmask_b32 v56, 0, v62, vcc
v_mfma_f32_16x16x32_bf16 v[204:207], a[212:215], a[132:135], v[204:207]
s_waitcnt lgkmcnt(4)
ds_read_b64_tr_b16 a[236:237], v39 offset:256
v_accvgpr_write_b32 a186, v56
v_mfma_f32_16x16x32_bf16 v[208:211], a[216:219], a[128:131], v[208:211]
s_waitcnt vmcnt(16)
ds_read_b64_tr_b16 a[238:239], v39 offset:8448
v_cndmask_b32 v56, 0, v63, vcc
v_mfma_f32_16x16x32_bf16 v[216:219], a[216:219], a[132:135], v[216:219]
s_barrier
ds_read_b64_tr_b16 a[192:193], v48 offset:16384
v_accvgpr_write_b32 a187, v56
v_mfma_f32_16x16x32_bf16 v[212:215], a[220:223], a[128:131], v[212:215]
s_add_u32 m0, s32, 49152
ds_read_b64_tr_b16 a[194:195], v48 offset:24576
v_cmp_eq_i32 vcc, -4, v57
s_nop 1
v_mfma_f32_16x16x32_bf16 v[220:223], a[220:223], a[132:135], v[220:223]
s_xor_b32 s33, s99, 16384
buffer_load_dwordx4 v16, s[16:19], s33 offen offset:0 nt lds
v_mfma_f32_16x16x32_bf16 v[224:227], a[224:227], a[128:131], v[224:227]
ds_read_b64_tr_b16 a[196:197], v49 offset:16384
v_cndmask_b32 v56, 0, v62, vcc
v_mfma_f32_16x16x32_bf16 v[232:235], a[224:227], a[132:135], v[232:235]
s_waitcnt lgkmcnt(3)
ds_read_b64_tr_b16 a[198:199], v49 offset:24576
v_accvgpr_write_b32 a188, v56
v_mfma_f32_16x16x32_bf16 v[228:231], a[228:231], a[128:131], v[228:231]
buffer_load_dwordx4 v17, s[16:19], s33 offen offset:1024 nt lds
v_mfma_f32_16x16x32_bf16 v[236:239], a[228:231], a[132:135], v[236:239]
ds_read_b64_tr_b16 a[200:201], v50 offset:16384
v_cndmask_b32 v56, 0, v63, vcc
v_mfma_f32_16x16x32_bf16 v[240:243], a[232:235], a[128:131], v[240:243]
ds_read_b64_tr_b16 a[202:203], v50 offset:24576
v_accvgpr_write_b32 a189, v56
v_mfma_f32_16x16x32_bf16 v[248:251], a[232:235], a[132:135], v[248:251]
buffer_load_dwordx4 v18, s[16:19], s33 offen offset:2048 nt lds
v_mfma_f32_16x16x32_bf16 v[244:247], a[236:239], a[128:131], v[244:247]
ds_read_b64_tr_b16 a[204:205], v51 offset:16384
v_cmp_eq_i32 vcc, -3, v57
s_nop 1
v_mfma_f32_16x16x32_bf16 v[252:255], a[236:239], a[132:135], v[252:255]
s_waitcnt lgkmcnt(3)
ds_read_b64_tr_b16 a[206:207], v51 offset:24576
v_cndmask_b32 v56, 0, v62, vcc
v_mfma_f32_16x16x32_bf16 v[128:131], a[192:195], a[136:139], v[128:131]
buffer_load_dwordx4 v19, s[16:19], s33 offen offset:3072 nt lds
v_mfma_f32_16x16x32_bf16 v[136:139], a[192:195], a[140:143], v[136:139]
ds_read_b64_tr_b16 a[208:209], v52 offset:16384
v_accvgpr_write_b32 a190, v56
v_mfma_f32_16x16x32_bf16 v[132:135], a[196:199], a[136:139], v[132:135]
ds_read_b64_tr_b16 a[210:211], v52 offset:24576
v_cndmask_b32 v56, 0, v63, vcc
v_mfma_f32_16x16x32_bf16 v[140:143], a[196:199], a[140:143], v[140:143]
s_waitcnt lgkmcnt(3)
ds_read_b64_tr_b16 a[212:213], v53 offset:16384
v_accvgpr_write_b32 a191, v56
v_mfma_f32_16x16x32_bf16 v[144:147], a[200:203], a[136:139], v[144:147]
ds_read_b64_tr_b16 a[214:215], v53 offset:24576
v_mov_b32 v58, 0x3f803f80
v_mfma_f32_16x16x32_bf16 v[152:155], a[200:203], a[140:143], v[152:155]
s_waitcnt lgkmcnt(4)
ds_read_b64_tr_b16 a[216:217], v54 offset:16384
v_accvgpr_write_b32 a176, v58
v_mfma_f32_16x16x32_bf16 v[148:151], a[204:207], a[136:139], v[148:151]
ds_read_b64_tr_b16 a[218:219], v54 offset:24576
v_accvgpr_write_b32 a177, v58
v_mfma_f32_16x16x32_bf16 v[156:159], a[204:207], a[140:143], v[156:159]
s_waitcnt lgkmcnt(4)
ds_read_b64_tr_b16 a[220:221], v55 offset:16384
v_accvgpr_write_b32 a178, v58
v_mfma_f32_16x16x32_bf16 v[160:163], a[208:211], a[136:139], v[160:163]
ds_read_b64_tr_b16 a[222:223], v55 offset:24576
v_accvgpr_write_b32 a179, v58
v_mfma_f32_16x16x32_bf16 v[168:171], a[208:211], a[140:143], v[168:171]
s_waitcnt lgkmcnt(4)
ds_read_b64_tr_b16 a[224:225], v48 offset:16640
v_mov_b32 v56, s80
v_mfma_f32_16x16x32_bf16 v[164:167], a[212:215], a[136:139], v[164:167]
ds_read_b64_tr_b16 a[226:227], v48 offset:24832
v_mov_b32 v57, s81
v_mfma_f32_16x16x32_bf16 v[172:175], a[212:215], a[140:143], v[172:175]
s_waitcnt lgkmcnt(4)
ds_read_b64_tr_b16 a[228:229], v49 offset:16640
v_mov_b32 v58, 0
v_mfma_f32_16x16x32_bf16 v[176:179], a[216:219], a[136:139], v[176:179]
ds_read_b64_tr_b16 a[230:231], v49 offset:24832
v_mov_b32 v59, 0
v_mfma_f32_16x16x32_bf16 v[184:187], a[216:219], a[140:143], v[184:187]
s_waitcnt lgkmcnt(4)
ds_read_b64_tr_b16 a[232:233], v50 offset:16640
v_mov_b32 v60, v1
v_mfma_f32_16x16x32_bf16 v[180:183], a[220:223], a[136:139], v[180:183]
ds_read_b64_tr_b16 a[234:235], v50 offset:24832
ds_read_b64_tr_b16 a[236:237], v51 offset:16640
v_mfma_f32_16x16x32_bf16 v[188:191], a[220:223], a[140:143], v[188:191]
s_waitcnt lgkmcnt(5)
buffer_atomic_cmpswap_x2 v[56:59], v60, s[64:67], 0 offen
v_mfma_f32_16x16x32_bf16 v[192:195], a[224:227], a[136:139], v[192:195]
ds_read_b64_tr_b16 a[238:239], v51 offset:24832
ds_read_b64_tr_b16 a[192:193], v52 offset:16640
v_mfma_f32_16x16x32_bf16 v[200:203], a[224:227], a[140:143], v[200:203]
s_waitcnt lgkmcnt(5)
ds_read_b64_tr_b16 a[194:195], v52 offset:24832
ds_read_b64_tr_b16 a[196:197], v53 offset:16640
v_mfma_f32_16x16x32_bf16 v[196:199], a[228:231], a[136:139], v[196:199]
ds_read_b64_tr_b16 a[198:199], v53 offset:24832
ds_read_b64_tr_b16 a[200:201], v54 offset:16640
v_mfma_f32_16x16x32_bf16 v[204:207], a[228:231], a[140:143], v[204:207]
s_waitcnt lgkmcnt(6)
ds_read_b64_tr_b16 a[202:203], v54 offset:24832
ds_read_b64_tr_b16 a[204:205], v55 offset:16640
v_mfma_f32_16x16x32_bf16 v[208:211], a[232:235], a[136:139], v[208:211]
s_waitcnt vmcnt(17)
ds_read_b64_tr_b16 a[206:207], v55 offset:24832
v_mfma_f32_16x16x32_bf16 v[216:219], a[232:235], a[140:143], v[216:219]
s_waitcnt lgkmcnt(7)
v_mfma_f32_16x16x32_bf16 v[212:215], a[236:239], a[136:139], v[212:215]
s_barrier
ds_read_b64_tr_b16 a[208:209], v32 offset:32768
ds_read_b64_tr_b16 a[210:211], v32 offset:40960
v_mfma_f32_16x16x32_bf16 v[220:223], a[236:239], a[140:143], v[220:223]
s_waitcnt lgkmcnt(5)
ds_read_b64_tr_b16 a[212:213], v33 offset:32768
ds_read_b64_tr_b16 a[214:215], v33 offset:40960
v_mfma_f32_16x16x32_bf16 v[224:227], a[192:195], a[136:139], v[224:227]
LA_t10:
s_load_dword s98, s[96:97], 24808
ds_read_b64_tr_b16 a[216:217], v34 offset:32768
ds_read_b64_tr_b16 a[218:219], v34 offset:40960
v_mfma_f32_16x16x32_bf16 v[232:235], a[192:195], a[140:143], v[232:235]
s_add_u32 m0, s32, 0
ds_read_b64_tr_b16 a[220:221], v35 offset:32768
ds_read_b64_tr_b16 a[222:223], v35 offset:40960
v_mfma_f32_16x16x32_bf16 v[228:231], a[196:199], a[136:139], v[228:231]
s_add_u32 s33, s46, 262144
buffer_load_dwordx4 v12, s[20:23], s33 offen offset:0 lds
v_mfma_f32_16x16x32_bf16 v[236:239], a[196:199], a[140:143], v[236:239]
s_waitcnt lgkmcnt(6)
ds_read_b64_tr_b16 a[224:225], v36 offset:32768
ds_read_b64_tr_b16 a[226:227], v36 offset:40960
v_mfma_f32_16x16x32_bf16 v[240:243], a[200:203], a[136:139], v[240:243]
buffer_load_dwordx4 v13, s[20:23], s33 offen offset:1024 lds
v_mfma_f32_16x16x32_bf16 v[248:251], a[200:203], a[140:143], v[248:251]
ds_read_b64_tr_b16 a[228:229], v37 offset:32768
ds_read_b64_tr_b16 a[230:231], v37 offset:40960
v_mfma_f32_16x16x32_bf16 v[244:247], a[204:207], a[136:139], v[244:247]
buffer_load_dwordx4 v14, s[20:23], s33 offen offset:2048 lds
v_mfma_f32_16x16x32_bf16 v[252:255], a[204:207], a[140:143], v[252:255]
ds_read_b64_tr_b16 a[232:233], v38 offset:32768
ds_read_b64_tr_b16 a[234:235], v38 offset:40960
v_mfma_f32_16x16x32_bf16 v[128:131], a[208:211], a[144:147], v[128:131]
buffer_load_dwordx4 v15, s[20:23], s33 offen offset:3072 lds
v_mfma_f32_16x16x32_bf16 v[136:139], a[208:211], a[148:151], v[136:139]
s_waitcnt lgkmcnt(4)
ds_read_b64_tr_b16 a[236:237], v39 offset:32768
ds_read_b64_tr_b16 a[238:239], v39 offset:40960
v_mfma_f32_16x16x32_bf16 v[132:135], a[212:215], a[144:147], v[132:135]
ds_read_b64_tr_b16 a[192:193], v32 offset:33024
ds_read_b64_tr_b16 a[194:195], v32 offset:41216
v_mfma_f32_16x16x32_bf16 v[140:143], a[212:215], a[148:151], v[140:143]
ds_read_b64_tr_b16 a[196:197], v33 offset:33024
ds_read_b64_tr_b16 a[198:199], v33 offset:41216
v_mfma_f32_16x16x32_bf16 v[144:147], a[216:219], a[144:147], v[144:147]
ds_read_b64_tr_b16 a[200:201], v34 offset:33024
ds_read_b64_tr_b16 a[202:203], v34 offset:41216
v_mfma_f32_16x16x32_bf16 v[152:155], a[216:219], a[148:151], v[152:155]
ds_read_b64_tr_b16 a[204:205], v35 offset:33024
ds_read_b64_tr_b16 a[206:207], v35 offset:41216
v_mfma_f32_16x16x32_bf16 v[148:151], a[220:223], a[144:147], v[148:151]
ds_read_b64_tr_b16 a[208:209], v36 offset:33024
ds_read_b64_tr_b16 a[210:211], v36 offset:41216
v_mfma_f32_16x16x32_bf16 v[156:159], a[220:223], a[148:151], v[156:159]
ds_read_b64_tr_b16 a[212:213], v37 offset:33024
ds_read_b64_tr_b16 a[214:215], v37 offset:41216
v_mfma_f32_16x16x32_bf16 v[160:163], a[224:227], a[144:147], v[160:163]
ds_read_b64_tr_b16 a[216:217], v38 offset:33024
ds_read_b64_tr_b16 a[218:219], v38 offset:41216
v_mfma_f32_16x16x32_bf16 v[168:171], a[224:227], a[148:151], v[168:171]
s_waitcnt lgkmcnt(8)
ds_read_b64_tr_b16 a[220:221], v39 offset:33024
ds_read_b64_tr_b16 a[222:223], v39 offset:41216
v_mfma_f32_16x16x32_bf16 v[164:167], a[228:231], a[144:147], v[164:167]
s_waitcnt vmcnt(17)
v_mfma_f32_16x16x32_bf16 v[172:175], a[228:231], a[148:151], v[172:175]
s_barrier
ds_read_b64_tr_b16 a[224:225], v32 offset:16384
ds_read_b64_tr_b16 a[226:227], v32 offset:24576
v_mfma_f32_16x16x32_bf16 v[176:179], a[232:235], a[144:147], v[176:179]
s_add_u32 m0, s32, 147456
ds_read_b64_tr_b16 a[228:229], v33 offset:16384
ds_read_b64_tr_b16 a[230:231], v33 offset:24576
v_mfma_f32_16x16x32_bf16 v[184:187], a[232:235], a[148:151], v[184:187]
s_xor_b32 s33, s99, 49152
buffer_load_dwordx4 v16, s[12:15], s33 offen offset:0 nt lds
v_mfma_f32_16x16x32_bf16 v[180:183], a[236:239], a[144:147], v[180:183]
ds_read_b64_tr_b16 a[232:233], v34 offset:16384
ds_read_b64_tr_b16 a[234:235], v34 offset:24576
v_mfma_f32_16x16x32_bf16 v[188:191], a[236:239], a[148:151], v[188:191]
ds_read_b64_tr_b16 a[236:237], v35 offset:16384
ds_read_b64_tr_b16 a[238:239], v35 offset:24576
v_mfma_f32_16x16x32_bf16 v[192:195], a[192:195], a[144:147], v[192:195]
buffer_load_dwordx4 v17, s[12:15], s33 offen offset:1024 nt lds
v_mfma_f32_16x16x32_bf16 v[200:203], a[192:195], a[148:151], v[200:203]
ds_read_b64_tr_b16 a[192:193], v36 offset:16384
ds_read_b64_tr_b16 a[194:195], v36 offset:24576
v_mfma_f32_16x16x32_bf16 v[196:199], a[196:199], a[144:147], v[196:199]
v_mfma_f32_16x16x32_bf16 v[204:207], a[196:199], a[148:151], v[204:207]
buffer_load_dwordx4 v18, s[12:15], s33 offen offset:2048 nt lds
v_mfma_f32_16x16x32_bf16 v[208:211], a[200:203], a[144:147], v[208:211]
ds_read_b64_tr_b16 a[196:197], v37 offset:16384
ds_read_b64_tr_b16 a[198:199], v37 offset:24576
v_mfma_f32_16x16x32_bf16 v[216:219], a[200:203], a[148:151], v[216:219]
s_waitcnt lgkmcnt(4)
ds_read_b64_tr_b16 a[200:201], v38 offset:16384
ds_read_b64_tr_b16 a[202:203], v38 offset:24576
v_mfma_f32_16x16x32_bf16 v[212:215], a[204:207], a[144:147], v[212:215]
buffer_load_dwordx4 v19, s[12:15], s33 offen offset:3072 nt lds
v_mfma_f32_16x16x32_bf16 v[220:223], a[204:207], a[148:151], v[220:223]
ds_read_b64_tr_b16 a[204:205], v39 offset:16384
ds_read_b64_tr_b16 a[206:207], v39 offset:24576
v_mfma_f32_16x16x32_bf16 v[224:227], a[208:211], a[144:147], v[224:227]
v_mfma_f32_16x16x32_bf16 v[232:235], a[208:211], a[148:151], v[232:235]
ds_read_b64_tr_b16 a[208:209], v32 offset:16640
ds_read_b64_tr_b16 a[210:211], v32 offset:24832
v_mfma_f32_16x16x32_bf16 v[228:231], a[212:215], a[144:147], v[228:231]
v_mfma_f32_16x16x32_bf16 v[236:239], a[212:215], a[148:151], v[236:239]
ds_read_b64_tr_b16 a[212:213], v33 offset:16640
ds_read_b64_tr_b16 a[214:215], v33 offset:24832
v_mfma_f32_16x16x32_bf16 v[240:243], a[216:219], a[144:147], v[240:243]
v_mfma_f32_16x16x32_bf16 v[248:251], a[216:219], a[148:151], v[248:251]
ds_read_b64_tr_b16 a[216:217], v34 offset:16640
ds_read_b64_tr_b16 a[218:219], v34 offset:24832
v_mfma_f32_16x16x32_bf16 v[244:247], a[220:223], a[144:147], v[244:247]
v_mfma_f32_16x16x32_bf16 v[252:255], a[220:223], a[148:151], v[252:255]
ds_read_b64_tr_b16 a[220:221], v35 offset:16640
ds_read_b64_tr_b16 a[222:223], v35 offset:24832
v_mfma_f32_16x16x32_bf16 v[128:131], a[224:227], a[152:155], v[128:131]
v_mfma_f32_16x16x32_bf16 v[136:139], a[224:227], a[156:159], v[136:139]
ds_read_b64_tr_b16 a[224:225], v36 offset:16640
ds_read_b64_tr_b16 a[226:227], v36 offset:24832
v_mfma_f32_16x16x32_bf16 v[132:135], a[228:231], a[152:155], v[132:135]
v_mfma_f32_16x16x32_bf16 v[140:143], a[228:231], a[156:159], v[140:143]
ds_read_b64_tr_b16 a[228:229], v37 offset:16640
ds_read_b64_tr_b16 a[230:231], v37 offset:24832
v_mfma_f32_16x16x32_bf16 v[144:147], a[232:235], a[152:155], v[144:147]
v_mfma_f32_16x16x32_bf16 v[152:155], a[232:235], a[156:159], v[152:155]
ds_read_b64_tr_b16 a[232:233], v38 offset:16640
ds_read_b64_tr_b16 a[234:235], v38 offset:24832
v_mfma_f32_16x16x32_bf16 v[148:151], a[236:239], a[152:155], v[148:151]
v_mfma_f32_16x16x32_bf16 v[156:159], a[236:239], a[156:159], v[156:159]
s_waitcnt lgkmcnt(4)
ds_read_b64_tr_b16 a[236:237], v39 offset:16640
ds_read_b64_tr_b16 a[238:239], v39 offset:24832
v_mfma_f32_16x16x32_bf16 v[160:163], a[192:195], a[152:155], v[160:163]
v_mfma_f32_16x16x32_bf16 v[168:171], a[192:195], a[156:159], v[168:171]
s_waitcnt vmcnt(13)
v_mfma_f32_16x16x32_bf16 v[164:167], a[196:199], a[152:155], v[164:167]
s_barrier
ds_read_b64_tr_b16 a[192:193], v40 offset:32768
ds_read_b64_tr_b16 a[194:195], v40 offset:40960
v_mfma_f32_16x16x32_bf16 v[172:175], a[196:199], a[156:159], v[172:175]
LA_t12:
s_load_dword s98, s[96:97], 25848
ds_read_b64_tr_b16 a[196:197], v41 offset:32768
ds_read_b64_tr_b16 a[198:199], v41 offset:40960
v_mfma_f32_16x16x32_bf16 v[176:179], a[200:203], a[152:155], v[176:179]
s_add_u32 m0, s32, 32768
v_mfma_f32_16x16x32_bf16 v[184:187], a[200:203], a[156:159], v[184:187]
s_xor_b32 s33, s99, 32768
buffer_load_dwordx4 v16, s[16:19], s33 offen offset:0 nt lds
v_mfma_f32_16x16x32_bf16 v[180:183], a[204:207], a[152:155], v[180:183]
ds_read_b64_tr_b16 a[200:201], v42 offset:32768
ds_read_b64_tr_b16 a[202:203], v42 offset:40960
v_mfma_f32_16x16x32_bf16 v[188:191], a[204:207], a[156:159], v[188:191]
ds_read_b64_tr_b16 a[204:205], v43 offset:32768
ds_read_b64_tr_b16 a[206:207], v43 offset:40960
v_mfma_f32_16x16x32_bf16 v[192:195], a[208:211], a[152:155], v[192:195]
buffer_load_dwordx4 v17, s[16:19], s33 offen offset:1024 nt lds
v_mfma_f32_16x16x32_bf16 v[200:203], a[208:211], a[156:159], v[200:203]
ds_read_b64_tr_b16 a[208:209], v44 offset:32768
ds_read_b64_tr_b16 a[210:211], v44 offset:40960
v_mfma_f32_16x16x32_bf16 v[196:199], a[212:215], a[152:155], v[196:199]
v_mfma_f32_16x16x32_bf16 v[204:207], a[212:215], a[156:159], v[204:207]
buffer_load_dwordx4 v18, s[16:19], s33 offen offset:2048 nt lds
v_mfma_f32_16x16x32_bf16 v[208:211], a[216:219], a[152:155], v[208:211]
ds_read_b64_tr_b16 a[212:213], v45 offset:32768
ds_read_b64_tr_b16 a[214:215], v45 offset:40960
v_mfma_f32_16x16x32_bf16 v[216:219], a[216:219], a[156:159], v[216:219]
ds_read_b64_tr_b16 a[216:217], v46 offset:32768
ds_read_b64_tr_b16 a[218:219], v46 offset:40960
v_mfma_f32_16x16x32_bf16 v[212:215], a[220:223], a[152:155], v[212:215]
buffer_load_dwordx4 v19, s[16:19], s33 offen offset:3072 nt lds
v_mfma_f32_16x16x32_bf16 v[220:223], a[220:223], a[156:159], v[220:223]
ds_read_b64_tr_b16 a[220:221], v47 offset:32768
ds_read_b64_tr_b16 a[222:223], v47 offset:40960
v_mfma_f32_16x16x32_bf16 v[224:227], a[224:227], a[152:155], v[224:227]
v_mfma_f32_16x16x32_bf16 v[232:235], a[224:227], a[156:159], v[232:235]
s_waitcnt lgkmcnt(4)
ds_read_b64_tr_b16 a[224:225], v40 offset:33024
ds_read_b64_tr_b16 a[226:227], v40 offset:41216
v_mfma_f32_16x16x32_bf16 v[228:231], a[228:231], a[152:155], v[228:231]
v_mfma_f32_16x16x32_bf16 v[236:239], a[228:231], a[156:159], v[236:239]
ds_read_b64_tr_b16 a[228:229], v41 offset:33024
ds_read_b64_tr_b16 a[230:231], v41 offset:41216
v_mfma_f32_16x16x32_bf16 v[240:243], a[232:235], a[152:155], v[240:243]
v_mfma_f32_16x16x32_bf16 v[248:251], a[232:235], a[156:159], v[248:251]
ds_read_b64_tr_b16 a[232:233], v42 offset:33024
ds_read_b64_tr_b16 a[234:235], v42 offset:41216
v_mfma_f32_16x16x32_bf16 v[244:247], a[236:239], a[152:155], v[244:247]
v_mfma_f32_16x16x32_bf16 v[252:255], a[236:239], a[156:159], v[252:255]
ds_read_b64_tr_b16 a[236:237], v43 offset:33024
ds_read_b64_tr_b16 a[238:239], v43 offset:41216
v_mfma_f32_16x16x32_bf16 v[128:131], a[192:195], a[160:163], v[128:131]
v_mfma_f32_16x16x32_bf16 v[136:139], a[192:195], a[164:167], v[136:139]
ds_read_b64_tr_b16 a[192:193], v44 offset:33024
ds_read_b64_tr_b16 a[194:195], v44 offset:41216
v_mfma_f32_16x16x32_bf16 v[132:135], a[196:199], a[160:163], v[132:135]
v_mfma_f32_16x16x32_bf16 v[140:143], a[196:199], a[164:167], v[140:143]
ds_read_b64_tr_b16 a[196:197], v45 offset:33024
ds_read_b64_tr_b16 a[198:199], v45 offset:41216
v_mfma_f32_16x16x32_bf16 v[144:147], a[200:203], a[160:163], v[144:147]
v_mfma_f32_16x16x32_bf16 v[152:155], a[200:203], a[164:167], v[152:155]
ds_read_b64_tr_b16 a[200:201], v46 offset:33024
ds_read_b64_tr_b16 a[202:203], v46 offset:41216
v_mfma_f32_16x16x32_bf16 v[148:151], a[204:207], a[160:163], v[148:151]
v_mfma_f32_16x16x32_bf16 v[156:159], a[204:207], a[164:167], v[156:159]
s_waitcnt vmcnt(8)
ds_read_b64_tr_b16 a[204:205], v47 offset:33024
ds_read_b64_tr_b16 a[206:207], v47 offset:41216
v_mfma_f32_16x16x32_bf16 v[160:163], a[208:211], a[160:163], v[160:163]
s_barrier
v_mfma_f32_16x16x32_bf16 v[168:171], a[208:211], a[164:167], v[168:171]
s_add_u32 m0, s32, 16384
ds_read_b64_tr_b16 a[208:209], v32 offset:0
ds_read_b64_tr_b16 a[210:211], v32 offset:8192
v_mfma_f32_16x16x32_bf16 v[164:167], a[212:215], a[160:163], v[164:167]
s_xor_b32 s33, s99, 65536
buffer_load_dwordx4 v16, s[12:15], s33 offen offset:0 nt lds
v_mfma_f32_16x16x32_bf16 v[172:175], a[212:215], a[164:167], v[172:175]
s_waitcnt lgkmcnt(4)
ds_read_b64_tr_b16 a[212:213], v33 offset:0
ds_read_b64_tr_b16 a[214:215], v33 offset:8192
v_mfma_f32_16x16x32_bf16 v[176:179], a[216:219], a[160:163], v[176:179]
v_mfma_f32_16x16x32_bf16 v[184:187], a[216:219], a[164:167], v[184:187]
buffer_load_dwordx4 v17, s[12:15], s33 offen offset:1024 nt lds
v_mfma_f32_16x16x32_bf16 v[180:183], a[220:223], a[160:163], v[180:183]
ds_read_b64_tr_b16 a[216:217], v34 offset:0
ds_read_b64_tr_b16 a[218:219], v34 offset:8192
v_mfma_f32_16x16x32_bf16 v[188:191], a[220:223], a[164:167], v[188:191]
ds_read_b64_tr_b16 a[220:221], v35 offset:0
ds_read_b64_tr_b16 a[222:223], v35 offset:8192
v_mfma_f32_16x16x32_bf16 v[192:195], a[224:227], a[160:163], v[192:195]
buffer_load_dwordx4 v18, s[12:15], s33 offen offset:2048 nt lds
v_mfma_f32_16x16x32_bf16 v[200:203], a[224:227], a[164:167], v[200:203]
ds_read_b64_tr_b16 a[224:225], v36 offset:0
ds_read_b64_tr_b16 a[226:227], v36 offset:8192
v_mfma_f32_16x16x32_bf16 v[196:199], a[228:231], a[160:163], v[196:199]
v_mfma_f32_16x16x32_bf16 v[204:207], a[228:231], a[164:167], v[204:207]
buffer_load_dwordx4 v19, s[12:15], s33 offen offset:3072 nt lds
v_mfma_f32_16x16x32_bf16 v[208:211], a[232:235], a[160:163], v[208:211]
ds_read_b64_tr_b16 a[228:229], v37 offset:0
ds_read_b64_tr_b16 a[230:231], v37 offset:8192
v_mfma_f32_16x16x32_bf16 v[216:219], a[232:235], a[164:167], v[216:219]
ds_read_b64_tr_b16 a[232:233], v38 offset:0
ds_read_b64_tr_b16 a[234:235], v38 offset:8192
v_mfma_f32_16x16x32_bf16 v[212:215], a[236:239], a[160:163], v[212:215]
v_mfma_f32_16x16x32_bf16 v[220:223], a[236:239], a[164:167], v[220:223]
ds_read_b64_tr_b16 a[236:237], v39 offset:0
ds_read_b64_tr_b16 a[238:239], v39 offset:8192
v_mfma_f32_16x16x32_bf16 v[224:227], a[192:195], a[160:163], v[224:227]
v_mfma_f32_16x16x32_bf16 v[232:235], a[192:195], a[164:167], v[232:235]
ds_read_b64_tr_b16 a[192:193], v32 offset:256
ds_read_b64_tr_b16 a[194:195], v32 offset:8448
v_mfma_f32_16x16x32_bf16 v[228:231], a[196:199], a[160:163], v[228:231]
v_mfma_f32_16x16x32_bf16 v[236:239], a[196:199], a[164:167], v[236:239]
ds_read_b64_tr_b16 a[196:197], v33 offset:256
ds_read_b64_tr_b16 a[198:199], v33 offset:8448
v_mfma_f32_16x16x32_bf16 v[240:243], a[200:203], a[160:163], v[240:243]
v_mfma_f32_16x16x32_bf16 v[248:251], a[200:203], a[164:167], v[248:251]
s_waitcnt lgkmcnt(4)
ds_read_b64_tr_b16 a[200:201], v34 offset:256
ds_read_b64_tr_b16 a[202:203], v34 offset:8448
v_mfma_f32_16x16x32_bf16 v[244:247], a[204:207], a[160:163], v[244:247]
v_mfma_f32_16x16x32_bf16 v[252:255], a[204:207], a[164:167], v[252:255]
ds_read_b64_tr_b16 a[204:205], v35 offset:256
ds_read_b64_tr_b16 a[206:207], v35 offset:8448
v_mfma_f32_16x16x32_bf16 v[128:131], a[208:211], a[168:171], v[128:131]
v_mfma_f32_16x16x32_bf16 v[136:139], a[208:211], a[172:175], v[136:139]
ds_read_b64_tr_b16 a[208:209], v36 offset:256
ds_read_b64_tr_b16 a[210:211], v36 offset:8448
v_mfma_f32_16x16x32_bf16 v[132:135], a[212:215], a[168:171], v[132:135]
v_mfma_f32_16x16x32_bf16 v[140:143], a[212:215], a[172:175], v[140:143]
ds_read_b64_tr_b16 a[212:213], v37 offset:256
ds_read_b64_tr_b16 a[214:215], v37 offset:8448
v_mfma_f32_16x16x32_bf16 v[144:147], a[216:219], a[168:171], v[144:147]
v_mfma_f32_16x16x32_bf16 v[152:155], a[216:219], a[172:175], v[152:155]
ds_read_b64_tr_b16 a[216:217], v38 offset:256
ds_read_b64_tr_b16 a[218:219], v38 offset:8448
v_mfma_f32_16x16x32_bf16 v[148:151], a[220:223], a[168:171], v[148:151]
v_cvt_pk_bf16_f32 v128, v128, v129
v_cvt_pk_bf16_f32 v129, v130, v131
v_mfma_f32_16x16x32_bf16 v[156:159], a[220:223], a[172:175], v[156:159]
ds_read_b64_tr_b16 a[220:221], v39 offset:256
v_cvt_pk_bf16_f32 v130, v132, v133
v_mfma_f32_16x16x32_bf16 v[160:163], a[224:227], a[168:171], v[160:163]
ds_read_b64_tr_b16 a[222:223], v39 offset:8448
v_cvt_pk_bf16_f32 v131, v134, v135
v_mfma_f32_16x16x32_bf16 v[168:171], a[224:227], a[172:175], v[168:171]
s_barrier
ds_read_b128 a[224:227], v24 offset:16384
v_cvt_pk_bf16_f32 v136, v136, v137
v_mfma_f32_16x16x32_bf16 v[164:167], a[228:231], a[168:171], v[164:167]
LA_t14:
s_load_dword s98, s[96:97], 27024
v_cvt_pk_bf16_f32 v137, v138, v139
v_cvt_pk_bf16_f32 v138, v140, v141
v_mfma_f32_16x16x32_bf16 v[172:175], a[228:231], a[172:175], v[172:175]
s_add_u32 m0, s32, 98304
ds_read_b128 a[228:231], v24 offset:24576
v_cvt_pk_bf16_f32 v139, v142, v143
v_mfma_f32_16x16x32_bf16 v[176:179], a[232:235], a[168:171], v[176:179]
s_xor_b32 s33, s99, 49152
buffer_load_dwordx4 v16, s[16:19], s33 offen offset:0 nt lds
v_mfma_f32_16x16x32_bf16 v[184:187], a[232:235], a[172:175], v[184:187]
ds_read_b128 a[232:235], v25 offset:16384
v_permlane32_swap_b32 v128, v130
v_mfma_f32_16x16x32_bf16 v[180:183], a[236:239], a[168:171], v[180:183]
v_permlane32_swap_b32 v129, v131
v_permlane32_swap_b32 v136, v138
v_mfma_f32_16x16x32_bf16 v[188:191], a[236:239], a[172:175], v[188:191]
s_waitcnt lgkmcnt(2)
buffer_load_dwordx4 v17, s[16:19], s33 offen offset:1024 nt lds
v_mfma_f32_16x16x32_bf16 v[192:195], a[192:195], a[168:171], v[192:195]
ds_read_b128 a[236:239], v25 offset:24576
v_permlane32_swap_b32 v137, v139
v_mfma_f32_16x16x32_bf16 v[200:203], a[192:195], a[172:175], v[200:203]
ds_read_b128 a[192:195], v26 offset:16384
v_accvgpr_write_b32 a0, v128
v_mfma_f32_16x16x32_bf16 v[196:199], a[196:199], a[168:171], v[196:199]
buffer_load_dwordx4 v18, s[16:19], s33 offen offset:2048 nt lds
v_mfma_f32_16x16x32_bf16 v[204:207], a[196:199], a[172:175], v[204:207]
ds_read_b128 a[196:199], v26 offset:24576
v_accvgpr_write_b32 a1, v129
v_mfma_f32_16x16x32_bf16 v[208:211], a[200:203], a[168:171], v[208:211]
v_accvgpr_write_b32 a2, v130
v_accvgpr_write_b32 a3, v131
v_mfma_f32_16x16x32_bf16 v[216:219], a[200:203], a[172:175], v[216:219]
buffer_load_dwordx4 v19, s[16:19], s33 offen offset:3072 nt lds
v_mfma_f32_16x16x32_bf16 v[212:215], a[204:207], a[168:171], v[212:215]
ds_read_b128 a[200:203], v27 offset:16384
v_accvgpr_write_b32 a4, v136
v_mfma_f32_16x16x32_bf16 v[220:223], a[204:207], a[172:175], v[220:223]
ds_read_b128 a[204:207], v27 offset:24576
v_accvgpr_write_b32 a5, v137
v_mfma_f32_16x16x32_bf16 v[224:227], a[208:211], a[168:171], v[224:227]
v_accvgpr_write_b32 a6, v138
v_accvgpr_write_b32 a7, v139
v_mfma_f32_16x16x32_bf16 v[232:235], a[208:211], a[172:175], v[232:235]
ds_read_b128 a[208:211], v24 offset:16640
v_cvt_pk_bf16_f32 v144, v144, v145
v_mfma_f32_16x16x32_bf16 v[228:231], a[212:215], a[168:171], v[228:231]
v_cvt_pk_bf16_f32 v145, v146, v147
v_cvt_pk_bf16_f32 v146, v148, v149
v_mfma_f32_16x16x32_bf16 v[236:239], a[212:215], a[172:175], v[236:239]
ds_read_b128 a[212:215], v24 offset:24832
v_cvt_pk_bf16_f32 v147, v150, v151
v_mfma_f32_16x16x32_bf16 v[240:243], a[216:219], a[168:171], v[240:243]
v_cvt_pk_bf16_f32 v152, v152, v153
v_cvt_pk_bf16_f32 v153, v154, v155
v_mfma_f32_16x16x32_bf16 v[248:251], a[216:219], a[172:175], v[248:251]
ds_read_b128 a[216:219], v25 offset:16640
v_cvt_pk_bf16_f32 v154, v156, v157
v_mfma_f32_16x16x32_bf16 v[244:247], a[220:223], a[168:171], v[244:247]
v_cvt_pk_bf16_f32 v155, v158, v159
v_permlane32_swap_b32 v144, v146
v_mfma_f32_16x16x32_bf16 v[252:255], a[220:223], a[172:175], v[252:255]
ds_read_b128 a[220:223], v25 offset:24832
v_permlane32_swap_b32 v145, v147
v_mfma_f32_16x16x32_bf16 v[96:99], a[224:227], a[0:3], 0
v_permlane32_swap_b32 v152, v154
v_permlane32_swap_b32 v153, v155
v_mfma_f32_16x16x32_bf16 v[104:107], a[224:227], a[4:7], 0
s_waitcnt lgkmcnt(2)
ds_read_b128 a[224:227], v26 offset:16640
v_accvgpr_write_b32 a8, v144
v_mfma_f32_16x16x32_bf16 v[100:103], a[228:231], a[0:3], 0
v_accvgpr_write_b32 a9, v145
v_accvgpr_write_b32 a10, v146
v_mfma_f32_16x16x32_bf16 v[108:111], a[228:231], a[4:7], 0
ds_read_b128 a[228:231], v26 offset:24832
v_accvgpr_write_b32 a11, v147
s_nop 1
v_mfma_f32_16x16x32_bf16 v[96:99], a[232:235], a[8:11], v[96:99]
v_accvgpr_write_b32 a12, v152
v_accvgpr_write_b32 a13, v153
v_accvgpr_write_b32 a14, v154
v_accvgpr_write_b32 a15, v155
s_nop 1
v_mfma_f32_16x16x32_bf16 v[104:107], a[232:235], a[12:15], v[104:107]
ds_read_b128 a[232:235], v27 offset:16640
v_cvt_pk_bf16_f32 v160, v160, v161
v_mfma_f32_16x16x32_bf16 v[100:103], a[236:239], a[8:11], v[100:103]
v_cvt_pk_bf16_f32 v161, v162, v163
v_cvt_pk_bf16_f32 v162, v164, v165
v_mfma_f32_16x16x32_bf16 v[108:111], a[236:239], a[12:15], v[108:111]
ds_read_b128 a[236:239], v27 offset:24832
v_cvt_pk_bf16_f32 v163, v166, v167
v_cvt_pk_bf16_f32 v168, v168, v169
v_cvt_pk_bf16_f32 v169, v170, v171
v_cvt_pk_bf16_f32 v170, v172, v173
v_cvt_pk_bf16_f32 v171, v174, v175
v_permlane32_swap_b32 v160, v162
v_permlane32_swap_b32 v161, v163
v_permlane32_swap_b32 v168, v170
v_permlane32_swap_b32 v169, v171
v_accvgpr_write_b32 a16, v160
v_accvgpr_write_b32 a17, v161
v_accvgpr_write_b32 a18, v162
v_accvgpr_write_b32 a19, v163
s_nop 1
v_mfma_f32_16x16x32_bf16 v[96:99], a[192:195], a[16:19], v[96:99]
v_accvgpr_write_b32 a20, v168
v_accvgpr_write_b32 a21, v169
v_accvgpr_write_b32 a22, v170
v_accvgpr_write_b32 a23, v171
s_nop 1
v_mfma_f32_16x16x32_bf16 v[104:107], a[192:195], a[20:23], v[104:107]
v_cvt_pk_bf16_f32 v176, v176, v177
v_cvt_pk_bf16_f32 v177, v178, v179
v_mfma_f32_16x16x32_bf16 v[100:103], a[196:199], a[16:19], v[100:103]
v_cvt_pk_bf16_f32 v178, v180, v181
v_cvt_pk_bf16_f32 v179, v182, v183
v_mfma_f32_16x16x32_bf16 v[108:111], a[196:199], a[20:23], v[108:111]
v_cvt_pk_bf16_f32 v184, v184, v185
v_cvt_pk_bf16_f32 v185, v186, v187
v_cvt_pk_bf16_f32 v186, v188, v189
v_cvt_pk_bf16_f32 v187, v190, v191
v_permlane32_swap_b32 v176, v178
v_permlane32_swap_b32 v177, v179
v_permlane32_swap_b32 v184, v186
v_permlane32_swap_b32 v185, v187
v_accvgpr_write_b32 a24, v176
v_accvgpr_write_b32 a25, v177
v_accvgpr_write_b32 a26, v178
v_accvgpr_write_b32 a27, v179
s_nop 1
v_mfma_f32_16x16x32_bf16 v[96:99], a[200:203], a[24:27], v[96:99]
s_barrier
ds_read_b128 a[192:195], v24 offset:49152
v_accvgpr_write_b32 a28, v184
v_accvgpr_write_b32 a29, v185
v_accvgpr_write_b32 a30, v186
v_accvgpr_write_b32 a31, v187
s_nop 1
v_mfma_f32_16x16x32_bf16 v[104:107], a[200:203], a[28:31], v[104:107]
s_add_u32 m0, s32, 0
ds_read_b128 a[196:199], v24 offset:57344
v_cvt_pk_bf16_f32 v192, v192, v193
v_mfma_f32_16x16x32_bf16 v[100:103], a[204:207], a[24:27], v[100:103]
s_xor_b32 s33, s99, 81920
buffer_load_dwordx4 v16, s[12:15], s33 offen offset:0 nt lds
v_mfma_f32_16x16x32_bf16 v[108:111], a[204:207], a[28:31], v[108:111]
ds_read_b128 a[200:203], v25 offset:49152
v_cvt_pk_bf16_f32 v193, v194, v195
v_cvt_pk_bf16_f32 v194, v196, v197
v_cvt_pk_bf16_f32 v195, v198, v199
v_cvt_pk_bf16_f32 v200, v200, v201
v_cvt_pk_bf16_f32 v201, v202, v203
v_cvt_pk_bf16_f32 v202, v204, v205
v_cvt_pk_bf16_f32 v203, v206, v207
v_permlane32_swap_b32 v192, v194
v_permlane32_swap_b32 v193, v195
v_permlane32_swap_b32 v200, v202
v_permlane32_swap_b32 v201, v203
v_accvgpr_write_b32 a32, v192
v_accvgpr_write_b32 a33, v193
v_accvgpr_write_b32 a34, v194
v_accvgpr_write_b32 a35, v195
s_nop 1
v_mfma_f32_16x16x32_bf16 v[96:99], a[208:211], a[32:35], v[96:99]
ds_read_b128 a[204:207], v25 offset:57344
v_accvgpr_write_b32 a36, v200
v_accvgpr_write_b32 a37, v201
v_accvgpr_write_b32 a38, v202
v_accvgpr_write_b32 a39, v203
s_nop 1
v_mfma_f32_16x16x32_bf16 v[104:107], a[208:211], a[36:39], v[104:107]
buffer_load_dwordx4 v17, s[12:15], s33 offen offset:1024 nt lds
v_mfma_f32_16x16x32_bf16 v[100:103], a[212:215], a[32:35], v[100:103]
ds_read_b128 a[208:211], v26 offset:49152
v_cvt_pk_bf16_f32 v208, v208, v209
v_mfma_f32_16x16x32_bf16 v[108:111], a[212:215], a[36:39], v[108:111]
s_waitcnt lgkmcnt(3)
ds_read_b128 a[212:215], v26 offset:57344
v_cvt_pk_bf16_f32 v209, v210, v211
v_cvt_pk_bf16_f32 v210, v212, v213
v_cvt_pk_bf16_f32 v211, v214, v215
v_cvt_pk_bf16_f32 v216, v216, v217
v_cvt_pk_bf16_f32 v217, v218, v219
v_cvt_pk_bf16_f32 v218, v220, v221
v_cvt_pk_bf16_f32 v219, v222, v223
v_permlane32_swap_b32 v208, v210
v_permlane32_swap_b32 v209, v211
v_permlane32_swap_b32 v216, v218
v_permlane32_swap_b32 v217, v219
v_accvgpr_write_b32 a40, v208
v_accvgpr_write_b32 a41, v209
v_accvgpr_write_b32 a42, v210
v_accvgpr_write_b32 a43, v211
s_nop 1
v_mfma_f32_16x16x32_bf16 v[96:99], a[216:219], a[40:43], v[96:99]
buffer_load_dwordx4 v18, s[12:15], s33 offen offset:2048 nt lds
v_accvgpr_write_b32 a44, v216
v_accvgpr_write_b32 a45, v217
v_accvgpr_write_b32 a46, v218
v_accvgpr_write_b32 a47, v219
s_nop 1
v_mfma_f32_16x16x32_bf16 v[104:107], a[216:219], a[44:47], v[104:107]
ds_read_b128 a[216:219], v27 offset:49152
v_cvt_pk_bf16_f32 v224, v224, v225
v_mfma_f32_16x16x32_bf16 v[100:103], a[220:223], a[40:43], v[100:103]
v_cvt_pk_bf16_f32 v225, v226, v227
v_cvt_pk_bf16_f32 v226, v228, v229
v_mfma_f32_16x16x32_bf16 v[108:111], a[220:223], a[44:47], v[108:111]
buffer_load_dwordx4 v19, s[12:15], s33 offen offset:3072 nt lds
v_cvt_pk_bf16_f32 v227, v230, v231
v_cvt_pk_bf16_f32 v232, v232, v233
v_cvt_pk_bf16_f32 v233, v234, v235
v_cvt_pk_bf16_f32 v234, v236, v237
v_cvt_pk_bf16_f32 v235, v238, v239
v_permlane32_swap_b32 v224, v226
v_permlane32_swap_b32 v225, v227
v_permlane32_swap_b32 v232, v234
v_permlane32_swap_b32 v233, v235
v_accvgpr_write_b32 a48, v224
v_accvgpr_write_b32 a49, v225
v_accvgpr_write_b32 a50, v226
v_accvgpr_write_b32 a51, v227
s_nop 1
v_mfma_f32_16x16x32_bf16 v[96:99], a[224:227], a[48:51], v[96:99]
ds_read_b128 a[220:223], v27 offset:57344
v_accvgpr_write_b32 a52, v232
v_accvgpr_write_b32 a53, v233
v_accvgpr_write_b32 a54, v234
v_accvgpr_write_b32 a55, v235
s_nop 1
v_mfma_f32_16x16x32_bf16 v[104:107], a[224:227], a[52:55], v[104:107]
ds_read_b128 a[224:227], v24 offset:49408
v_cvt_pk_bf16_f32 v240, v240, v241
v_mfma_f32_16x16x32_bf16 v[100:103], a[228:231], a[48:51], v[100:103]
v_cvt_pk_bf16_f32 v241, v242, v243
v_cvt_pk_bf16_f32 v242, v244, v245
v_mfma_f32_16x16x32_bf16 v[108:111], a[228:231], a[52:55], v[108:111]
ds_read_b128 a[228:231], v24 offset:57600
v_cvt_pk_bf16_f32 v243, v246, v247
v_cvt_pk_bf16_f32 v248, v248, v249
v_cvt_pk_bf16_f32 v249, v250, v251
v_cvt_pk_bf16_f32 v250, v252, v253
v_cvt_pk_bf16_f32 v251, v254, v255
v_permlane32_swap_b32 v240, v242
v_permlane32_swap_b32 v241, v243
v_permlane32_swap_b32 v248, v250
v_permlane32_swap_b32 v249, v251
v_accvgpr_write_b32 a56, v240
v_accvgpr_write_b32 a57, v241
v_accvgpr_write_b32 a58, v242
v_accvgpr_write_b32 a59, v243
s_nop 1
v_mfma_f32_16x16x32_bf16 v[96:99], a[232:235], a[56:59], v[96:99]
v_accvgpr_write_b32 a60, v248
v_accvgpr_write_b32 a61, v249
v_accvgpr_write_b32 a62, v250
v_accvgpr_write_b32 a63, v251
s_nop 1
v_mfma_f32_16x16x32_bf16 v[104:107], a[232:235], a[60:63], v[104:107]
ds_read_b128 a[232:235], v25 offset:49408
v_mfma_f32_16x16x32_bf16 v[100:103], a[236:239], a[56:59], v[100:103]
v_mfma_f32_16x16x32_bf16 v[108:111], a[236:239], a[60:63], v[108:111]
ds_read_b128 a[236:239], v25 offset:57600
v_mfma_f32_16x16x32_bf16 v[112:115], a[192:195], a[0:3], 0
v_mfma_f32_16x16x32_bf16 v[120:123], a[192:195], a[4:7], 0
ds_read_b128 a[192:195], v26 offset:49408
v_mfma_f32_16x16x32_bf16 v[116:119], a[196:199], a[0:3], 0
v_mfma_f32_16x16x32_bf16 v[124:127], a[196:199], a[4:7], 0
s_waitcnt lgkmcnt(2)
ds_read_b128 a[196:199], v26 offset:57600
v_max3_f32 v56, v96, v97, v98
v_mfma_f32_16x16x32_bf16 v[112:115], a[200:203], a[8:11], v[112:115]
v_max3_f32 v57, v104, v105, v106
v_max3_f32 v56, v56, v99, v100
v_mfma_f32_16x16x32_bf16 v[120:123], a[200:203], a[12:15], v[120:123]
ds_read_b128 a[200:203], v27 offset:49408
v_max3_f32 v57, v57, v107, v108
v_mfma_f32_16x16x32_bf16 v[116:119], a[204:207], a[8:11], v[116:119]
v_max3_f32 v56, v56, v101, v102
v_max3_f32 v57, v57, v109, v110
v_mfma_f32_16x16x32_bf16 v[124:127], a[204:207], a[12:15], v[124:127]
ds_read_b128 a[204:207], v27 offset:57600
v_max_f32 v56, v56, v103
v_mfma_f32_16x16x32_bf16 v[112:115], a[208:211], a[16:19], v[112:115]
s_barrier
v_max_f32 v57, v57, v111
v_mov_b32 v58, v56
v_mfma_f32_16x16x32_bf16 v[120:123], a[208:211], a[20:23], v[120:123]
LA_t16:
s_load_dword s98, s[96:97], 29128
ds_read_b64_tr_b16 a[208:209], v48 offset:0
v_mov_b32 v59, v57
v_mfma_f32_16x16x32_bf16 v[116:119], a[212:215], a[16:19], v[116:119]
s_add_u32 m0, s32, 81920
ds_read_b64_tr_b16 a[210:211], v48 offset:8192
v_permlane32_swap_b32 v56, v58
v_mfma_f32_16x16x32_bf16 v[124:127], a[212:215], a[20:23], v[124:127]
s_xor_b32 s33, s99, 65536
buffer_load_dwordx4 v16, s[16:19], s33 offen offset:0 nt lds
v_mfma_f32_16x16x32_bf16 v[112:115], a[216:219], a[24:27], v[112:115]
ds_read_b64_tr_b16 a[212:213], v49 offset:0
v_permlane32_swap_b32 v57, v59
v_mfma_f32_16x16x32_bf16 v[120:123], a[216:219], a[28:31], v[120:123]
ds_read_b64_tr_b16 a[214:215], v49 offset:8192
v_max_f32 v56, v56, v58
v_mfma_f32_16x16x32_bf16 v[116:119], a[220:223], a[24:27], v[116:119]
ds_read_b64_tr_b16 a[216:217], v50 offset:0
v_max_f32 v57, v57, v59
v_mfma_f32_16x16x32_bf16 v[124:127], a[220:223], a[28:31], v[124:127]
ds_read_b64_tr_b16 a[218:219], v50 offset:8192
v_mov_b32 v58, v56
v_mfma_f32_16x16x32_bf16 v[112:115], a[224:227], a[32:35], v[112:115]
ds_read_b64_tr_b16 a[220:221], v51 offset:0
v_mov_b32 v59, v57
v_mfma_f32_16x16x32_bf16 v[120:123], a[224:227], a[36:39], v[120:123]
ds_read_b64_tr_b16 a[222:223], v51 offset:8192
v_permlane16_swap_b32 v56, v58
v_mfma_f32_16x16x32_bf16 v[116:119], a[228:231], a[32:35], v[116:119]
ds_read_b64_tr_b16 a[224:225], v52 offset:0
v_permlane16_swap_b32 v57, v59
v_mfma_f32_16x16x32_bf16 v[124:127], a[228:231], a[36:39], v[124:127]
ds_read_b64_tr_b16 a[226:227], v52 offset:8192
v_max_f32 v56, v56, v58
v_mfma_f32_16x16x32_bf16 v[112:115], a[232:235], a[40:43], v[112:115]
ds_read_b64_tr_b16 a[228:229], v53 offset:0
v_max_f32 v57, v57, v59
v_mfma_f32_16x16x32_bf16 v[120:123], a[232:235], a[44:47], v[120:123]
s_waitcnt lgkmcnt(4)
ds_read_b64_tr_b16 a[230:231], v53 offset:8192
v_mul_f32 v56, s35, v56
v_mfma_f32_16x16x32_bf16 v[116:119], a[236:239], a[40:43], v[116:119]
ds_read_b64_tr_b16 a[232:233], v54 offset:0
v_mul_f32 v57, s35, v57
v_mfma_f32_16x16x32_bf16 v[124:127], a[236:239], a[44:47], v[124:127]
buffer_load_dwordx4 v17, s[16:19], s33 offen offset:1024 nt lds
v_mfma_f32_16x16x32_bf16 v[112:115], a[192:195], a[48:51], v[112:115]
ds_read_b64_tr_b16 a[234:235], v54 offset:8192
v_sub_f32 v72, s37, v56
v_mfma_f32_16x16x32_bf16 v[120:123], a[192:195], a[52:55], v[120:123]
ds_read_b64_tr_b16 a[236:237], v55 offset:0
v_sub_f32 v76, s37, v57
v_mfma_f32_16x16x32_bf16 v[116:119], a[196:199], a[48:51], v[116:119]
ds_read_b64_tr_b16 a[238:239], v55 offset:8192
v_fma_f32 v56, v96, s35, v72
v_mfma_f32_16x16x32_bf16 v[124:127], a[196:199], a[52:55], v[124:127]
ds_read_b64_tr_b16 a[192:193], v48 offset:256
v_fma_f32 v57, v97, s35, v72
v_mfma_f32_16x16x32_bf16 v[112:115], a[200:203], a[56:59], v[112:115]
v_exp_f32 v56, v56
v_mfma_f32_16x16x32_bf16 v[120:123], a[200:203], a[60:63], v[120:123]
ds_read_b64_tr_b16 a[194:195], v48 offset:8448
v_fma_f32 v58, v98, s35, v72
v_mfma_f32_16x16x32_bf16 v[116:119], a[204:207], a[56:59], v[116:119]
v_exp_f32 v57, v57
v_mfma_f32_16x16x32_bf16 v[124:127], a[204:207], a[60:63], v[124:127]
ds_read_b64_tr_b16 a[196:197], v49 offset:256
v_fma_f32 v59, v99, s35, v72
v_exp_f32 v58, v58
v_fma_f32 v60, v100, s35, v72
v_exp_f32 v59, v59
v_fma_f32 v61, v101, s35, v72
v_cvt_pk_bf16_f32 v80, v56, v57
v_exp_f32 v60, v60
v_fma_f32 v62, v102, s35, v72
v_exp_f32 v61, v61
v_fma_f32 v63, v103, s35, v72
v_cvt_pk_bf16_f32 v81, v58, v59
v_exp_f32 v62, v62
v_fma_f32 v56, v104, s35, v76
v_exp_f32 v63, v63
v_fma_f32 v57, v105, s35, v76
v_cvt_pk_bf16_f32 v82, v60, v61
v_exp_f32 v56, v56
v_fma_f32 v58, v106, s35, v76
v_exp_f32 v57, v57
v_fma_f32 v59, v107, s35, v76
v_cvt_pk_bf16_f32 v83, v62, v63
v_exp_f32 v58, v58
v_fma_f32 v60, v108, s35, v76
v_exp_f32 v59, v59
v_fma_f32 v61, v109, s35, v76
v_cvt_pk_bf16_f32 v84, v56, v57
v_exp_f32 v60, v60
v_fma_f32 v62, v110, s35, v76
v_exp_f32 v61, v61
v_fma_f32 v63, v111, s35, v76
v_cvt_pk_bf16_f32 v85, v58, v59
v_exp_f32 v62, v62
v_exp_f32 v63, v63
v_cvt_pk_bf16_f32 v86, v60, v61
v_cvt_pk_bf16_f32 v87, v62, v63
v_mfma_f32_16x16x32_bf16 v[64:67], a[176:179], v[80:83], 0
ds_read_b64_tr_b16 a[198:199], v49 offset:8448
ds_read_b64_tr_b16 a[200:201], v50 offset:256
v_mfma_f32_16x16x32_bf16 v[68:71], a[176:179], v[84:87], 0
ds_read_b64_tr_b16 a[202:203], v50 offset:8448
ds_read_b64_tr_b16 a[204:205], v51 offset:256
v_mfma_f32_16x16x32_bf16 v[128:131], a[208:211], v[80:83], 0
ds_read_b64_tr_b16 a[206:207], v51 offset:8448
v_mfma_f32_16x16x32_bf16 v[136:139], a[208:211], v[84:87], 0
buffer_load_dwordx4 v18, s[16:19], s33 offen offset:2048 nt lds
v_mfma_f32_16x16x32_bf16 v[132:135], a[212:215], v[80:83], 0
ds_read_b64_tr_b16 a[208:209], v52 offset:256
v_fma_f32 v56, v112, s35, v72
v_mfma_f32_16x16x32_bf16 v[140:143], a[212:215], v[84:87], 0
ds_read_b64_tr_b16 a[210:211], v52 offset:8448
v_fma_f32 v57, v113, s35, v72
v_mfma_f32_16x16x32_bf16 v[144:147], a[216:219], v[80:83], 0
v_exp_f32 v56, v56
v_mfma_f32_16x16x32_bf16 v[152:155], a[216:219], v[84:87], 0
s_waitcnt lgkmcnt(2)
ds_read_b64_tr_b16 a[212:213], v53 offset:256
v_fma_f32 v58, v114, s35, v72
v_mfma_f32_16x16x32_bf16 v[148:151], a[220:223], v[80:83], 0
v_exp_f32 v57, v57
v_mfma_f32_16x16x32_bf16 v[156:159], a[220:223], v[84:87], 0
ds_read_b64_tr_b16 a[214:215], v53 offset:8448
v_fma_f32 v59, v115, s35, v72
v_mfma_f32_16x16x32_bf16 v[160:163], a[224:227], v[80:83], 0
v_exp_f32 v58, v58
v_mfma_f32_16x16x32_bf16 v[168:171], a[224:227], v[84:87], 0
ds_read_b64_tr_b16 a[216:217], v54 offset:256
v_fma_f32 v60, v116, s35, v72
v_mfma_f32_16x16x32_bf16 v[164:167], a[228:231], v[80:83], 0
v_exp_f32 v59, v59
v_mfma_f32_16x16x32_bf16 v[172:175], a[228:231], v[84:87], 0
ds_read_b64_tr_b16 a[218:219], v54 offset:8448
v_fma_f32 v61, v117, s35, v72
v_mfma_f32_16x16x32_bf16 v[176:179], a[232:235], v[80:83], 0
ds_read_b64_tr_b16 a[220:221], v55 offset:256
v_cvt_pk_bf16_f32 v88, v56, v57
v_mfma_f32_16x16x32_bf16 v[184:187], a[232:235], v[84:87], 0
buffer_load_dwordx4 v19, s[16:19], s33 offen offset:3072 nt lds
v_mfma_f32_16x16x32_bf16 v[180:183], a[236:239], v[80:83], 0
v_exp_f32 v60, v60
v_mfma_f32_16x16x32_bf16 v[188:191], a[236:239], v[84:87], 0
ds_read_b64_tr_b16 a[222:223], v55 offset:8448
v_fma_f32 v62, v118, s35, v72
v_mfma_f32_16x16x32_bf16 v[192:195], a[192:195], v[80:83], 0
s_barrier
v_exp_f32 v61, v61
v_mfma_f32_16x16x32_bf16 v[200:203], a[192:195], v[84:87], 0
s_add_u32 m0, s32, 114688
ds_read_b128 a[224:227], v24 offset:0
v_fma_f32 v63, v119, s35, v72
v_mfma_f32_16x16x32_bf16 v[196:199], a[196:199], v[80:83], 0
s_xor_b32 s33, s99, 98304
ds_read_b128 a[228:231], v24 offset:8192
v_cvt_pk_bf16_f32 v89, v58, v59
v_mfma_f32_16x16x32_bf16 v[204:207], a[196:199], v[84:87], 0
v_exp_f32 v62, v62
v_mfma_f32_16x16x32_bf16 v[208:211], a[200:203], v[80:83], 0
ds_read_b128 a[232:235], v25 offset:0
v_fma_f32 v56, v120, s35, v76
v_mfma_f32_16x16x32_bf16 v[216:219], a[200:203], v[84:87], 0
v_exp_f32 v63, v63
v_mfma_f32_16x16x32_bf16 v[212:215], a[204:207], v[80:83], 0
ds_read_b128 a[236:239], v25 offset:8192
v_fma_f32 v57, v121, s35, v76
v_mfma_f32_16x16x32_bf16 v[220:223], a[204:207], v[84:87], 0
s_waitcnt lgkmcnt(2)
ds_read_b128 a[192:195], v26 offset:0
v_cvt_pk_bf16_f32 v90, v60, v61
v_mfma_f32_16x16x32_bf16 v[224:227], a[208:211], v[80:83], 0
v_exp_f32 v56, v56
v_mfma_f32_16x16x32_bf16 v[232:235], a[208:211], v[84:87], 0
buffer_load_dwordx4 v16, s[12:15], s33 offen offset:0 nt lds
v_mfma_f32_16x16x32_bf16 v[228:231], a[212:215], v[80:83], 0
ds_read_b128 a[196:199], v26 offset:8192
v_fma_f32 v58, v122, s35, v76
v_mfma_f32_16x16x32_bf16 v[236:239], a[212:215], v[84:87], 0
v_exp_f32 v57, v57
v_mfma_f32_16x16x32_bf16 v[240:243], a[216:219], v[80:83], 0
ds_read_b128 a[200:203], v27 offset:0
v_fma_f32 v59, v123, s35, v76
v_mfma_f32_16x16x32_bf16 v[248:251], a[216:219], v[84:87], 0
ds_read_b128 a[204:207], v27 offset:8192
v_cvt_pk_bf16_f32 v91, v62, v63
v_mfma_f32_16x16x32_bf16 v[244:247], a[220:223], v[80:83], 0
v_exp_f32 v58, v58
v_mfma_f32_16x16x32_bf16 v[252:255], a[220:223], v[84:87], 0
ds_read_b128 a[208:211], v24 offset:256
v_fma_f32 v60, v124, s35, v76
v_mfma_f32_16x16x32_bf16 v[96:99], a[224:227], a[0:3], 0
v_exp_f32 v59, v59
v_mfma_f32_16x16x32_bf16 v[104:107], a[224:227], a[4:7], 0
ds_read_b128 a[212:215], v24 offset:8448
v_fma_f32 v61, v125, s35, v76
v_mfma_f32_16x16x32_bf16 v[100:103], a[228:231], a[0:3], 0
ds_read_b128 a[216:219], v25 offset:256
v_cvt_pk_bf16_f32 v92, v56, v57
v_mfma_f32_16x16x32_bf16 v[108:111], a[228:231], a[4:7], 0
s_waitcnt lgkmcnt(3)
v_exp_f32 v60, v60
v_mfma_f32_16x16x32_bf16 v[96:99], a[232:235], a[8:11], v[96:99]
ds_read_b128 a[220:223], v25 offset:8448
v_fma_f32 v62, v126, s35, v76
v_mfma_f32_16x16x32_bf16 v[104:107], a[232:235], a[12:15], v[104:107]
buffer_load_dwordx4 v17, s[12:15], s33 offen offset:1024 nt lds
v_mfma_f32_16x16x32_bf16 v[100:103], a[236:239], a[8:11], v[100:103]
v_exp_f32 v61, v61
v_mfma_f32_16x16x32_bf16 v[108:111], a[236:239], a[12:15], v[108:111]
ds_read_b128 a[224:227], v26 offset:256
v_fma_f32 v63, v127, s35, v76
v_mfma_f32_16x16x32_bf16 v[96:99], a[192:195], a[16:19], v[96:99]
ds_read_b128 a[228:231], v26 offset:8448
v_cvt_pk_bf16_f32 v93, v58, v59
v_mfma_f32_16x16x32_bf16 v[104:107], a[192:195], a[20:23], v[104:107]
v_exp_f32 v62, v62
v_mfma_f32_16x16x32_bf16 v[100:103], a[196:199], a[16:19], v[100:103]
v_exp_f32 v63, v63
v_mfma_f32_16x16x32_bf16 v[108:111], a[196:199], a[20:23], v[108:111]
ds_read_b128 a[232:235], v27 offset:256
v_cvt_pk_bf16_f32 v94, v60, v61
v_mfma_f32_16x16x32_bf16 v[96:99], a[200:203], a[24:27], v[96:99]
ds_read_b128 a[236:239], v27 offset:8448
v_cvt_pk_bf16_f32 v95, v62, v63
v_mfma_f32_16x16x32_bf16 v[104:107], a[200:203], a[28:31], v[104:107]
s_barrier
ds_read_b64_tr_b16 a[192:193], v32 offset:49152
v_or3_b32 v0, v88, v89, v90
v_mfma_f32_16x16x32_bf16 v[100:103], a[204:207], a[24:27], v[100:103]
LA_t18:
s_load_dword s98, s[96:97], 30780
ds_read_b64_tr_b16 a[194:195], v32 offset:57344
v_or3_b32 v1, v91, v92, v93
v_mfma_f32_16x16x32_bf16 v[108:111], a[204:207], a[28:31], v[108:111]
s_waitcnt lgkmcnt(4)
ds_read_b64_tr_b16 a[196:197], v33 offset:49152
v_or3_b32 v0, v0, v94, v95
v_mfma_f32_16x16x32_bf16 v[96:99], a[208:211], a[32:35], v[96:99]
ds_read_b64_tr_b16 a[198:199], v33 offset:57344
v_bitop3_b32 v0, v0, v1, s36 bitop3:0xa8
v_mfma_f32_16x16x32_bf16 v[104:107], a[208:211], a[36:39], v[104:107]
buffer_load_dwordx4 v18, s[12:15], s33 offen offset:2048 nt lds
v_mfma_f32_16x16x32_bf16 v[100:103], a[212:215], a[32:35], v[100:103]
ds_read_b64_tr_b16 a[200:201], v34 offset:49152
v_cmp_ne_u32 vcc, 0, v0
v_mfma_f32_16x16x32_bf16 v[108:111], a[212:215], a[36:39], v[108:111]
s_cbranch_vccnz LA_stub1
LA_back1:
ds_read_b64_tr_b16 a[202:203], v34 offset:57344
ds_read_b64_tr_b16 a[204:205], v35 offset:49152
v_mfma_f32_16x16x32_bf16 v[96:99], a[216:219], a[40:43], v[96:99]
ds_read_b64_tr_b16 a[206:207], v35 offset:57344
ds_read_b64_tr_b16 a[208:209], v36 offset:49152
v_mfma_f32_16x16x32_bf16 v[104:107], a[216:219], a[44:47], v[104:107]
ds_read_b64_tr_b16 a[210:211], v36 offset:57344
ds_read_b64_tr_b16 a[212:213], v37 offset:49152
v_mfma_f32_16x16x32_bf16 v[100:103], a[220:223], a[40:43], v[100:103]
ds_read_b64_tr_b16 a[214:215], v37 offset:57344
ds_read_b64_tr_b16 a[216:217], v38 offset:49152
v_mfma_f32_16x16x32_bf16 v[108:111], a[220:223], a[44:47], v[108:111]
ds_read_b64_tr_b16 a[218:219], v38 offset:57344
ds_read_b64_tr_b16 a[220:221], v39 offset:49152
v_mfma_f32_16x16x32_bf16 v[96:99], a[224:227], a[48:51], v[96:99]
ds_read_b64_tr_b16 a[222:223], v39 offset:57344
v_mfma_f32_16x16x32_bf16 v[104:107], a[224:227], a[52:55], v[104:107]
ds_read_b64_tr_b16 a[224:225], v32 offset:49408
ds_read_b64_tr_b16 a[226:227], v32 offset:57600
v_mfma_f32_16x16x32_bf16 v[100:103], a[228:231], a[48:51], v[100:103]
v_mfma_f32_16x16x32_bf16 v[108:111], a[228:231], a[52:55], v[108:111]
s_waitcnt lgkmcnt(5)
ds_read_b64_tr_b16 a[228:229], v33 offset:49408
ds_read_b64_tr_b16 a[230:231], v33 offset:57600
v_mfma_f32_16x16x32_bf16 v[96:99], a[232:235], a[56:59], v[96:99]
v_mfma_f32_16x16x32_bf16 v[104:107], a[232:235], a[60:63], v[104:107]
buffer_load_dwordx4 v19, s[12:15], s33 offen offset:3072 nt lds
v_mfma_f32_16x16x32_bf16 v[100:103], a[236:239], a[56:59], v[100:103]
s_add_u32 m0, s32, 131072
ds_read_b64_tr_b16 a[232:233], v34 offset:49408
ds_read_b64_tr_b16 a[234:235], v34 offset:57600
v_mfma_f32_16x16x32_bf16 v[108:111], a[236:239], a[60:63], v[108:111]
s_xor_b32 s33, s99, 81920
ds_read_b64_tr_b16 a[236:237], v35 offset:49408
ds_read_b64_tr_b16 a[238:239], v35 offset:57600
v_mfma_f32_16x16x32_bf16 v[64:67], a[176:179], v[88:91], v[64:67]
v_mfma_f32_16x16x32_bf16 v[68:71], a[176:179], v[92:95], v[68:71]
v_mfma_f32_16x16x32_bf16 v[128:131], a[192:195], v[88:91], v[128:131]
v_mfma_f32_16x16x32_bf16 v[136:139], a[192:195], v[92:95], v[136:139]
ds_read_b64_tr_b16 a[192:193], v36 offset:49408
v_fma_f32 v56, v96, s35, v72
v_mfma_f32_16x16x32_bf16 v[132:135], a[196:199], v[88:91], v[132:135]
ds_read_b64_tr_b16 a[194:195], v36 offset:57600
v_fma_f32 v57, v97, s35, v72
v_mfma_f32_16x16x32_bf16 v[140:143], a[196:199], v[92:95], v[140:143]
v_exp_f32 v56, v56
v_mfma_f32_16x16x32_bf16 v[144:147], a[200:203], v[88:91], v[144:147]
ds_read_b64_tr_b16 a[196:197], v37 offset:49408
v_fma_f32 v58, v98, s35, v72
v_mfma_f32_16x16x32_bf16 v[152:155], a[200:203], v[92:95], v[152:155]
v_exp_f32 v57, v57
v_mfma_f32_16x16x32_bf16 v[148:151], a[204:207], v[88:91], v[148:151]
ds_read_b64_tr_b16 a[198:199], v37 offset:57600
v_fma_f32 v59, v99, s35, v72
v_mfma_f32_16x16x32_bf16 v[156:159], a[204:207], v[92:95], v[156:159]
buffer_load_dwordx4 v16, s[16:19], s33 offen offset:0 nt lds
v_mfma_f32_16x16x32_bf16 v[160:163], a[208:211], v[88:91], v[160:163]
v_exp_f32 v58, v58
v_mfma_f32_16x16x32_bf16 v[168:171], a[208:211], v[92:95], v[168:171]
ds_read_b64_tr_b16 a[200:201], v38 offset:49408
v_fma_f32 v60, v100, s35, v72
v_mfma_f32_16x16x32_bf16 v[164:167], a[212:215], v[88:91], v[164:167]
v_exp_f32 v59, v59
v_mfma_f32_16x16x32_bf16 v[172:175], a[212:215], v[92:95], v[172:175]
s_waitcnt lgkmcnt(1)
ds_read_b64_tr_b16 a[202:203], v38 offset:57600
v_fma_f32 v61, v101, s35, v72
v_mfma_f32_16x16x32_bf16 v[176:179], a[216:219], v[88:91], v[176:179]
s_waitcnt vmcnt(25)
ds_read_b64_tr_b16 a[204:205], v39 offset:49408
v_cvt_pk_bf16_f32 v80, v56, v57
v_mfma_f32_16x16x32_bf16 v[184:187], a[216:219], v[92:95], v[184:187]
v_exp_f32 v60, v60
v_mfma_f32_16x16x32_bf16 v[180:183], a[220:223], v[88:91], v[180:183]
ds_read_b64_tr_b16 a[206:207], v39 offset:57600
v_fma_f32 v62, v102, s35, v72
v_mfma_f32_16x16x32_bf16 v[188:191], a[220:223], v[92:95], v[188:191]
s_barrier
v_exp_f32 v61, v61
v_mfma_f32_16x16x32_bf16 v[192:195], a[224:227], v[88:91], v[192:195]
ds_read_b128 a[208:211], v28 offset:16384
v_fma_f32 v63, v103, s35, v72
v_mfma_f32_16x16x32_bf16 v[200:203], a[224:227], v[92:95], v[200:203]
ds_read_b128 a[212:215], v28 offset:24576
v_cvt_pk_bf16_f32 v81, v58, v59
v_mfma_f32_16x16x32_bf16 v[196:199], a[228:231], v[88:91], v[196:199]
v_exp_f32 v62, v62
v_mfma_f32_16x16x32_bf16 v[204:207], a[228:231], v[92:95], v[204:207]
buffer_load_dwordx4 v17, s[16:19], s33 offen offset:1024 nt lds
v_mfma_f32_16x16x32_bf16 v[208:211], a[232:235], v[88:91], v[208:211]
ds_read_b128 a[216:219], v29 offset:16384
v_fma_f32 v56, v104, s35, v76
v_mfma_f32_16x16x32_bf16 v[216:219], a[232:235], v[92:95], v[216:219]
v_exp_f32 v63, v63
v_mfma_f32_16x16x32_bf16 v[212:215], a[236:239], v[88:91], v[212:215]
ds_read_b128 a[220:223], v29 offset:24576
v_fma_f32 v57, v105, s35, v76
v_mfma_f32_16x16x32_bf16 v[220:223], a[236:239], v[92:95], v[220:223]
ds_read_b128 a[224:227], v30 offset:16384
v_cvt_pk_bf16_f32 v82, v60, v61
v_mfma_f32_16x16x32_bf16 v[224:227], a[192:195], v[88:91], v[224:227]
v_exp_f32 v56, v56
v_mfma_f32_16x16x32_bf16 v[232:235], a[192:195], v[92:95], v[232:235]
ds_read_b128 a[228:231], v30 offset:24576
v_fma_f32 v58, v106, s35, v76
v_mfma_f32_16x16x32_bf16 v[228:231], a[196:199], v[88:91], v[228:231]
v_exp_f32 v57, v57
v_mfma_f32_16x16x32_bf16 v[236:239], a[196:199], v[92:95], v[236:239]
s_waitcnt lgkmcnt(2)
ds_read_b128 a[232:235], v31 offset:16384
v_fma_f32 v59, v107, s35, v76
v_mfma_f32_16x16x32_bf16 v[240:243], a[200:203], v[88:91], v[240:243]
ds_read_b128 a[236:239], v31 offset:24576
v_cvt_pk_bf16_f32 v83, v62, v63
v_mfma_f32_16x16x32_bf16 v[248:251], a[200:203], v[92:95], v[248:251]
v_exp_f32 v58, v58
v_mfma_f32_16x16x32_bf16 v[244:247], a[204:207], v[88:91], v[244:247]
ds_read_b128 a[192:195], v28 offset:16640
v_fma_f32 v60, v108, s35, v76
v_mfma_f32_16x16x32_bf16 v[252:255], a[204:207], v[92:95], v[252:255]
buffer_load_dwordx4 v18, s[16:19], s33 offen offset:2048 nt lds
v_mfma_f32_16x16x32_bf16 v[112:115], a[208:211], a[0:3], 0
v_exp_f32 v59, v59
v_mfma_f32_16x16x32_bf16 v[120:123], a[208:211], a[4:7], 0
ds_read_b128 a[196:199], v28 offset:24832
v_fma_f32 v61, v109, s35, v76
v_mfma_f32_16x16x32_bf16 v[116:119], a[212:215], a[0:3], 0
ds_read_b128 a[200:203], v29 offset:16640
v_cvt_pk_bf16_f32 v84, v56, v57
v_mfma_f32_16x16x32_bf16 v[124:127], a[212:215], a[4:7], 0
v_exp_f32 v60, v60
v_mfma_f32_16x16x32_bf16 v[112:115], a[216:219], a[8:11], v[112:115]
ds_read_b128 a[204:207], v29 offset:24832
v_fma_f32 v62, v110, s35, v76
v_mfma_f32_16x16x32_bf16 v[120:123], a[216:219], a[12:15], v[120:123]
v_exp_f32 v61, v61
v_mfma_f32_16x16x32_bf16 v[116:119], a[220:223], a[8:11], v[116:119]
ds_read_b128 a[208:211], v30 offset:16640
v_fma_f32 v63, v111, s35, v76
v_mfma_f32_16x16x32_bf16 v[124:127], a[220:223], a[12:15], v[124:127]
s_waitcnt lgkmcnt(2)
ds_read_b128 a[212:215], v30 offset:24832
v_cvt_pk_bf16_f32 v85, v58, v59
v_mfma_f32_16x16x32_bf16 v[112:115], a[224:227], a[16:19], v[112:115]
s_waitcnt vmcnt(23)
v_exp_f32 v62, v62
v_mfma_f32_16x16x32_bf16 v[120:123], a[224:227], a[20:23], v[120:123]
v_exp_f32 v63, v63
v_mfma_f32_16x16x32_bf16 v[116:119], a[228:231], a[16:19], v[116:119]
ds_read_b128 a[216:219], v31 offset:16640
v_cvt_pk_bf16_f32 v86, v60, v61
v_mfma_f32_16x16x32_bf16 v[124:127], a[228:231], a[20:23], v[124:127]
buffer_load_dwordx4 v19, s[16:19], s33 offen offset:3072 nt lds
v_mfma_f32_16x16x32_bf16 v[112:115], a[232:235], a[24:27], v[112:115]
s_add_u32 m0, s32, 65536
ds_read_b128 a[220:223], v31 offset:24832
v_cvt_pk_bf16_f32 v87, v62, v63
v_mfma_f32_16x16x32_bf16 v[120:123], a[232:235], a[28:31], v[120:123]
s_barrier
ds_read_b64_tr_b16 a[224:225], v32 offset:32768
v_or3_b32 v0, v80, v81, v82
v_mfma_f32_16x16x32_bf16 v[116:119], a[236:239], a[24:27], v[116:119]
LA_t20:
s_load_dword s98, s[96:97], 32104
ds_read_b64_tr_b16 a[226:227], v32 offset:40960
v_or3_b32 v1, v83, v84, v85
v_mfma_f32_16x16x32_bf16 v[124:127], a[236:239], a[28:31], v[124:127]
s_xor_b32 s33, s99, 114688
ds_read_b64_tr_b16 a[228:229], v33 offset:32768
v_or3_b32 v0, v0, v86, v87
v_mfma_f32_16x16x32_bf16 v[112:115], a[192:195], a[32:35], v[112:115]
ds_read_b64_tr_b16 a[230:231], v33 offset:40960
v_bitop3_b32 v0, v0, v1, s36 bitop3:0xa8
v_mfma_f32_16x16x32_bf16 v[120:123], a[192:195], a[36:39], v[120:123]
ds_read_b64_tr_b16 a[232:233], v34 offset:32768
v_cmp_ne_u32 vcc, 0, v0
v_mfma_f32_16x16x32_bf16 v[116:119], a[196:199], a[32:35], v[116:119]
s_cbranch_vccnz LA_stub2
LA_back2:
ds_read_b64_tr_b16 a[234:235], v34 offset:40960
ds_read_b64_tr_b16 a[236:237], v35 offset:32768
v_mfma_f32_16x16x32_bf16 v[124:127], a[196:199], a[36:39], v[124:127]
ds_read_b64_tr_b16 a[238:239], v35 offset:40960
ds_read_b64_tr_b16 a[192:193], v36 offset:32768
v_mfma_f32_16x16x32_bf16 v[112:115], a[200:203], a[40:43], v[112:115]
ds_read_b64_tr_b16 a[194:195], v36 offset:40960
ds_read_b64_tr_b16 a[196:197], v37 offset:32768
v_mfma_f32_16x16x32_bf16 v[120:123], a[200:203], a[44:47], v[120:123]
s_waitcnt lgkmcnt(7)
ds_read_b64_tr_b16 a[198:199], v37 offset:40960
ds_read_b64_tr_b16 a[200:201], v38 offset:32768
v_mfma_f32_16x16x32_bf16 v[116:119], a[204:207], a[40:43], v[116:119]
ds_read_b64_tr_b16 a[202:203], v38 offset:40960
v_mfma_f32_16x16x32_bf16 v[124:127], a[204:207], a[44:47], v[124:127]
buffer_load_dwordx4 v16, s[12:15], s33 offen offset:0 nt lds
v_mfma_f32_16x16x32_bf16 v[112:115], a[208:211], a[48:51], v[112:115]
ds_read_b64_tr_b16 a[204:205], v39 offset:32768
ds_read_b64_tr_b16 a[206:207], v39 offset:40960
v_mfma_f32_16x16x32_bf16 v[120:123], a[208:211], a[52:55], v[120:123]
ds_read_b64_tr_b16 a[208:209], v32 offset:33024
ds_read_b64_tr_b16 a[210:211], v32 offset:41216
v_mfma_f32_16x16x32_bf16 v[116:119], a[212:215], a[48:51], v[116:119]
v_mfma_f32_16x16x32_bf16 v[124:127], a[212:215], a[52:55], v[124:127]
ds_read_b64_tr_b16 a[212:213], v33 offset:33024
ds_read_b64_tr_b16 a[214:215], v33 offset:41216
v_mfma_f32_16x16x32_bf16 v[112:115], a[216:219], a[56:59], v[112:115]
v_mfma_f32_16x16x32_bf16 v[120:123], a[216:219], a[60:63], v[120:123]
ds_read_b64_tr_b16 a[216:217], v34 offset:33024
ds_read_b64_tr_b16 a[218:219], v34 offset:41216
v_mfma_f32_16x16x32_bf16 v[116:119], a[220:223], a[56:59], v[116:119]
v_mfma_f32_16x16x32_bf16 v[124:127], a[220:223], a[60:63], v[124:127]
ds_read_b64_tr_b16 a[220:221], v35 offset:33024
ds_read_b64_tr_b16 a[222:223], v35 offset:41216
v_mfma_f32_16x16x32_bf16 v[64:67], a[176:179], v[80:83], v[64:67]
v_mfma_f32_16x16x32_bf16 v[68:71], a[176:179], v[84:87], v[68:71]
v_mfma_f32_16x16x32_bf16 v[128:131], a[224:227], v[80:83], v[128:131]
v_mfma_f32_16x16x32_bf16 v[136:139], a[224:227], v[84:87], v[136:139]
buffer_load_dwordx4 v17, s[12:15], s33 offen offset:1024 nt lds
v_mfma_f32_16x16x32_bf16 v[132:135], a[228:231], v[80:83], v[132:135]
ds_read_b64_tr_b16 a[224:225], v36 offset:33024
v_fma_f32 v56, v112, s35, v72
v_mfma_f32_16x16x32_bf16 v[140:143], a[228:231], v[84:87], v[140:143]
s_waitcnt lgkmcnt(1)
ds_read_b64_tr_b16 a[226:227], v36 offset:41216
v_fma_f32 v57, v113, s35, v72
v_mfma_f32_16x16x32_bf16 v[144:147], a[232:235], v[80:83], v[144:147]
v_exp_f32 v56, v56
v_mfma_f32_16x16x32_bf16 v[152:155], a[232:235], v[84:87], v[152:155]
ds_read_b64_tr_b16 a[228:229], v37 offset:33024
v_fma_f32 v58, v114, s35, v72
v_mfma_f32_16x16x32_bf16 v[148:151], a[236:239], v[80:83], v[148:151]
v_exp_f32 v57, v57
v_mfma_f32_16x16x32_bf16 v[156:159], a[236:239], v[84:87], v[156:159]
ds_read_b64_tr_b16 a[230:231], v37 offset:41216
v_fma_f32 v59, v115, s35, v72
v_mfma_f32_16x16x32_bf16 v[160:163], a[192:195], v[80:83], v[160:163]
v_exp_f32 v58, v58
v_mfma_f32_16x16x32_bf16 v[168:171], a[192:195], v[84:87], v[168:171]
ds_read_b64_tr_b16 a[232:233], v38 offset:33024
v_fma_f32 v60, v116, s35, v72
v_mfma_f32_16x16x32_bf16 v[164:167], a[196:199], v[80:83], v[164:167]
v_exp_f32 v59, v59
v_mfma_f32_16x16x32_bf16 v[172:175], a[196:199], v[84:87], v[172:175]
ds_read_b64_tr_b16 a[234:235], v38 offset:41216
v_fma_f32 v61, v117, s35, v72
v_mfma_f32_16x16x32_bf16 v[176:179], a[200:203], v[80:83], v[176:179]
s_waitcnt vmcnt(22)
ds_read_b64_tr_b16 a[236:237], v39 offset:33024
v_cvt_pk_bf16_f32 v88, v56, v57
v_mfma_f32_16x16x32_bf16 v[184:187], a[200:203], v[84:87], v[184:187]
buffer_load_dwordx4 v18, s[12:15], s33 offen offset:2048 nt lds
v_mfma_f32_16x16x32_bf16 v[180:183], a[204:207], v[80:83], v[180:183]
v_exp_f32 v60, v60
v_mfma_f32_16x16x32_bf16 v[188:191], a[204:207], v[84:87], v[188:191]
ds_read_b64_tr_b16 a[238:239], v39 offset:41216
v_fma_f32 v62, v118, s35, v72
v_mfma_f32_16x16x32_bf16 v[192:195], a[208:211], v[80:83], v[192:195]
s_barrier
v_exp_f32 v61, v61
v_mfma_f32_16x16x32_bf16 v[200:203], a[208:211], v[84:87], v[200:203]
ds_read_b128 a[192:195], v20 offset:16384
v_fma_f32 v63, v119, s35, v72
v_mfma_f32_16x16x32_bf16 v[196:199], a[212:215], v[80:83], v[196:199]
ds_read_b128 a[196:199], v20 offset:24576
v_cvt_pk_bf16_f32 v89, v58, v59
v_mfma_f32_16x16x32_bf16 v[204:207], a[212:215], v[84:87], v[204:207]
v_exp_f32 v62, v62
v_mfma_f32_16x16x32_bf16 v[208:211], a[216:219], v[80:83], v[208:211]
ds_read_b128 a[200:203], v21 offset:16384
v_fma_f32 v56, v120, s35, v76
v_mfma_f32_16x16x32_bf16 v[216:219], a[216:219], v[84:87], v[216:219]
v_exp_f32 v63, v63
v_mfma_f32_16x16x32_bf16 v[212:215], a[220:223], v[80:83], v[212:215]
ds_read_b128 a[204:207], v21 offset:24576
v_fma_f32 v57, v121, s35, v76
v_mfma_f32_16x16x32_bf16 v[220:223], a[220:223], v[84:87], v[220:223]
s_waitcnt lgkmcnt(2)
ds_read_b128 a[208:211], v22 offset:16384
v_cvt_pk_bf16_f32 v90, v60, v61
v_mfma_f32_16x16x32_bf16 v[224:227], a[224:227], v[80:83], v[224:227]
v_exp_f32 v56, v56
v_mfma_f32_16x16x32_bf16 v[232:235], a[224:227], v[84:87], v[232:235]
buffer_load_dwordx4 v19, s[12:15], s33 offen offset:3072 nt lds
v_mfma_f32_16x16x32_bf16 v[228:231], a[228:231], v[80:83], v[228:231]
s_add_u32 m0, s32, 49152
ds_read_b128 a[212:215], v22 offset:24576
v_fma_f32 v58, v122, s35, v76
v_mfma_f32_16x16x32_bf16 v[236:239], a[228:231], v[84:87], v[236:239]
s_xor_b32 s33, s99, 98304
v_exp_f32 v57, v57
v_mfma_f32_16x16x32_bf16 v[240:243], a[232:235], v[80:83], v[240:243]
ds_read_b128 a[216:219], v23 offset:16384
v_fma_f32 v59, v123, s35, v76
v_mfma_f32_16x16x32_bf16 v[248:251], a[232:235], v[84:87], v[248:251]
ds_read_b128 a[220:223], v23 offset:24576
v_cvt_pk_bf16_f32 v91, v62, v63
v_mfma_f32_16x16x32_bf16 v[244:247], a[236:239], v[80:83], v[244:247]
v_exp_f32 v58, v58
v_mfma_f32_16x16x32_bf16 v[252:255], a[236:239], v[84:87], v[252:255]
ds_read_b128 a[224:227], v20 offset:16640
v_fma_f32 v60, v124, s35, v76
v_mfma_f32_16x16x32_bf16 v[96:99], a[192:195], a[0:3], 0
v_exp_f32 v59, v59
v_mfma_f32_16x16x32_bf16 v[104:107], a[192:195], a[4:7], 0
ds_read_b128 a[228:231], v20 offset:24832
v_fma_f32 v61, v125, s35, v76
v_mfma_f32_16x16x32_bf16 v[100:103], a[196:199], a[0:3], 0
ds_read_b128 a[232:235], v21 offset:16640
v_cvt_pk_bf16_f32 v92, v56, v57
v_mfma_f32_16x16x32_bf16 v[108:111], a[196:199], a[4:7], 0
s_waitcnt lgkmcnt(3)
v_exp_f32 v60, v60
v_mfma_f32_16x16x32_bf16 v[96:99], a[200:203], a[8:11], v[96:99]
ds_read_b128 a[236:239], v21 offset:24832
v_fma_f32 v62, v126, s35, v76
v_mfma_f32_16x16x32_bf16 v[104:107], a[200:203], a[12:15], v[104:107]
buffer_load_dwordx4 v16, s[16:19], s33 offen offset:0 nt lds
v_mfma_f32_16x16x32_bf16 v[100:103], a[204:207], a[8:11], v[100:103]
v_exp_f32 v61, v61
v_mfma_f32_16x16x32_bf16 v[108:111], a[204:207], a[12:15], v[108:111]
ds_read_b128 a[192:195], v22 offset:16640
v_fma_f32 v63, v127, s35, v76
v_mfma_f32_16x16x32_bf16 v[96:99], a[208:211], a[16:19], v[96:99]
ds_read_b128 a[196:199], v22 offset:24832
v_cvt_pk_bf16_f32 v93, v58, v59
v_mfma_f32_16x16x32_bf16 v[104:107], a[208:211], a[20:23], v[104:107]
s_waitcnt vmcnt(21)
v_exp_f32 v62, v62
v_mfma_f32_16x16x32_bf16 v[100:103], a[212:215], a[16:19], v[100:103]
v_exp_f32 v63, v63
v_mfma_f32_16x16x32_bf16 v[108:111], a[212:215], a[20:23], v[108:111]
ds_read_b128 a[200:203], v23 offset:16640
v_cvt_pk_bf16_f32 v94, v60, v61
v_mfma_f32_16x16x32_bf16 v[96:99], a[216:219], a[24:27], v[96:99]
ds_read_b128 a[204:207], v23 offset:24832
v_cvt_pk_bf16_f32 v95, v62, v63
v_mfma_f32_16x16x32_bf16 v[104:107], a[216:219], a[28:31], v[104:107]
s_barrier
ds_read_b64_tr_b16 a[208:209], v40 offset:32768
v_or3_b32 v0, v88, v89, v90
v_mfma_f32_16x16x32_bf16 v[100:103], a[220:223], a[24:27], v[100:103]
LA_t22:
s_load_dword s98, s[96:97], 33416
ds_read_b64_tr_b16 a[210:211], v40 offset:40960
v_or3_b32 v1, v91, v92, v93
v_mfma_f32_16x16x32_bf16 v[108:111], a[220:223], a[28:31], v[108:111]
s_waitcnt lgkmcnt(4)
ds_read_b64_tr_b16 a[212:213], v41 offset:32768
v_or3_b32 v0, v0, v94, v95
v_mfma_f32_16x16x32_bf16 v[96:99], a[224:227], a[32:35], v[96:99]
ds_read_b64_tr_b16 a[214:215], v41 offset:40960
v_bitop3_b32 v0, v0, v1, s36 bitop3:0xa8
v_mfma_f32_16x16x32_bf16 v[104:107], a[224:227], a[36:39], v[104:107]
buffer_load_dwordx4 v17, s[16:19], s33 offen offset:1024 nt lds
v_mfma_f32_16x16x32_bf16 v[100:103], a[228:231], a[32:35], v[100:103]
ds_read_b64_tr_b16 a[216:217], v42 offset:32768
v_cmp_ne_u32 vcc, 0, v0
v_mfma_f32_16x16x32_bf16 v[108:111], a[228:231], a[36:39], v[108:111]
s_cbranch_vccnz LA_stub3
LA_back3:
ds_read_b64_tr_b16 a[218:219], v42 offset:40960
ds_read_b64_tr_b16 a[220:221], v43 offset:32768
v_mfma_f32_16x16x32_bf16 v[96:99], a[232:235], a[40:43], v[96:99]
ds_read_b64_tr_b16 a[222:223], v43 offset:40960
ds_read_b64_tr_b16 a[224:225], v44 offset:32768
v_mfma_f32_16x16x32_bf16 v[104:107], a[232:235], a[44:47], v[104:107]
ds_read_b64_tr_b16 a[226:227], v44 offset:40960
ds_read_b64_tr_b16 a[228:229], v45 offset:32768
v_mfma_f32_16x16x32_bf16 v[100:103], a[236:239], a[40:43], v[100:103]
ds_read_b64_tr_b16 a[230:231], v45 offset:40960
ds_read_b64_tr_b16 a[232:233], v46 offset:32768
v_mfma_f32_16x16x32_bf16 v[108:111], a[236:239], a[44:47], v[108:111]
ds_read_b64_tr_b16 a[234:235], v46 offset:40960
ds_read_b64_tr_b16 a[236:237], v47 offset:32768
v_mfma_f32_16x16x32_bf16 v[96:99], a[192:195], a[48:51], v[96:99]
ds_read_b64_tr_b16 a[238:239], v47 offset:40960
v_mfma_f32_16x16x32_bf16 v[104:107], a[192:195], a[52:55], v[104:107]
ds_read_b64_tr_b16 a[192:193], v40 offset:33024
ds_read_b64_tr_b16 a[194:195], v40 offset:41216
v_mfma_f32_16x16x32_bf16 v[100:103], a[196:199], a[48:51], v[100:103]
v_mfma_f32_16x16x32_bf16 v[108:111], a[196:199], a[52:55], v[108:111]
s_waitcnt lgkmcnt(5)
ds_read_b64_tr_b16 a[196:197], v41 offset:33024
ds_read_b64_tr_b16 a[198:199], v41 offset:41216
v_mfma_f32_16x16x32_bf16 v[96:99], a[200:203], a[56:59], v[96:99]
buffer_load_dwordx4 v18, s[16:19], s33 offen offset:2048 nt lds
v_mfma_f32_16x16x32_bf16 v[104:107], a[200:203], a[60:63], v[104:107]
ds_read_b64_tr_b16 a[200:201], v42 offset:33024
ds_read_b64_tr_b16 a[202:203], v42 offset:41216
v_mfma_f32_16x16x32_bf16 v[100:103], a[204:207], a[56:59], v[100:103]
v_mfma_f32_16x16x32_bf16 v[108:111], a[204:207], a[60:63], v[108:111]
ds_read_b64_tr_b16 a[204:205], v43 offset:33024
ds_read_b64_tr_b16 a[206:207], v43 offset:41216
v_mfma_f32_16x16x32_bf16 v[64:67], a[176:179], v[88:91], v[64:67]
v_mfma_f32_16x16x32_bf16 v[68:71], a[176:179], v[92:95], v[68:71]
v_mfma_f32_16x16x32_bf16 v[128:131], a[208:211], v[88:91], v[128:131]
v_mfma_f32_16x16x32_bf16 v[136:139], a[208:211], v[92:95], v[136:139]
ds_read_b64_tr_b16 a[208:209], v44 offset:33024
v_fma_f32 v56, v96, s35, v72
v_mfma_f32_16x16x32_bf16 v[132:135], a[212:215], v[88:91], v[132:135]
ds_read_b64_tr_b16 a[210:211], v44 offset:41216
v_fma_f32 v57, v97, s35, v72
v_mfma_f32_16x16x32_bf16 v[140:143], a[212:215], v[92:95], v[140:143]
v_exp_f32 v56, v56
v_mfma_f32_16x16x32_bf16 v[144:147], a[216:219], v[88:91], v[144:147]
ds_read_b64_tr_b16 a[212:213], v45 offset:33024
v_fma_f32 v58, v98, s35, v72
v_mfma_f32_16x16x32_bf16 v[152:155], a[216:219], v[92:95], v[152:155]
buffer_load_dwordx4 v19, s[16:19], s33 offen offset:3072 nt lds
v_mfma_f32_16x16x32_bf16 v[148:151], a[220:223], v[88:91], v[148:151]
s_add_u32 m0, s32, 147456
v_exp_f32 v57, v57
v_mfma_f32_16x16x32_bf16 v[156:159], a[220:223], v[92:95], v[156:159]
s_xor_b32 s33, s99, 131072
ds_read_b64_tr_b16 a[214:215], v45 offset:41216
v_fma_f32 v59, v99, s35, v72
v_mfma_f32_16x16x32_bf16 v[160:163], a[224:227], v[88:91], v[160:163]
v_exp_f32 v58, v58
v_mfma_f32_16x16x32_bf16 v[168:171], a[224:227], v[92:95], v[168:171]
ds_read_b64_tr_b16 a[216:217], v46 offset:33024
v_fma_f32 v60, v100, s35, v72
v_mfma_f32_16x16x32_bf16 v[164:167], a[228:231], v[88:91], v[164:167]
v_exp_f32 v59, v59
v_mfma_f32_16x16x32_bf16 v[172:175], a[228:231], v[92:95], v[172:175]
s_waitcnt lgkmcnt(2)
ds_read_b64_tr_b16 a[218:219], v46 offset:41216
v_fma_f32 v61, v101, s35, v72
v_mfma_f32_16x16x32_bf16 v[176:179], a[232:235], v[88:91], v[176:179]
s_waitcnt vmcnt(20)
ds_read_b64_tr_b16 a[220:221], v47 offset:33024
v_cvt_pk_bf16_f32 v80, v56, v57
v_mfma_f32_16x16x32_bf16 v[184:187], a[232:235], v[92:95], v[184:187]
v_exp_f32 v60, v60
v_mfma_f32_16x16x32_bf16 v[180:183], a[236:239], v[88:91], v[180:183]
ds_read_b64_tr_b16 a[222:223], v47 offset:41216
v_fma_f32 v62, v102, s35, v72
v_mfma_f32_16x16x32_bf16 v[188:191], a[236:239], v[92:95], v[188:191]
s_barrier
v_exp_f32 v61, v61
v_mfma_f32_16x16x32_bf16 v[192:195], a[192:195], v[88:91], v[192:195]
buffer_load_dwordx4 v16, s[12:15], s33 offen offset:0 nt lds
v_mfma_f32_16x16x32_bf16 v[200:203], a[192:195], v[92:95], v[200:203]
ds_read_b128 a[224:227], v20 offset:0
v_fma_f32 v63, v103, s35, v72
v_mfma_f32_16x16x32_bf16 v[196:199], a[196:199], v[88:91], v[196:199]
ds_read_b128 a[228:231], v20 offset:8192
v_cvt_pk_bf16_f32 v81, v58, v59
v_mfma_f32_16x16x32_bf16 v[204:207], a[196:199], v[92:95], v[204:207]
v_exp_f32 v62, v62
v_mfma_f32_16x16x32_bf16 v[208:211], a[200:203], v[88:91], v[208:211]
ds_read_b128 a[232:235], v21 offset:0
v_fma_f32 v56, v104, s35, v76
v_mfma_f32_16x16x32_bf16 v[216:219], a[200:203], v[92:95], v[216:219]
v_exp_f32 v63, v63
v_mfma_f32_16x16x32_bf16 v[212:215], a[204:207], v[88:91], v[212:215]
ds_read_b128 a[236:239], v21 offset:8192
v_fma_f32 v57, v105, s35, v76
v_mfma_f32_16x16x32_bf16 v[220:223], a[204:207], v[92:95], v[220:223]
ds_read_b128 a[192:195], v22 offset:0
v_cvt_pk_bf16_f32 v82, v60, v61
v_mfma_f32_16x16x32_bf16 v[224:227], a[208:211], v[88:91], v[224:227]
v_exp_f32 v56, v56
v_mfma_f32_16x16x32_bf16 v[232:235], a[208:211], v[92:95], v[232:235]
s_waitcnt lgkmcnt(2)
ds_read_b128 a[196:199], v22 offset:8192
v_fma_f32 v58, v106, s35, v76
v_mfma_f32_16x16x32_bf16 v[228:231], a[212:215], v[88:91], v[228:231]
v_exp_f32 v57, v57
v_mfma_f32_16x16x32_bf16 v[236:239], a[212:215], v[92:95], v[236:239]
buffer_load_dwordx4 v17, s[12:15], s33 offen offset:1024 nt lds
v_mfma_f32_16x16x32_bf16 v[240:243], a[216:219], v[88:91], v[240:243]
ds_read_b128 a[200:203], v23 offset:0
v_fma_f32 v59, v107, s35, v76
v_mfma_f32_16x16x32_bf16 v[248:251], a[216:219], v[92:95], v[248:251]
ds_read_b128 a[204:207], v23 offset:8192
v_cvt_pk_bf16_f32 v83, v62, v63
v_mfma_f32_16x16x32_bf16 v[244:247], a[220:223], v[88:91], v[244:247]
v_exp_f32 v58, v58
v_mfma_f32_16x16x32_bf16 v[252:255], a[220:223], v[92:95], v[252:255]
ds_read_b128 a[208:211], v20 offset:256
v_fma_f32 v60, v108, s35, v76
v_mfma_f32_16x16x32_bf16 v[112:115], a[224:227], a[0:3], 0
v_exp_f32 v59, v59
v_mfma_f32_16x16x32_bf16 v[120:123], a[224:227], a[4:7], 0
ds_read_b128 a[212:215], v20 offset:8448
v_fma_f32 v61, v109, s35, v76
v_mfma_f32_16x16x32_bf16 v[116:119], a[228:231], a[0:3], 0
ds_read_b128 a[216:219], v21 offset:256
v_cvt_pk_bf16_f32 v84, v56, v57
v_mfma_f32_16x16x32_bf16 v[124:127], a[228:231], a[4:7], 0
v_exp_f32 v60, v60
v_mfma_f32_16x16x32_bf16 v[112:115], a[232:235], a[8:11], v[112:115]
ds_read_b128 a[220:223], v21 offset:8448
v_fma_f32 v62, v110, s35, v76
v_mfma_f32_16x16x32_bf16 v[120:123], a[232:235], a[12:15], v[120:123]
s_waitcnt lgkmcnt(3)
v_exp_f32 v61, v61
v_mfma_f32_16x16x32_bf16 v[116:119], a[236:239], a[8:11], v[116:119]
buffer_load_dwordx4 v18, s[12:15], s33 offen offset:2048 nt lds
v_mfma_f32_16x16x32_bf16 v[124:127], a[236:239], a[12:15], v[124:127]
ds_read_b128 a[224:227], v22 offset:256
v_fma_f32 v63, v111, s35, v76
v_mfma_f32_16x16x32_bf16 v[112:115], a[192:195], a[16:19], v[112:115]
ds_read_b128 a[228:231], v22 offset:8448
v_cvt_pk_bf16_f32 v85, v58, v59
v_mfma_f32_16x16x32_bf16 v[120:123], a[192:195], a[20:23], v[120:123]
s_waitcnt vmcnt(19)
v_exp_f32 v62, v62
v_mfma_f32_16x16x32_bf16 v[116:119], a[196:199], a[16:19], v[116:119]
v_exp_f32 v63, v63
v_mfma_f32_16x16x32_bf16 v[124:127], a[196:199], a[20:23], v[124:127]
ds_read_b128 a[232:235], v23 offset:256
v_cvt_pk_bf16_f32 v86, v60, v61
v_mfma_f32_16x16x32_bf16 v[112:115], a[200:203], a[24:27], v[112:115]
ds_read_b128 a[236:239], v23 offset:8448
v_cvt_pk_bf16_f32 v87, v62, v63
v_mfma_f32_16x16x32_bf16 v[120:123], a[200:203], a[28:31], v[120:123]
s_barrier
ds_read_b64_tr_b16 a[192:193], v40 offset:16384
v_or3_b32 v0, v80, v81, v82
v_mfma_f32_16x16x32_bf16 v[116:119], a[204:207], a[24:27], v[116:119]
LA_t24:
s_load_dword s98, s[96:97], 34732
ds_read_b64_tr_b16 a[194:195], v40 offset:24576
v_or3_b32 v1, v83, v84, v85
v_mfma_f32_16x16x32_bf16 v[124:127], a[204:207], a[28:31], v[124:127]
ds_read_b64_tr_b16 a[196:197], v41 offset:16384
v_or3_b32 v0, v0, v86, v87
v_mfma_f32_16x16x32_bf16 v[112:115], a[208:211], a[32:35], v[112:115]
ds_read_b64_tr_b16 a[198:199], v41 offset:24576
v_bitop3_b32 v0, v0, v1, s36 bitop3:0xa8
v_mfma_f32_16x16x32_bf16 v[120:123], a[208:211], a[36:39], v[120:123]
s_waitcnt lgkmcnt(4)
buffer_load_dwordx4 v19, s[12:15], s33 offen offset:3072 nt lds
v_mfma_f32_16x16x32_bf16 v[116:119], a[212:215], a[32:35], v[116:119]
s_add_u32 m0, s32, 32768
ds_read_b64_tr_b16 a[200:201], v42 offset:16384
v_cmp_ne_u32 vcc, 0, v0
v_mfma_f32_16x16x32_bf16 v[124:127], a[212:215], a[36:39], v[124:127]
s_xor_b32 s33, s99, 114688
ds_read_b64_tr_b16 a[202:203], v42 offset:24576
ds_read_b64_tr_b16 a[204:205], v43 offset:16384
v_mfma_f32_16x16x32_bf16 v[112:115], a[216:219], a[40:43], v[112:115]
s_cbranch_vccnz LA_stub4
LA_back4:
ds_read_b64_tr_b16 a[206:207], v43 offset:24576
ds_read_b64_tr_b16 a[208:209], v44 offset:16384
v_mfma_f32_16x16x32_bf16 v[120:123], a[216:219], a[44:47], v[120:123]
ds_read_b64_tr_b16 a[210:211], v44 offset:24576
ds_read_b64_tr_b16 a[212:213], v45 offset:16384
v_mfma_f32_16x16x32_bf16 v[116:119], a[220:223], a[40:43], v[116:119]
ds_read_b64_tr_b16 a[214:215], v45 offset:24576
ds_read_b64_tr_b16 a[216:217], v46 offset:16384
v_mfma_f32_16x16x32_bf16 v[124:127], a[220:223], a[44:47], v[124:127]
ds_read_b64_tr_b16 a[218:219], v46 offset:24576
ds_read_b64_tr_b16 a[220:221], v47 offset:16384
v_mfma_f32_16x16x32_bf16 v[112:115], a[224:227], a[48:51], v[112:115]
ds_read_b64_tr_b16 a[222:223], v47 offset:24576
v_mfma_f32_16x16x32_bf16 v[120:123], a[224:227], a[52:55], v[120:123]
ds_read_b64_tr_b16 a[224:225], v40 offset:16640
ds_read_b64_tr_b16 a[226:227], v40 offset:24832
v_mfma_f32_16x16x32_bf16 v[116:119], a[228:231], a[48:51], v[116:119]
v_mfma_f32_16x16x32_bf16 v[124:127], a[228:231], a[52:55], v[124:127]
ds_read_b64_tr_b16 a[228:229], v41 offset:16640
ds_read_b64_tr_b16 a[230:231], v41 offset:24832
v_mfma_f32_16x16x32_bf16 v[112:115], a[232:235], a[56:59], v[112:115]
buffer_load_dwordx4 v16, s[16:19], s33 offen offset:0 nt lds
v_mfma_f32_16x16x32_bf16 v[120:123], a[232:235], a[60:63], v[120:123]
ds_read_b64_tr_b16 a[232:233], v42 offset:16640
ds_read_b64_tr_b16 a[234:235], v42 offset:24832
v_mfma_f32_16x16x32_bf16 v[116:119], a[236:239], a[56:59], v[116:119]
v_mfma_f32_16x16x32_bf16 v[124:127], a[236:239], a[60:63], v[124:127]
ds_read_b64_tr_b16 a[236:237], v43 offset:16640
ds_read_b64_tr_b16 a[238:239], v43 offset:24832
v_mfma_f32_16x16x32_bf16 v[64:67], a[176:179], v[80:83], v[64:67]
v_mfma_f32_16x16x32_bf16 v[68:71], a[176:179], v[84:87], v[68:71]
s_waitcnt lgkmcnt(4)
v_mfma_f32_16x16x32_bf16 v[128:131], a[192:195], v[80:83], v[128:131]
v_mfma_f32_16x16x32_bf16 v[136:139], a[192:195], v[84:87], v[136:139]
ds_read_b64_tr_b16 a[192:193], v44 offset:16640
v_fma_f32 v56, v112, s35, v72
v_mfma_f32_16x16x32_bf16 v[132:135], a[196:199], v[80:83], v[132:135]
ds_read_b64_tr_b16 a[194:195], v44 offset:24832
v_fma_f32 v57, v113, s35, v72
v_mfma_f32_16x16x32_bf16 v[140:143], a[196:199], v[84:87], v[140:143]
v_exp_f32 v56, v56
v_mfma_f32_16x16x32_bf16 v[144:147], a[200:203], v[80:83], v[144:147]
ds_read_b64_tr_b16 a[196:197], v45 offset:16640
v_fma_f32 v58, v114, s35, v72
v_mfma_f32_16x16x32_bf16 v[152:155], a[200:203], v[84:87], v[152:155]
buffer_load_dwordx4 v17, s[16:19], s33 offen offset:1024 nt lds
v_mfma_f32_16x16x32_bf16 v[148:151], a[204:207], v[80:83], v[148:151]
v_exp_f32 v57, v57
v_mfma_f32_16x16x32_bf16 v[156:159], a[204:207], v[84:87], v[156:159]
ds_read_b64_tr_b16 a[198:199], v45 offset:24832
v_fma_f32 v59, v115, s35, v72
v_mfma_f32_16x16x32_bf16 v[160:163], a[208:211], v[80:83], v[160:163]
v_exp_f32 v58, v58
v_mfma_f32_16x16x32_bf16 v[168:171], a[208:211], v[84:87], v[168:171]
ds_read_b64_tr_b16 a[200:201], v46 offset:16640
v_fma_f32 v60, v116, s35, v72
v_mfma_f32_16x16x32_bf16 v[164:167], a[212:215], v[80:83], v[164:167]
v_exp_f32 v59, v59
v_mfma_f32_16x16x32_bf16 v[172:175], a[212:215], v[84:87], v[172:175]
ds_read_b64_tr_b16 a[202:203], v46 offset:24832
v_fma_f32 v61, v117, s35, v72
v_mfma_f32_16x16x32_bf16 v[176:179], a[216:219], v[80:83], v[176:179]
s_waitcnt vmcnt(18)
ds_read_b64_tr_b16 a[204:205], v47 offset:16640
v_cvt_pk_bf16_f32 v88, v56, v57
v_mfma_f32_16x16x32_bf16 v[184:187], a[216:219], v[84:87], v[184:187]
v_exp_f32 v60, v60
v_mfma_f32_16x16x32_bf16 v[180:183], a[220:223], v[80:83], v[180:183]
ds_read_b64_tr_b16 a[206:207], v47 offset:24832
v_fma_f32 v62, v118, s35, v72
v_mfma_f32_16x16x32_bf16 v[188:191], a[220:223], v[84:87], v[188:191]
s_barrier
v_exp_f32 v61, v61
v_mfma_f32_16x16x32_bf16 v[192:195], a[224:227], v[80:83], v[192:195]
buffer_load_dwordx4 v18, s[16:19], s33 offen offset:2048 nt lds
v_mfma_f32_16x16x32_bf16 v[200:203], a[224:227], v[84:87], v[200:203]
ds_read_b128 a[208:211], v24 offset:49152
v_fma_f32 v63, v119, s35, v72
v_mfma_f32_16x16x32_bf16 v[196:199], a[228:231], v[80:83], v[196:199]
ds_read_b128 a[212:215], v24 offset:57344
v_cvt_pk_bf16_f32 v89, v58, v59
v_mfma_f32_16x16x32_bf16 v[204:207], a[228:231], v[84:87], v[204:207]
s_waitcnt lgkmcnt(2)
v_exp_f32 v62, v62
v_mfma_f32_16x16x32_bf16 v[208:211], a[232:235], v[80:83], v[208:211]
ds_read_b128 a[216:219], v25 offset:49152
v_fma_f32 v56, v120, s35, v76
v_mfma_f32_16x16x32_bf16 v[216:219], a[232:235], v[84:87], v[216:219]
v_exp_f32 v63, v63
v_mfma_f32_16x16x32_bf16 v[212:215], a[236:239], v[80:83], v[212:215]
ds_read_b128 a[220:223], v25 offset:57344
v_fma_f32 v57, v121, s35, v76
v_mfma_f32_16x16x32_bf16 v[220:223], a[236:239], v[84:87], v[220:223]
ds_read_b128 a[224:227], v26 offset:49152
v_cvt_pk_bf16_f32 v90, v60, v61
v_mfma_f32_16x16x32_bf16 v[224:227], a[192:195], v[80:83], v[224:227]
v_exp_f32 v56, v56
v_mfma_f32_16x16x32_bf16 v[232:235], a[192:195], v[84:87], v[232:235]
ds_read_b128 a[228:231], v26 offset:57344
v_fma_f32 v58, v122, s35, v76
v_mfma_f32_16x16x32_bf16 v[228:231], a[196:199], v[80:83], v[228:231]
v_exp_f32 v57, v57
v_mfma_f32_16x16x32_bf16 v[236:239], a[196:199], v[84:87], v[236:239]
buffer_load_dwordx4 v19, s[16:19], s33 offen offset:3072 nt lds
v_mfma_f32_16x16x32_bf16 v[240:243], a[200:203], v[80:83], v[240:243]
s_add_u32 m0, s32, 16384
ds_read_b128 a[232:235], v27 offset:49152
v_fma_f32 v59, v123, s35, v76
v_mfma_f32_16x16x32_bf16 v[248:251], a[200:203], v[84:87], v[248:251]
s_xor_b32 s33, s99, 147456
ds_read_b128 a[236:239], v27 offset:57344
v_cvt_pk_bf16_f32 v91, v62, v63
v_mfma_f32_16x16x32_bf16 v[244:247], a[204:207], v[80:83], v[244:247]
v_exp_f32 v58, v58
v_mfma_f32_16x16x32_bf16 v[252:255], a[204:207], v[84:87], v[252:255]
s_waitcnt lgkmcnt(2)
ds_read_b128 a[192:195], v24 offset:49408
v_fma_f32 v60, v124, s35, v76
v_mfma_f32_16x16x32_bf16 v[96:99], a[208:211], a[0:3], 0
v_exp_f32 v59, v59
v_mfma_f32_16x16x32_bf16 v[104:107], a[208:211], a[4:7], 0
ds_read_b128 a[196:199], v24 offset:57600
v_fma_f32 v61, v125, s35, v76
v_mfma_f32_16x16x32_bf16 v[100:103], a[212:215], a[0:3], 0
ds_read_b128 a[200:203], v25 offset:49408
v_cvt_pk_bf16_f32 v92, v56, v57
v_mfma_f32_16x16x32_bf16 v[108:111], a[212:215], a[4:7], 0
v_exp_f32 v60, v60
v_mfma_f32_16x16x32_bf16 v[96:99], a[216:219], a[8:11], v[96:99]
ds_read_b128 a[204:207], v25 offset:57600
v_fma_f32 v62, v126, s35, v76
v_mfma_f32_16x16x32_bf16 v[104:107], a[216:219], a[12:15], v[104:107]
v_exp_f32 v61, v61
v_mfma_f32_16x16x32_bf16 v[100:103], a[220:223], a[8:11], v[100:103]
buffer_load_dwordx4 v16, s[12:15], s33 offen offset:0 nt lds
v_mfma_f32_16x16x32_bf16 v[108:111], a[220:223], a[12:15], v[108:111]
ds_read_b128 a[208:211], v26 offset:49408
v_fma_f32 v63, v127, s35, v76
v_mfma_f32_16x16x32_bf16 v[96:99], a[224:227], a[16:19], v[96:99]
ds_read_b128 a[212:215], v26 offset:57600
v_cvt_pk_bf16_f32 v93, v58, v59
v_mfma_f32_16x16x32_bf16 v[104:107], a[224:227], a[20:23], v[104:107]
s_waitcnt vmcnt(17)
v_exp_f32 v62, v62
v_mfma_f32_16x16x32_bf16 v[100:103], a[228:231], a[16:19], v[100:103]
v_exp_f32 v63, v63
v_mfma_f32_16x16x32_bf16 v[108:111], a[228:231], a[20:23], v[108:111]
s_waitcnt lgkmcnt(2)
ds_read_b128 a[216:219], v27 offset:49408
v_cvt_pk_bf16_f32 v94, v60, v61
v_mfma_f32_16x16x32_bf16 v[96:99], a[232:235], a[24:27], v[96:99]
ds_read_b128 a[220:223], v27 offset:57600
v_cvt_pk_bf16_f32 v95, v62, v63
v_mfma_f32_16x16x32_bf16 v[104:107], a[232:235], a[28:31], v[104:107]
s_barrier
ds_read_b64_tr_b16 a[224:225], v48 offset:0
v_or3_b32 v0, v88, v89, v90
v_mfma_f32_16x16x32_bf16 v[100:103], a[236:239], a[24:27], v[100:103]
LA_t26:
s_load_dword s98, s[96:97], 36064
ds_read_b64_tr_b16 a[226:227], v48 offset:8192
v_or3_b32 v1, v91, v92, v93
v_mfma_f32_16x16x32_bf16 v[108:111], a[236:239], a[28:31], v[108:111]
ds_read_b64_tr_b16 a[228:229], v49 offset:0
v_or3_b32 v0, v0, v94, v95
v_mfma_f32_16x16x32_bf16 v[96:99], a[192:195], a[32:35], v[96:99]
ds_read_b64_tr_b16 a[230:231], v49 offset:8192
v_bitop3_b32 v0, v0, v1, s36 bitop3:0xa8
v_mfma_f32_16x16x32_bf16 v[104:107], a[192:195], a[36:39], v[104:107]
buffer_load_dwordx4 v17, s[12:15], s33 offen offset:1024 nt lds
v_mfma_f32_16x16x32_bf16 v[100:103], a[196:199], a[32:35], v[100:103]
ds_read_b64_tr_b16 a[232:233], v50 offset:0
v_cmp_ne_u32 vcc, 0, v0
v_mfma_f32_16x16x32_bf16 v[108:111], a[196:199], a[36:39], v[108:111]
s_cbranch_vccnz LA_stub5
LA_back5:
ds_read_b64_tr_b16 a[234:235], v50 offset:8192
ds_read_b64_tr_b16 a[236:237], v51 offset:0
v_mfma_f32_16x16x32_bf16 v[96:99], a[200:203], a[40:43], v[96:99]
ds_read_b64_tr_b16 a[238:239], v51 offset:8192
ds_read_b64_tr_b16 a[192:193], v52 offset:0
v_mfma_f32_16x16x32_bf16 v[104:107], a[200:203], a[44:47], v[104:107]
ds_read_b64_tr_b16 a[194:195], v52 offset:8192
ds_read_b64_tr_b16 a[196:197], v53 offset:0
v_mfma_f32_16x16x32_bf16 v[100:103], a[204:207], a[40:43], v[100:103]
ds_read_b64_tr_b16 a[198:199], v53 offset:8192
ds_read_b64_tr_b16 a[200:201], v54 offset:0
v_mfma_f32_16x16x32_bf16 v[108:111], a[204:207], a[44:47], v[108:111]
s_waitcnt lgkmcnt(8)
ds_read_b64_tr_b16 a[202:203], v54 offset:8192
ds_read_b64_tr_b16 a[204:205], v55 offset:0
v_mfma_f32_16x16x32_bf16 v[96:99], a[208:211], a[48:51], v[96:99]
ds_read_b64_tr_b16 a[206:207], v55 offset:8192
v_mfma_f32_16x16x32_bf16 v[104:107], a[208:211], a[52:55], v[104:107]
ds_read_b64_tr_b16 a[208:209], v48 offset:256
ds_read_b64_tr_b16 a[210:211], v48 offset:8448
v_mfma_f32_16x16x32_bf16 v[100:103], a[212:215], a[48:51], v[100:103]
v_mfma_f32_16x16x32_bf16 v[108:111], a[212:215], a[52:55], v[108:111]
ds_read_b64_tr_b16 a[212:213], v49 offset:256
ds_read_b64_tr_b16 a[214:215], v49 offset:8448
v_mfma_f32_16x16x32_bf16 v[96:99], a[216:219], a[56:59], v[96:99]
buffer_load_dwordx4 v18, s[12:15], s33 offen offset:2048 nt lds
v_mfma_f32_16x16x32_bf16 v[104:107], a[216:219], a[60:63], v[104:107]
ds_read_b64_tr_b16 a[216:217], v50 offset:256
ds_read_b64_tr_b16 a[218:219], v50 offset:8448
v_mfma_f32_16x16x32_bf16 v[100:103], a[220:223], a[56:59], v[100:103]
v_mfma_f32_16x16x32_bf16 v[108:111], a[220:223], a[60:63], v[108:111]
ds_read_b64_tr_b16 a[220:221], v51 offset:256
ds_read_b64_tr_b16 a[222:223], v51 offset:8448
v_mfma_f32_16x16x32_bf16 v[64:67], a[176:179], v[88:91], v[64:67]
v_mfma_f32_16x16x32_bf16 v[68:71], a[176:179], v[92:95], v[68:71]
v_mfma_f32_16x16x32_bf16 v[128:131], a[224:227], v[88:91], v[128:131]
v_mfma_f32_16x16x32_bf16 v[136:139], a[224:227], v[92:95], v[136:139]
ds_read_b64_tr_b16 a[224:225], v52 offset:256
v_fma_f32 v56, v96, s35, v72
v_mfma_f32_16x16x32_bf16 v[132:135], a[228:231], v[88:91], v[132:135]
ds_read_b64_tr_b16 a[226:227], v52 offset:8448
v_fma_f32 v57, v97, s35, v72
v_mfma_f32_16x16x32_bf16 v[140:143], a[228:231], v[92:95], v[140:143]
s_waitcnt lgkmcnt(2)
v_exp_f32 v56, v56
v_mfma_f32_16x16x32_bf16 v[144:147], a[232:235], v[88:91], v[144:147]
ds_read_b64_tr_b16 a[228:229], v53 offset:256
v_fma_f32 v58, v98, s35, v72
v_mfma_f32_16x16x32_bf16 v[152:155], a[232:235], v[92:95], v[152:155]
buffer_load_dwordx4 v19, s[12:15], s33 offen offset:3072 nt lds
v_mfma_f32_16x16x32_bf16 v[148:151], a[236:239], v[88:91], v[148:151]
s_add_u32 m0, s32, 98304
v_exp_f32 v57, v57
v_mfma_f32_16x16x32_bf16 v[156:159], a[236:239], v[92:95], v[156:159]
s_xor_b32 s33, s99, 131072
ds_read_b64_tr_b16 a[230:231], v53 offset:8448
v_fma_f32 v59, v99, s35, v72
v_mfma_f32_16x16x32_bf16 v[160:163], a[192:195], v[88:91], v[160:163]
v_exp_f32 v58, v58
v_mfma_f32_16x16x32_bf16 v[168:171], a[192:195], v[92:95], v[168:171]
ds_read_b64_tr_b16 a[232:233], v54 offset:256
v_fma_f32 v60, v100, s35, v72
v_mfma_f32_16x16x32_bf16 v[164:167], a[196:199], v[88:91], v[164:167]
v_exp_f32 v59, v59
v_mfma_f32_16x16x32_bf16 v[172:175], a[196:199], v[92:95], v[172:175]
ds_read_b64_tr_b16 a[234:235], v54 offset:8448
v_fma_f32 v61, v101, s35, v72
v_mfma_f32_16x16x32_bf16 v[176:179], a[200:203], v[88:91], v[176:179]
s_waitcnt vmcnt(16)
ds_read_b64_tr_b16 a[236:237], v55 offset:256
v_cvt_pk_bf16_f32 v80, v56, v57
v_mfma_f32_16x16x32_bf16 v[184:187], a[200:203], v[92:95], v[184:187]
v_exp_f32 v60, v60
v_mfma_f32_16x16x32_bf16 v[180:183], a[204:207], v[88:91], v[180:183]
ds_read_b64_tr_b16 a[238:239], v55 offset:8448
v_fma_f32 v62, v102, s35, v72
v_mfma_f32_16x16x32_bf16 v[188:191], a[204:207], v[92:95], v[188:191]
s_barrier
v_exp_f32 v61, v61
v_mfma_f32_16x16x32_bf16 v[192:195], a[208:211], v[88:91], v[192:195]
buffer_load_dwordx4 v16, s[16:19], s33 offen offset:0 nt lds
v_mfma_f32_16x16x32_bf16 v[200:203], a[208:211], v[92:95], v[200:203]
ds_read_b128 a[192:195], v24 offset:0
v_fma_f32 v63, v103, s35, v72
v_mfma_f32_16x16x32_bf16 v[196:199], a[212:215], v[88:91], v[196:199]
ds_read_b128 a[196:199], v24 offset:8192
v_cvt_pk_bf16_f32 v81, v58, v59
v_mfma_f32_16x16x32_bf16 v[204:207], a[212:215], v[92:95], v[204:207]
v_exp_f32 v62, v62
v_mfma_f32_16x16x32_bf16 v[208:211], a[216:219], v[88:91], v[208:211]
ds_read_b128 a[200:203], v25 offset:0
v_fma_f32 v56, v104, s35, v76
v_mfma_f32_16x16x32_bf16 v[216:219], a[216:219], v[92:95], v[216:219]
v_exp_f32 v63, v63
v_mfma_f32_16x16x32_bf16 v[212:215], a[220:223], v[88:91], v[212:215]
ds_read_b128 a[204:207], v25 offset:8192
v_fma_f32 v57, v105, s35, v76
v_mfma_f32_16x16x32_bf16 v[220:223], a[220:223], v[92:95], v[220:223]
s_waitcnt lgkmcnt(2)
ds_read_b128 a[208:211], v26 offset:0
v_cvt_pk_bf16_f32 v82, v60, v61
v_mfma_f32_16x16x32_bf16 v[224:227], a[224:227], v[88:91], v[224:227]
v_exp_f32 v56, v56
v_mfma_f32_16x16x32_bf16 v[232:235], a[224:227], v[92:95], v[232:235]
ds_read_b128 a[212:215], v26 offset:8192
v_fma_f32 v58, v106, s35, v76
v_mfma_f32_16x16x32_bf16 v[228:231], a[228:231], v[88:91], v[228:231]
v_exp_f32 v57, v57
v_mfma_f32_16x16x32_bf16 v[236:239], a[228:231], v[92:95], v[236:239]
buffer_load_dwordx4 v17, s[16:19], s33 offen offset:1024 nt lds
v_mfma_f32_16x16x32_bf16 v[240:243], a[232:235], v[88:91], v[240:243]
ds_read_b128 a[216:219], v27 offset:0
v_fma_f32 v59, v107, s35, v76
v_mfma_f32_16x16x32_bf16 v[248:251], a[232:235], v[92:95], v[248:251]
ds_read_b128 a[220:223], v27 offset:8192
v_cvt_pk_bf16_f32 v83, v62, v63
v_mfma_f32_16x16x32_bf16 v[244:247], a[236:239], v[88:91], v[244:247]
v_exp_f32 v58, v58
v_mfma_f32_16x16x32_bf16 v[252:255], a[236:239], v[92:95], v[252:255]
ds_read_b128 a[224:227], v24 offset:256
v_fma_f32 v60, v108, s35, v76
v_mfma_f32_16x16x32_bf16 v[112:115], a[192:195], a[0:3], 0
v_exp_f32 v59, v59
v_mfma_f32_16x16x32_bf16 v[120:123], a[192:195], a[4:7], 0
ds_read_b128 a[228:231], v24 offset:8448
v_fma_f32 v61, v109, s35, v76
v_mfma_f32_16x16x32_bf16 v[116:119], a[196:199], a[0:3], 0
ds_read_b128 a[232:235], v25 offset:256
v_cvt_pk_bf16_f32 v84, v56, v57
v_mfma_f32_16x16x32_bf16 v[124:127], a[196:199], a[4:7], 0
s_waitcnt lgkmcnt(3)
v_exp_f32 v60, v60
v_mfma_f32_16x16x32_bf16 v[112:115], a[200:203], a[8:11], v[112:115]
ds_read_b128 a[236:239], v25 offset:8448
v_fma_f32 v62, v110, s35, v76
v_mfma_f32_16x16x32_bf16 v[120:123], a[200:203], a[12:15], v[120:123]
v_exp_f32 v61, v61
v_mfma_f32_16x16x32_bf16 v[116:119], a[204:207], a[8:11], v[116:119]
buffer_load_dwordx4 v18, s[16:19], s33 offen offset:2048 nt lds
v_mfma_f32_16x16x32_bf16 v[124:127], a[204:207], a[12:15], v[124:127]
ds_read_b128 a[192:195], v26 offset:256
v_fma_f32 v63, v111, s35, v76
v_mfma_f32_16x16x32_bf16 v[112:115], a[208:211], a[16:19], v[112:115]
ds_read_b128 a[196:199], v26 offset:8448
v_cvt_pk_bf16_f32 v85, v58, v59
v_mfma_f32_16x16x32_bf16 v[120:123], a[208:211], a[20:23], v[120:123]
s_waitcnt vmcnt(15)
v_exp_f32 v62, v62
v_mfma_f32_16x16x32_bf16 v[116:119], a[212:215], a[16:19], v[116:119]
v_exp_f32 v63, v63
v_mfma_f32_16x16x32_bf16 v[124:127], a[212:215], a[20:23], v[124:127]
ds_read_b128 a[200:203], v27 offset:256
v_cvt_pk_bf16_f32 v86, v60, v61
v_mfma_f32_16x16x32_bf16 v[112:115], a[216:219], a[24:27], v[112:115]
ds_read_b128 a[204:207], v27 offset:8448
v_cvt_pk_bf16_f32 v87, v62, v63
v_mfma_f32_16x16x32_bf16 v[120:123], a[216:219], a[28:31], v[120:123]
s_barrier
ds_read_b64_tr_b16 a[208:209], v32 offset:49152
v_or3_b32 v0, v80, v81, v82
v_mfma_f32_16x16x32_bf16 v[116:119], a[220:223], a[24:27], v[116:119]
LA_t28:
s_load_dword s98, s[96:97], 37376
ds_read_b64_tr_b16 a[210:211], v32 offset:57344
v_or3_b32 v1, v83, v84, v85
v_mfma_f32_16x16x32_bf16 v[124:127], a[220:223], a[28:31], v[124:127]
s_waitcnt lgkmcnt(4)
ds_read_b64_tr_b16 a[212:213], v33 offset:49152
v_or3_b32 v0, v0, v86, v87
v_mfma_f32_16x16x32_bf16 v[112:115], a[224:227], a[32:35], v[112:115]
ds_read_b64_tr_b16 a[214:215], v33 offset:57344
v_bitop3_b32 v0, v0, v1, s36 bitop3:0xa8
v_mfma_f32_16x16x32_bf16 v[120:123], a[224:227], a[36:39], v[120:123]
buffer_load_dwordx4 v19, s[16:19], s33 offen offset:3072 nt lds
v_mfma_f32_16x16x32_bf16 v[116:119], a[228:231], a[32:35], v[116:119]
s_add_u32 m0, s32, 0
ds_read_b64_tr_b16 a[216:217], v34 offset:49152
v_cmp_ne_u32 vcc, 0, v0
v_mfma_f32_16x16x32_bf16 v[124:127], a[228:231], a[36:39], v[124:127]
s_xor_b32 s33, s99, 163840
ds_read_b64_tr_b16 a[218:219], v34 offset:57344
ds_read_b64_tr_b16 a[220:221], v35 offset:49152
v_mfma_f32_16x16x32_bf16 v[112:115], a[232:235], a[40:43], v[112:115]
s_cbranch_vccnz LA_stub6
LA_back6:
ds_read_b64_tr_b16 a[222:223], v35 offset:57344
ds_read_b64_tr_b16 a[224:225], v36 offset:49152
v_mfma_f32_16x16x32_bf16 v[120:123], a[232:235], a[44:47], v[120:123]
ds_read_b64_tr_b16 a[226:227], v36 offset:57344
ds_read_b64_tr_b16 a[228:229], v37 offset:49152
v_mfma_f32_16x16x32_bf16 v[116:119], a[236:239], a[40:43], v[116:119]
ds_read_b64_tr_b16 a[230:231], v37 offset:57344
ds_read_b64_tr_b16 a[232:233], v38 offset:49152
v_mfma_f32_16x16x32_bf16 v[124:127], a[236:239], a[44:47], v[124:127]
ds_read_b64_tr_b16 a[234:235], v38 offset:57344
ds_read_b64_tr_b16 a[236:237], v39 offset:49152
v_mfma_f32_16x16x32_bf16 v[112:115], a[192:195], a[48:51], v[112:115]
ds_read_b64_tr_b16 a[238:239], v39 offset:57344
v_mfma_f32_16x16x32_bf16 v[120:123], a[192:195], a[52:55], v[120:123]
ds_read_b64_tr_b16 a[192:193], v32 offset:49408
ds_read_b64_tr_b16 a[194:195], v32 offset:57600
v_mfma_f32_16x16x32_bf16 v[116:119], a[196:199], a[48:51], v[116:119]
v_mfma_f32_16x16x32_bf16 v[124:127], a[196:199], a[52:55], v[124:127]
s_waitcnt lgkmcnt(5)
ds_read_b64_tr_b16 a[196:197], v33 offset:49408
ds_read_b64_tr_b16 a[198:199], v33 offset:57600
v_mfma_f32_16x16x32_bf16 v[112:115], a[200:203], a[56:59], v[112:115]
buffer_load_dwordx4 v16, s[12:15], s33 offen offset:0 nt lds
v_mfma_f32_16x16x32_bf16 v[120:123], a[200:203], a[60:63], v[120:123]
ds_read_b64_tr_b16 a[200:201], v34 offset:49408
ds_read_b64_tr_b16 a[202:203], v34 offset:57600
v_mfma_f32_16x16x32_bf16 v[116:119], a[204:207], a[56:59], v[116:119]
v_mfma_f32_16x16x32_bf16 v[124:127], a[204:207], a[60:63], v[124:127]
ds_read_b64_tr_b16 a[204:205], v35 offset:49408
ds_read_b64_tr_b16 a[206:207], v35 offset:57600
v_mfma_f32_16x16x32_bf16 v[64:67], a[176:179], v[80:83], v[64:67]
v_mfma_f32_16x16x32_bf16 v[68:71], a[176:179], v[84:87], v[68:71]
v_mfma_f32_16x16x32_bf16 v[128:131], a[208:211], v[80:83], v[128:131]
v_mfma_f32_16x16x32_bf16 v[136:139], a[208:211], v[84:87], v[136:139]
ds_read_b64_tr_b16 a[208:209], v36 offset:49408
v_fma_f32 v56, v112, s35, v72
v_mfma_f32_16x16x32_bf16 v[132:135], a[212:215], v[80:83], v[132:135]
ds_read_b64_tr_b16 a[210:211], v36 offset:57600
v_fma_f32 v57, v113, s35, v72
v_mfma_f32_16x16x32_bf16 v[140:143], a[212:215], v[84:87], v[140:143]
v_exp_f32 v56, v56
v_mfma_f32_16x16x32_bf16 v[144:147], a[216:219], v[80:83], v[144:147]
ds_read_b64_tr_b16 a[212:213], v37 offset:49408
v_fma_f32 v58, v114, s35, v72
v_mfma_f32_16x16x32_bf16 v[152:155], a[216:219], v[84:87], v[152:155]
buffer_load_dwordx4 v17, s[12:15], s33 offen offset:1024 nt lds
v_mfma_f32_16x16x32_bf16 v[148:151], a[220:223], v[80:83], v[148:151]
v_exp_f32 v57, v57
v_mfma_f32_16x16x32_bf16 v[156:159], a[220:223], v[84:87], v[156:159]
ds_read_b64_tr_b16 a[214:215], v37 offset:57600
v_fma_f32 v59, v115, s35, v72
v_mfma_f32_16x16x32_bf16 v[160:163], a[224:227], v[80:83], v[160:163]
v_exp_f32 v58, v58
v_mfma_f32_16x16x32_bf16 v[168:171], a[224:227], v[84:87], v[168:171]
ds_read_b64_tr_b16 a[216:217], v38 offset:49408
v_fma_f32 v60, v116, s35, v72
v_mfma_f32_16x16x32_bf16 v[164:167], a[228:231], v[80:83], v[164:167]
v_exp_f32 v59, v59
v_mfma_f32_16x16x32_bf16 v[172:175], a[228:231], v[84:87], v[172:175]
s_waitcnt lgkmcnt(2)
ds_read_b64_tr_b16 a[218:219], v38 offset:57600
v_fma_f32 v61, v117, s35, v72
v_mfma_f32_16x16x32_bf16 v[176:179], a[232:235], v[80:83], v[176:179]
s_waitcnt vmcnt(14)
ds_read_b64_tr_b16 a[220:221], v39 offset:49408
v_cvt_pk_bf16_f32 v88, v56, v57
v_mfma_f32_16x16x32_bf16 v[184:187], a[232:235], v[84:87], v[184:187]
v_exp_f32 v60, v60
v_mfma_f32_16x16x32_bf16 v[180:183], a[236:239], v[80:83], v[180:183]
ds_read_b64_tr_b16 a[222:223], v39 offset:57600
v_fma_f32 v62, v118, s35, v72
v_mfma_f32_16x16x32_bf16 v[188:191], a[236:239], v[84:87], v[188:191]
s_barrier
v_exp_f32 v61, v61
v_mfma_f32_16x16x32_bf16 v[192:195], a[192:195], v[80:83], v[192:195]
buffer_load_dwordx4 v18, s[12:15], s33 offen offset:2048 nt lds
v_mfma_f32_16x16x32_bf16 v[200:203], a[192:195], v[84:87], v[200:203]
ds_read_b128 a[224:227], v28 offset:16384
v_fma_f32 v63, v119, s35, v72
v_mfma_f32_16x16x32_bf16 v[196:199], a[196:199], v[80:83], v[196:199]
ds_read_b128 a[228:231], v28 offset:24576
v_cvt_pk_bf16_f32 v89, v58, v59
v_mfma_f32_16x16x32_bf16 v[204:207], a[196:199], v[84:87], v[204:207]
v_exp_f32 v62, v62
v_mfma_f32_16x16x32_bf16 v[208:211], a[200:203], v[80:83], v[208:211]
ds_read_b128 a[232:235], v29 offset:16384
v_fma_f32 v56, v120, s35, v76
v_mfma_f32_16x16x32_bf16 v[216:219], a[200:203], v[84:87], v[216:219]
v_exp_f32 v63, v63
v_mfma_f32_16x16x32_bf16 v[212:215], a[204:207], v[80:83], v[212:215]
ds_read_b128 a[236:239], v29 offset:24576
v_fma_f32 v57, v121, s35, v76
v_mfma_f32_16x16x32_bf16 v[220:223], a[204:207], v[84:87], v[220:223]
ds_read_b128 a[192:195], v30 offset:16384
v_cvt_pk_bf16_f32 v90, v60, v61
v_mfma_f32_16x16x32_bf16 v[224:227], a[208:211], v[80:83], v[224:227]
v_exp_f32 v56, v56
v_mfma_f32_16x16x32_bf16 v[232:235], a[208:211], v[84:87], v[232:235]
s_waitcnt lgkmcnt(2)
ds_read_b128 a[196:199], v30 offset:24576
v_fma_f32 v58, v122, s35, v76
v_mfma_f32_16x16x32_bf16 v[228:231], a[212:215], v[80:83], v[228:231]
v_exp_f32 v57, v57
v_mfma_f32_16x16x32_bf16 v[236:239], a[212:215], v[84:87], v[236:239]
buffer_load_dwordx4 v19, s[12:15], s33 offen offset:3072 nt lds
v_mfma_f32_16x16x32_bf16 v[240:243], a[216:219], v[80:83], v[240:243]
s_add_u32 m0, s32, 81920
ds_read_b128 a[200:203], v31 offset:16384
v_fma_f32 v59, v123, s35, v76
v_mfma_f32_16x16x32_bf16 v[248:251], a[216:219], v[84:87], v[248:251]
s_xor_b32 s33, s99, 147456
ds_read_b128 a[204:207], v31 offset:24576
v_cvt_pk_bf16_f32 v91, v62, v63
v_mfma_f32_16x16x32_bf16 v[244:247], a[220:223], v[80:83], v[244:247]
v_exp_f32 v58, v58
v_mfma_f32_16x16x32_bf16 v[252:255], a[220:223], v[84:87], v[252:255]
ds_read_b128 a[208:211], v28 offset:16640
v_fma_f32 v60, v124, s35, v76
v_mfma_f32_16x16x32_bf16 v[96:99], a[224:227], a[0:3], 0
v_exp_f32 v59, v59
v_mfma_f32_16x16x32_bf16 v[104:107], a[224:227], a[4:7], 0
ds_read_b128 a[212:215], v28 offset:24832
v_fma_f32 v61, v125, s35, v76
v_mfma_f32_16x16x32_bf16 v[100:103], a[228:231], a[0:3], 0
ds_read_b128 a[216:219], v29 offset:16640
v_cvt_pk_bf16_f32 v92, v56, v57
v_mfma_f32_16x16x32_bf16 v[108:111], a[228:231], a[4:7], 0
v_exp_f32 v60, v60
v_mfma_f32_16x16x32_bf16 v[96:99], a[232:235], a[8:11], v[96:99]
ds_read_b128 a[220:223], v29 offset:24832
v_fma_f32 v62, v126, s35, v76
v_mfma_f32_16x16x32_bf16 v[104:107], a[232:235], a[12:15], v[104:107]
s_waitcnt lgkmcnt(3)
v_exp_f32 v61, v61
v_mfma_f32_16x16x32_bf16 v[100:103], a[236:239], a[8:11], v[100:103]
buffer_load_dwordx4 v16, s[16:19], s33 offen offset:0 nt lds
v_mfma_f32_16x16x32_bf16 v[108:111], a[236:239], a[12:15], v[108:111]
ds_read_b128 a[224:227], v30 offset:16640
v_fma_f32 v63, v127, s35, v76
v_mfma_f32_16x16x32_bf16 v[96:99], a[192:195], a[16:19], v[96:99]
ds_read_b128 a[228:231], v30 offset:24832
v_cvt_pk_bf16_f32 v93, v58, v59
v_mfma_f32_16x16x32_bf16 v[104:107], a[192:195], a[20:23], v[104:107]
s_waitcnt vmcnt(13)
v_exp_f32 v62, v62
v_mfma_f32_16x16x32_bf16 v[100:103], a[196:199], a[16:19], v[100:103]
v_exp_f32 v63, v63
v_mfma_f32_16x16x32_bf16 v[108:111], a[196:199], a[20:23], v[108:111]
ds_read_b128 a[232:235], v31 offset:16640
v_cvt_pk_bf16_f32 v94, v60, v61
v_mfma_f32_16x16x32_bf16 v[96:99], a[200:203], a[24:27], v[96:99]
ds_read_b128 a[236:239], v31 offset:24832
v_cvt_pk_bf16_f32 v95, v62, v63
v_mfma_f32_16x16x32_bf16 v[104:107], a[200:203], a[28:31], v[104:107]
s_barrier
ds_read_b64_tr_b16 a[192:193], v32 offset:32768
v_or3_b32 v0, v88, v89, v90
v_mfma_f32_16x16x32_bf16 v[100:103], a[204:207], a[24:27], v[100:103]
LA_t30:
s_load_dword s98, s[96:97], 38704
ds_read_b64_tr_b16 a[194:195], v32 offset:40960
v_or3_b32 v1, v91, v92, v93
v_mfma_f32_16x16x32_bf16 v[108:111], a[204:207], a[28:31], v[108:111]
ds_read_b64_tr_b16 a[196:197], v33 offset:32768
v_or3_b32 v0, v0, v94, v95
v_mfma_f32_16x16x32_bf16 v[96:99], a[208:211], a[32:35], v[96:99]
buffer_load_dwordx4 v17, s[16:19], s33 offen offset:1024 nt lds
v_mfma_f32_16x16x32_bf16 v[104:107], a[208:211], a[36:39], v[104:107]
s_waitcnt lgkmcnt(3)
ds_read_b64_tr_b16 a[198:199], v33 offset:40960
v_bitop3_b32 v0, v0, v1, s36 bitop3:0xa8
v_mfma_f32_16x16x32_bf16 v[100:103], a[212:215], a[32:35], v[100:103]
ds_read_b64_tr_b16 a[200:201], v34 offset:32768
v_cmp_ne_u32 vcc, 0, v0
v_mfma_f32_16x16x32_bf16 v[108:111], a[212:215], a[36:39], v[108:111]
s_cbranch_vccnz LA_stub7
LA_back7:
ds_read_b64_tr_b16 a[202:203], v34 offset:40960
ds_read_b64_tr_b16 a[204:205], v35 offset:32768
v_mfma_f32_16x16x32_bf16 v[96:99], a[216:219], a[40:43], v[96:99]
ds_read_b64_tr_b16 a[206:207], v35 offset:40960
ds_read_b64_tr_b16 a[208:209], v36 offset:32768
v_mfma_f32_16x16x32_bf16 v[104:107], a[216:219], a[44:47], v[104:107]
ds_read_b64_tr_b16 a[210:211], v36 offset:40960
ds_read_b64_tr_b16 a[212:213], v37 offset:32768
v_mfma_f32_16x16x32_bf16 v[100:103], a[220:223], a[40:43], v[100:103]
ds_read_b64_tr_b16 a[214:215], v37 offset:40960
ds_read_b64_tr_b16 a[216:217], v38 offset:32768
v_mfma_f32_16x16x32_bf16 v[108:111], a[220:223], a[44:47], v[108:111]
ds_read_b64_tr_b16 a[218:219], v38 offset:40960
ds_read_b64_tr_b16 a[220:221], v39 offset:32768
v_mfma_f32_16x16x32_bf16 v[96:99], a[224:227], a[48:51], v[96:99]
ds_read_b64_tr_b16 a[222:223], v39 offset:40960
v_mfma_f32_16x16x32_bf16 v[104:107], a[224:227], a[52:55], v[104:107]
ds_read_b64_tr_b16 a[224:225], v32 offset:33024
ds_read_b64_tr_b16 a[226:227], v32 offset:41216
v_mfma_f32_16x16x32_bf16 v[100:103], a[228:231], a[48:51], v[100:103]
buffer_load_dwordx4 v18, s[16:19], s33 offen offset:2048 nt lds
v_mfma_f32_16x16x32_bf16 v[108:111], a[228:231], a[52:55], v[108:111]
ds_read_b64_tr_b16 a[228:229], v33 offset:33024
ds_read_b64_tr_b16 a[230:231], v33 offset:41216
v_mfma_f32_16x16x32_bf16 v[96:99], a[232:235], a[56:59], v[96:99]
v_mfma_f32_16x16x32_bf16 v[104:107], a[232:235], a[60:63], v[104:107]
ds_read_b64_tr_b16 a[232:233], v34 offset:33024
ds_read_b64_tr_b16 a[234:235], v34 offset:41216
v_mfma_f32_16x16x32_bf16 v[100:103], a[236:239], a[56:59], v[100:103]
v_mfma_f32_16x16x32_bf16 v[108:111], a[236:239], a[60:63], v[108:111]
ds_read_b64_tr_b16 a[236:237], v35 offset:33024
ds_read_b64_tr_b16 a[238:239], v35 offset:41216
v_mfma_f32_16x16x32_bf16 v[64:67], a[176:179], v[88:91], v[64:67]
v_mfma_f32_16x16x32_bf16 v[68:71], a[176:179], v[92:95], v[68:71]
s_waitcnt lgkmcnt(4)
v_mfma_f32_16x16x32_bf16 v[128:131], a[192:195], v[88:91], v[128:131]
v_mfma_f32_16x16x32_bf16 v[136:139], a[192:195], v[92:95], v[136:139]
ds_read_b64_tr_b16 a[192:193], v36 offset:33024
v_fma_f32 v56, v96, s35, v72
v_mfma_f32_16x16x32_bf16 v[132:135], a[196:199], v[88:91], v[132:135]
buffer_load_dwordx4 v19, s[16:19], s33 offen offset:3072 nt lds
v_mfma_f32_16x16x32_bf16 v[140:143], a[196:199], v[92:95], v[140:143]
s_add_u32 m0, s32, 114688
ds_read_b64_tr_b16 a[194:195], v36 offset:41216
v_fma_f32 v57, v97, s35, v72
v_mfma_f32_16x16x32_bf16 v[144:147], a[200:203], v[88:91], v[144:147]
s_xor_b32 s33, s99, 180224
v_exp_f32 v56, v56
v_mfma_f32_16x16x32_bf16 v[152:155], a[200:203], v[92:95], v[152:155]
ds_read_b64_tr_b16 a[196:197], v37 offset:33024
v_fma_f32 v58, v98, s35, v72
v_mfma_f32_16x16x32_bf16 v[148:151], a[204:207], v[88:91], v[148:151]
v_exp_f32 v57, v57
v_mfma_f32_16x16x32_bf16 v[156:159], a[204:207], v[92:95], v[156:159]
ds_read_b64_tr_b16 a[198:199], v37 offset:41216
v_fma_f32 v59, v99, s35, v72
v_mfma_f32_16x16x32_bf16 v[160:163], a[208:211], v[88:91], v[160:163]
v_exp_f32 v58, v58
v_mfma_f32_16x16x32_bf16 v[168:171], a[208:211], v[92:95], v[168:171]
ds_read_b64_tr_b16 a[200:201], v38 offset:33024
v_fma_f32 v60, v100, s35, v72
v_mfma_f32_16x16x32_bf16 v[164:167], a[212:215], v[88:91], v[164:167]
v_exp_f32 v59, v59
v_mfma_f32_16x16x32_bf16 v[172:175], a[212:215], v[92:95], v[172:175]
ds_read_b64_tr_b16 a[202:203], v38 offset:41216
v_fma_f32 v61, v101, s35, v72
v_mfma_f32_16x16x32_bf16 v[176:179], a[216:219], v[88:91], v[176:179]
s_waitcnt vmcnt(12)
buffer_load_dwordx4 v16, s[12:15], s33 offen offset:0 nt lds
v_mfma_f32_16x16x32_bf16 v[184:187], a[216:219], v[92:95], v[184:187]
ds_read_b64_tr_b16 a[204:205], v39 offset:33024
v_cvt_pk_bf16_f32 v80, v56, v57
v_mfma_f32_16x16x32_bf16 v[180:183], a[220:223], v[88:91], v[180:183]
v_exp_f32 v60, v60
v_mfma_f32_16x16x32_bf16 v[188:191], a[220:223], v[92:95], v[188:191]
ds_read_b64_tr_b16 a[206:207], v39 offset:41216
v_fma_f32 v62, v102, s35, v72
v_mfma_f32_16x16x32_bf16 v[192:195], a[224:227], v[88:91], v[192:195]
s_barrier
v_exp_f32 v61, v61
v_mfma_f32_16x16x32_bf16 v[200:203], a[224:227], v[92:95], v[200:203]
ds_read_b128 a[208:211], v20 offset:16384
v_fma_f32 v63, v103, s35, v72
v_mfma_f32_16x16x32_bf16 v[196:199], a[228:231], v[88:91], v[196:199]
ds_read_b128 a[212:215], v20 offset:24576
v_cvt_pk_bf16_f32 v81, v58, v59
v_mfma_f32_16x16x32_bf16 v[204:207], a[228:231], v[92:95], v[204:207]
s_waitcnt lgkmcnt(3)
v_exp_f32 v62, v62
v_mfma_f32_16x16x32_bf16 v[208:211], a[232:235], v[88:91], v[208:211]
ds_read_b128 a[216:219], v21 offset:16384
v_fma_f32 v56, v104, s35, v76
v_mfma_f32_16x16x32_bf16 v[216:219], a[232:235], v[92:95], v[216:219]
v_exp_f32 v63, v63
v_mfma_f32_16x16x32_bf16 v[212:215], a[236:239], v[88:91], v[212:215]
buffer_load_dwordx4 v17, s[12:15], s33 offen offset:1024 nt lds
v_mfma_f32_16x16x32_bf16 v[220:223], a[236:239], v[92:95], v[220:223]
ds_read_b128 a[220:223], v21 offset:24576
v_fma_f32 v57, v105, s35, v76
v_mfma_f32_16x16x32_bf16 v[224:227], a[192:195], v[88:91], v[224:227]
ds_read_b128 a[224:227], v22 offset:16384
v_cvt_pk_bf16_f32 v82, v60, v61
v_mfma_f32_16x16x32_bf16 v[232:235], a[192:195], v[92:95], v[232:235]
v_exp_f32 v56, v56
v_mfma_f32_16x16x32_bf16 v[228:231], a[196:199], v[88:91], v[228:231]
ds_read_b128 a[228:231], v22 offset:24576
v_fma_f32 v58, v106, s35, v76
v_mfma_f32_16x16x32_bf16 v[236:239], a[196:199], v[92:95], v[236:239]
v_exp_f32 v57, v57
v_mfma_f32_16x16x32_bf16 v[240:243], a[200:203], v[88:91], v[240:243]
ds_read_b128 a[232:235], v23 offset:16384
v_fma_f32 v59, v107, s35, v76
v_mfma_f32_16x16x32_bf16 v[248:251], a[200:203], v[92:95], v[248:251]
s_waitcnt lgkmcnt(2)
ds_read_b128 a[236:239], v23 offset:24576
v_cvt_pk_bf16_f32 v83, v62, v63
v_mfma_f32_16x16x32_bf16 v[244:247], a[204:207], v[88:91], v[244:247]
v_exp_f32 v58, v58
v_mfma_f32_16x16x32_bf16 v[252:255], a[204:207], v[92:95], v[252:255]
ds_read_b128 a[192:195], v20 offset:16640
v_fma_f32 v60, v108, s35, v76
v_mfma_f32_16x16x32_bf16 v[112:115], a[208:211], a[0:3], 0
buffer_load_dwordx4 v18, s[12:15], s33 offen offset:2048 nt lds
v_mfma_f32_16x16x32_bf16 v[120:123], a[208:211], a[4:7], 0
v_exp_f32 v59, v59
v_mfma_f32_16x16x32_bf16 v[116:119], a[212:215], a[0:3], 0
ds_read_b128 a[196:199], v20 offset:24832
v_fma_f32 v61, v109, s35, v76
v_mfma_f32_16x16x32_bf16 v[124:127], a[212:215], a[4:7], 0
ds_read_b128 a[200:203], v21 offset:16640
v_cvt_pk_bf16_f32 v84, v56, v57
v_mfma_f32_16x16x32_bf16 v[112:115], a[216:219], a[8:11], v[112:115]
v_exp_f32 v60, v60
v_mfma_f32_16x16x32_bf16 v[120:123], a[216:219], a[12:15], v[120:123]
ds_read_b128 a[204:207], v21 offset:24832
v_fma_f32 v62, v110, s35, v76
v_mfma_f32_16x16x32_bf16 v[116:119], a[220:223], a[8:11], v[116:119]
v_exp_f32 v61, v61
v_mfma_f32_16x16x32_bf16 v[124:127], a[220:223], a[12:15], v[124:127]
ds_read_b128 a[208:211], v22 offset:16640
v_fma_f32 v63, v111, s35, v76
v_mfma_f32_16x16x32_bf16 v[112:115], a[224:227], a[16:19], v[112:115]
ds_read_b128 a[212:215], v22 offset:24832
v_cvt_pk_bf16_f32 v85, v58, v59
v_mfma_f32_16x16x32_bf16 v[120:123], a[224:227], a[20:23], v[120:123]
s_waitcnt lgkmcnt(3)
v_exp_f32 v62, v62
v_mfma_f32_16x16x32_bf16 v[116:119], a[228:231], a[16:19], v[116:119]
s_waitcnt vmcnt(11)
buffer_load_dwordx4 v19, s[12:15], s33 offen offset:3072 nt lds
v_mfma_f32_16x16x32_bf16 v[124:127], a[228:231], a[20:23], v[124:127]
s_add_u32 m0, s32, 131072
v_exp_f32 v63, v63
v_mfma_f32_16x16x32_bf16 v[112:115], a[232:235], a[24:27], v[112:115]
s_xor_b32 s33, s99, 163840
ds_read_b128 a[216:219], v23 offset:16640
v_cvt_pk_bf16_f32 v86, v60, v61
v_mfma_f32_16x16x32_bf16 v[120:123], a[232:235], a[28:31], v[120:123]
ds_read_b128 a[220:223], v23 offset:24832
v_cvt_pk_bf16_f32 v87, v62, v63
v_mfma_f32_16x16x32_bf16 v[116:119], a[236:239], a[24:27], v[116:119]
s_barrier
ds_read_b64_tr_b16 a[224:225], v40 offset:32768
v_or3_b32 v0, v80, v81, v82
v_mfma_f32_16x16x32_bf16 v[124:127], a[236:239], a[28:31], v[124:127]
LA_t32:
s_load_dword s98, s[96:97], 40052
ds_read_b64_tr_b16 a[226:227], v40 offset:40960
v_or3_b32 v1, v83, v84, v85
v_mfma_f32_16x16x32_bf16 v[112:115], a[192:195], a[32:35], v[112:115]
ds_read_b64_tr_b16 a[228:229], v41 offset:32768
v_or3_b32 v0, v0, v86, v87
v_mfma_f32_16x16x32_bf16 v[120:123], a[192:195], a[36:39], v[120:123]
ds_read_b64_tr_b16 a[230:231], v41 offset:40960
v_bitop3_b32 v0, v0, v1, s36 bitop3:0xa8
v_mfma_f32_16x16x32_bf16 v[116:119], a[196:199], a[32:35], v[116:119]
ds_read_b64_tr_b16 a[232:233], v42 offset:32768
v_cmp_ne_u32 vcc, 0, v0
v_mfma_f32_16x16x32_bf16 v[124:127], a[196:199], a[36:39], v[124:127]
s_cbranch_vccnz LA_stub8
LA_back8:
ds_read_b64_tr_b16 a[234:235], v42 offset:40960
v_accvgpr_read_b32 v12, a180
v_mfma_f32_16x16x32_bf16 v[112:115], a[200:203], a[40:43], v[112:115]
buffer_load_dwordx4 v16, s[16:19], s33 offen offset:0 nt lds
v_mfma_f32_16x16x32_bf16 v[120:123], a[200:203], a[44:47], v[120:123]
s_waitcnt lgkmcnt(3)
ds_read_b64_tr_b16 a[236:237], v43 offset:32768
v_accvgpr_read_b32 v13, a181
v_mfma_f32_16x16x32_bf16 v[116:119], a[204:207], a[40:43], v[116:119]
ds_read_b64_tr_b16 a[238:239], v43 offset:40960
v_accvgpr_read_b32 v14, a182
v_mfma_f32_16x16x32_bf16 v[124:127], a[204:207], a[44:47], v[124:127]
ds_read_b64_tr_b16 a[192:193], v44 offset:32768
v_accvgpr_read_b32 v15, a183
v_mfma_f32_16x16x32_bf16 v[112:115], a[208:211], a[48:51], v[112:115]
buffer_load_dwordx2 v[6:7], off, s[64:67], 0 sc1
v_mfma_f32_16x16x32_bf16 v[120:123], a[208:211], a[52:55], v[120:123]
ds_read_b64_tr_b16 a[194:195], v44 offset:40960
ds_read_b64_tr_b16 a[196:197], v45 offset:32768
v_mfma_f32_16x16x32_bf16 v[116:119], a[212:215], a[48:51], v[116:119]
ds_read_b64_tr_b16 a[198:199], v45 offset:40960
ds_read_b64_tr_b16 a[200:201], v46 offset:32768
v_mfma_f32_16x16x32_bf16 v[124:127], a[212:215], a[52:55], v[124:127]
ds_read_b64_tr_b16 a[202:203], v46 offset:40960
ds_read_b64_tr_b16 a[204:205], v47 offset:32768
v_mfma_f32_16x16x32_bf16 v[112:115], a[216:219], a[56:59], v[112:115]
ds_read_b64_tr_b16 a[206:207], v47 offset:40960
ds_read_b64_tr_b16 a[208:209], v40 offset:33024
v_mfma_f32_16x16x32_bf16 v[120:123], a[216:219], a[60:63], v[120:123]
ds_read_b64_tr_b16 a[210:211], v40 offset:41216
ds_read_b64_tr_b16 a[212:213], v41 offset:33024
v_mfma_f32_16x16x32_bf16 v[116:119], a[220:223], a[56:59], v[116:119]
buffer_load_dwordx4 v17, s[16:19], s33 offen offset:1024 nt lds
v_mfma_f32_16x16x32_bf16 v[124:127], a[220:223], a[60:63], v[124:127]
ds_read_b64_tr_b16 a[214:215], v41 offset:41216
ds_read_b64_tr_b16 a[216:217], v42 offset:33024
v_mfma_f32_16x16x32_bf16 v[64:67], a[176:179], v[80:83], v[64:67]
ds_read_b64_tr_b16 a[218:219], v42 offset:41216
ds_read_b64_tr_b16 a[220:221], v43 offset:33024
v_mfma_f32_16x16x32_bf16 v[68:71], a[176:179], v[84:87], v[68:71]
ds_read_b64_tr_b16 a[222:223], v43 offset:41216
v_mfma_f32_16x16x32_bf16 v[128:131], a[224:227], v[80:83], v[128:131]
v_mfma_f32_16x16x32_bf16 v[136:139], a[224:227], v[84:87], v[136:139]
s_waitcnt lgkmcnt(5)
ds_read_b64_tr_b16 a[224:225], v44 offset:33024
v_fma_f32 v56, v112, s35, v72
v_mfma_f32_16x16x32_bf16 v[132:135], a[228:231], v[80:83], v[132:135]
ds_read_b64_tr_b16 a[226:227], v44 offset:41216
v_fma_f32 v57, v113, s35, v72
v_mfma_f32_16x16x32_bf16 v[140:143], a[228:231], v[84:87], v[140:143]
v_exp_f32 v56, v56
v_mfma_f32_16x16x32_bf16 v[144:147], a[232:235], v[80:83], v[144:147]
ds_read_b64_tr_b16 a[228:229], v45 offset:33024
v_fma_f32 v58, v114, s35, v72
v_mfma_f32_16x16x32_bf16 v[152:155], a[232:235], v[84:87], v[152:155]
v_exp_f32 v57, v57
v_mfma_f32_16x16x32_bf16 v[148:151], a[236:239], v[80:83], v[148:151]
buffer_load_dwordx4 v18, s[16:19], s33 offen offset:2048 nt lds
v_mfma_f32_16x16x32_bf16 v[156:159], a[236:239], v[84:87], v[156:159]
ds_read_b64_tr_b16 a[230:231], v45 offset:41216
v_fma_f32 v59, v115, s35, v72
v_mfma_f32_16x16x32_bf16 v[160:163], a[192:195], v[80:83], v[160:163]
v_exp_f32 v58, v58
v_mfma_f32_16x16x32_bf16 v[168:171], a[192:195], v[84:87], v[168:171]
ds_read_b64_tr_b16 a[232:233], v46 offset:33024
v_fma_f32 v60, v116, s35, v72
v_mfma_f32_16x16x32_bf16 v[164:167], a[196:199], v[80:83], v[164:167]
v_exp_f32 v59, v59
v_mfma_f32_16x16x32_bf16 v[172:175], a[196:199], v[84:87], v[172:175]
ds_read_b64_tr_b16 a[234:235], v46 offset:41216
v_fma_f32 v61, v117, s35, v72
v_mfma_f32_16x16x32_bf16 v[176:179], a[200:203], v[80:83], v[176:179]
s_waitcnt vmcnt(12)
ds_read_b64_tr_b16 a[236:237], v47 offset:33024
v_cvt_pk_bf16_f32 v88, v56, v57
v_mfma_f32_16x16x32_bf16 v[184:187], a[200:203], v[84:87], v[184:187]
v_exp_f32 v60, v60
v_mfma_f32_16x16x32_bf16 v[180:183], a[204:207], v[80:83], v[180:183]
ds_read_b64_tr_b16 a[238:239], v47 offset:41216
v_fma_f32 v62, v118, s35, v72
v_mfma_f32_16x16x32_bf16 v[188:191], a[204:207], v[84:87], v[188:191]
s_barrier
v_exp_f32 v61, v61
v_mfma_f32_16x16x32_bf16 v[192:195], a[208:211], v[80:83], v[192:195]
buffer_load_dwordx4 v19, s[16:19], s33 offen offset:3072 nt lds
v_mfma_f32_16x16x32_bf16 v[200:203], a[208:211], v[84:87], v[200:203]
s_waitcnt lgkmcnt(1)
ds_read_b128 a[192:195], v20 offset:0
v_fma_f32 v63, v119, s35, v72
v_mfma_f32_16x16x32_bf16 v[196:199], a[212:215], v[80:83], v[196:199]
s_add_u32 m0, s32, 65536
ds_read_b128 a[196:199], v20 offset:8192
v_cvt_pk_bf16_f32 v89, v58, v59
v_mfma_f32_16x16x32_bf16 v[204:207], a[212:215], v[84:87], v[204:207]
s_xor_b32 s33, s99, 196608
v_exp_f32 v62, v62
v_mfma_f32_16x16x32_bf16 v[208:211], a[216:219], v[80:83], v[208:211]
ds_read_b128 a[200:203], v21 offset:0
v_fma_f32 v56, v120, s35, v76
v_mfma_f32_16x16x32_bf16 v[216:219], a[216:219], v[84:87], v[216:219]
v_exp_f32 v63, v63
v_mfma_f32_16x16x32_bf16 v[212:215], a[220:223], v[80:83], v[212:215]
ds_read_b128 a[204:207], v21 offset:8192
v_fma_f32 v57, v121, s35, v76
v_mfma_f32_16x16x32_bf16 v[220:223], a[220:223], v[84:87], v[220:223]
ds_read_b128 a[208:211], v22 offset:0
v_cvt_pk_bf16_f32 v90, v60, v61
v_mfma_f32_16x16x32_bf16 v[224:227], a[224:227], v[80:83], v[224:227]
v_exp_f32 v56, v56
v_mfma_f32_16x16x32_bf16 v[232:235], a[224:227], v[84:87], v[232:235]
ds_read_b128 a[212:215], v22 offset:8192
v_fma_f32 v58, v122, s35, v76
v_mfma_f32_16x16x32_bf16 v[228:231], a[228:231], v[80:83], v[228:231]
buffer_load_dwordx4 v16, s[12:15], s33 offen offset:0 nt lds
v_mfma_f32_16x16x32_bf16 v[236:239], a[228:231], v[84:87], v[236:239]
v_exp_f32 v57, v57
v_mfma_f32_16x16x32_bf16 v[240:243], a[232:235], v[80:83], v[240:243]
ds_read_b128 a[216:219], v23 offset:0
v_fma_f32 v59, v123, s35, v76
v_mfma_f32_16x16x32_bf16 v[248:251], a[232:235], v[84:87], v[248:251]
s_waitcnt lgkmcnt(2)
ds_read_b128 a[220:223], v23 offset:8192
v_cvt_pk_bf16_f32 v91, v62, v63
v_mfma_f32_16x16x32_bf16 v[244:247], a[236:239], v[80:83], v[244:247]
v_exp_f32 v58, v58
v_mfma_f32_16x16x32_bf16 v[252:255], a[236:239], v[84:87], v[252:255]
ds_read_b128 a[224:227], v20 offset:256
v_fma_f32 v60, v124, s35, v76
v_mfma_f32_16x16x32_bf16 v[96:99], a[192:195], a[0:3], 0
v_exp_f32 v59, v59
v_mfma_f32_16x16x32_bf16 v[104:107], a[192:195], a[4:7], 0
ds_read_b128 a[228:231], v20 offset:8448
v_fma_f32 v61, v125, s35, v76
v_mfma_f32_16x16x32_bf16 v[100:103], a[196:199], a[0:3], 0
ds_read_b128 a[232:235], v21 offset:256
v_cvt_pk_bf16_f32 v92, v56, v57
v_mfma_f32_16x16x32_bf16 v[108:111], a[196:199], a[4:7], 0
v_exp_f32 v60, v60
v_mfma_f32_16x16x32_bf16 v[96:99], a[200:203], a[8:11], v[96:99]
buffer_load_dwordx4 v17, s[12:15], s33 offen offset:1024 nt lds
v_mfma_f32_16x16x32_bf16 v[104:107], a[200:203], a[12:15], v[104:107]
ds_read_b128 a[236:239], v21 offset:8448
v_fma_f32 v62, v126, s35, v76
v_mfma_f32_16x16x32_bf16 v[100:103], a[204:207], a[8:11], v[100:103]
v_exp_f32 v61, v61
v_mfma_f32_16x16x32_bf16 v[108:111], a[204:207], a[12:15], v[108:111]
ds_read_b128 a[192:195], v22 offset:256
v_fma_f32 v63, v127, s35, v76
v_mfma_f32_16x16x32_bf16 v[96:99], a[208:211], a[16:19], v[96:99]
ds_read_b128 a[196:199], v22 offset:8448
v_cvt_pk_bf16_f32 v93, v58, v59
v_mfma_f32_16x16x32_bf16 v[104:107], a[208:211], a[20:23], v[104:107]
s_waitcnt lgkmcnt(3)
v_exp_f32 v62, v62
v_mfma_f32_16x16x32_bf16 v[100:103], a[212:215], a[16:19], v[100:103]
s_waitcnt vmcnt(11)
v_exp_f32 v63, v63
v_mfma_f32_16x16x32_bf16 v[108:111], a[212:215], a[20:23], v[108:111]
ds_read_b128 a[200:203], v23 offset:256
v_cvt_pk_bf16_f32 v94, v60, v61
v_mfma_f32_16x16x32_bf16 v[96:99], a[216:219], a[24:27], v[96:99]
ds_read_b128 a[204:207], v23 offset:8448
v_cvt_pk_bf16_f32 v95, v62, v63
v_mfma_f32_16x16x32_bf16 v[104:107], a[216:219], a[28:31], v[104:107]
s_barrier
ds_read_b64_tr_b16 a[208:209], v40 offset:16384
v_or3_b32 v0, v88, v89, v90
v_mfma_f32_16x16x32_bf16 v[100:103], a[220:223], a[24:27], v[100:103]
LA_t34:
s_load_dword s98, s[96:97], 41400
buffer_load_dwordx4 v18, s[12:15], s33 offen offset:2048 nt lds
v_mfma_f32_16x16x32_bf16 v[108:111], a[220:223], a[28:31], v[108:111]
ds_read_b64_tr_b16 a[210:211], v40 offset:24576
v_or3_b32 v1, v91, v92, v93
v_mfma_f32_16x16x32_bf16 v[96:99], a[224:227], a[32:35], v[96:99]
ds_read_b64_tr_b16 a[212:213], v41 offset:16384
v_or3_b32 v0, v0, v94, v95
v_mfma_f32_16x16x32_bf16 v[104:107], a[224:227], a[36:39], v[104:107]
ds_read_b64_tr_b16 a[214:215], v41 offset:24576
v_bitop3_b32 v0, v0, v1, s36 bitop3:0xa8
v_mfma_f32_16x16x32_bf16 v[100:103], a[228:231], a[32:35], v[100:103]
ds_read_b64_tr_b16 a[216:217], v42 offset:16384
v_cmp_ne_u32 vcc, 0, v0
v_mfma_f32_16x16x32_bf16 v[108:111], a[228:231], a[36:39], v[108:111]
s_cbranch_vccnz LA_stub9
LA_back9:
ds_read_b64_tr_b16 a[218:219], v42 offset:24576
ds_read_b64_tr_b16 a[220:221], v43 offset:16384
v_mfma_f32_16x16x32_bf16 v[96:99], a[232:235], a[40:43], v[96:99]
s_cmp_eq_u32 s6, 3
s_cselect_b32 s63, 0x40000000, 0
ds_read_b64_tr_b16 a[222:223], v43 offset:24576
v_add_u32 v2, s63, v12
v_mfma_f32_16x16x32_bf16 v[104:107], a[232:235], a[44:47], v[104:107]
s_waitcnt lgkmcnt(5)
ds_read_b64_tr_b16 a[224:225], v44 offset:16384
v_accvgpr_write_b32 a175, v2
v_mfma_f32_16x16x32_bf16 v[100:103], a[236:239], a[40:43], v[100:103]
s_mov_b32 s72, s56
ds_read_b64_tr_b16 a[226:227], v44 offset:24576
ds_read_b64_tr_b16 a[228:229], v45 offset:16384
v_mfma_f32_16x16x32_bf16 v[108:111], a[236:239], a[44:47], v[108:111]
s_mov_b32 s73, s60
ds_read_b64_tr_b16 a[230:231], v45 offset:24576
ds_read_b64_tr_b16 a[232:233], v46 offset:16384
v_mfma_f32_16x16x32_bf16 v[96:99], a[192:195], a[48:51], v[96:99]
s_cmp_eq_u32 s6, 1
s_cselect_b32 s72, s57, s72
buffer_load_dwordx4 v19, s[12:15], s33 offen offset:3072 nt lds
v_mfma_f32_16x16x32_bf16 v[104:107], a[192:195], a[52:55], v[104:107]
s_add_u32 m0, s32, 49152
ds_read_b64_tr_b16 a[234:235], v46 offset:24576
ds_read_b64_tr_b16 a[236:237], v47 offset:16384
v_mfma_f32_16x16x32_bf16 v[100:103], a[196:199], a[48:51], v[100:103]
s_xor_b32 s33, s99, 180224
ds_read_b64_tr_b16 a[238:239], v47 offset:24576
ds_read_b64_tr_b16 a[192:193], v40 offset:16640
v_mfma_f32_16x16x32_bf16 v[108:111], a[196:199], a[52:55], v[108:111]
s_cmp_eq_u32 s6, 1
s_cselect_b32 s73, s61, s73
ds_read_b64_tr_b16 a[194:195], v40 offset:24832
ds_read_b64_tr_b16 a[196:197], v41 offset:16640
v_mfma_f32_16x16x32_bf16 v[96:99], a[200:203], a[56:59], v[96:99]
s_cmp_eq_u32 s6, 2
s_cselect_b32 s72, s58, s72
ds_read_b64_tr_b16 a[198:199], v41 offset:24832
v_mfma_f32_16x16x32_bf16 v[104:107], a[200:203], a[60:63], v[104:107]
s_cmp_eq_u32 s6, 2
s_cselect_b32 s73, s62, s73
ds_read_b64_tr_b16 a[200:201], v42 offset:16640
ds_read_b64_tr_b16 a[202:203], v42 offset:24832
v_mfma_f32_16x16x32_bf16 v[100:103], a[204:207], a[56:59], v[100:103]
s_cmp_eq_u32 s6, 3
s_cselect_b32 s72, s59, s72
v_mfma_f32_16x16x32_bf16 v[108:111], a[204:207], a[60:63], v[108:111]
s_cmp_eq_u32 s6, 3
s_cselect_b32 s73, 0x40000000, s73
ds_read_b64_tr_b16 a[204:205], v43 offset:16640
ds_read_b64_tr_b16 a[206:207], v43 offset:24832
v_mfma_f32_16x16x32_bf16 v[64:67], a[176:179], v[88:91], v[64:67]
v_mfma_f32_16x16x32_bf16 v[68:71], a[176:179], v[92:95], v[68:71]
v_mfma_f32_16x16x32_bf16 v[128:131], a[208:211], v[88:91], v[128:131]
buffer_load_dwordx4 v16, s[16:19], s33 offen offset:0 nt lds
v_mfma_f32_16x16x32_bf16 v[136:139], a[208:211], v[92:95], v[136:139]
s_waitcnt lgkmcnt(2)
ds_read_b64_tr_b16 a[208:209], v44 offset:16640
v_fma_f32 v56, v96, s35, v72
v_mfma_f32_16x16x32_bf16 v[132:135], a[212:215], v[88:91], v[132:135]
ds_read_b64_tr_b16 a[210:211], v44 offset:24832
v_fma_f32 v57, v97, s35, v72
v_mfma_f32_16x16x32_bf16 v[140:143], a[212:215], v[92:95], v[140:143]
v_exp_f32 v56, v56
v_mfma_f32_16x16x32_bf16 v[144:147], a[216:219], v[88:91], v[144:147]
ds_read_b64_tr_b16 a[212:213], v45 offset:16640
v_fma_f32 v58, v98, s35, v72
v_mfma_f32_16x16x32_bf16 v[152:155], a[216:219], v[92:95], v[152:155]
v_exp_f32 v57, v57
v_mfma_f32_16x16x32_bf16 v[148:151], a[220:223], v[88:91], v[148:151]
ds_read_b64_tr_b16 a[214:215], v45 offset:24832
v_fma_f32 v59, v99, s35, v72
v_mfma_f32_16x16x32_bf16 v[156:159], a[220:223], v[92:95], v[156:159]
v_exp_f32 v58, v58
v_mfma_f32_16x16x32_bf16 v[160:163], a[224:227], v[88:91], v[160:163]
ds_read_b64_tr_b16 a[216:217], v46 offset:16640
v_fma_f32 v60, v100, s35, v72
v_mfma_f32_16x16x32_bf16 v[168:171], a[224:227], v[92:95], v[168:171]
v_exp_f32 v59, v59
v_mfma_f32_16x16x32_bf16 v[164:167], a[228:231], v[88:91], v[164:167]
buffer_load_dwordx4 v17, s[16:19], s33 offen offset:1024 nt lds
v_mfma_f32_16x16x32_bf16 v[172:175], a[228:231], v[92:95], v[172:175]
ds_read_b64_tr_b16 a[218:219], v46 offset:24832
v_fma_f32 v61, v101, s35, v72
v_mfma_f32_16x16x32_bf16 v[176:179], a[232:235], v[88:91], v[176:179]
s_waitcnt vmcnt(11)
ds_read_b64_tr_b16 a[220:221], v47 offset:16640
v_cvt_pk_bf16_f32 v80, v56, v57
v_mfma_f32_16x16x32_bf16 v[184:187], a[232:235], v[92:95], v[184:187]
v_exp_f32 v60, v60
v_mfma_f32_16x16x32_bf16 v[180:183], a[236:239], v[88:91], v[180:183]
ds_read_b64_tr_b16 a[222:223], v47 offset:24832
v_fma_f32 v62, v102, s35, v72
v_mfma_f32_16x16x32_bf16 v[188:191], a[236:239], v[92:95], v[188:191]
s_barrier
v_exp_f32 v61, v61
v_mfma_f32_16x16x32_bf16 v[192:195], a[192:195], v[88:91], v[192:195]
ds_read_b128 a[224:227], v24 offset:49152
v_fma_f32 v63, v103, s35, v72
v_mfma_f32_16x16x32_bf16 v[200:203], a[192:195], v[92:95], v[200:203]
ds_read_b128 a[228:231], v24 offset:57344
v_cvt_pk_bf16_f32 v81, v58, v59
v_mfma_f32_16x16x32_bf16 v[196:199], a[196:199], v[88:91], v[196:199]
v_exp_f32 v62, v62
v_mfma_f32_16x16x32_bf16 v[204:207], a[196:199], v[92:95], v[204:207]
ds_read_b128 a[232:235], v25 offset:49152
v_fma_f32 v56, v104, s35, v76
v_mfma_f32_16x16x32_bf16 v[208:211], a[200:203], v[88:91], v[208:211]
buffer_load_dwordx4 v18, s[16:19], s33 offen offset:2048 nt lds
v_mfma_f32_16x16x32_bf16 v[216:219], a[200:203], v[92:95], v[216:219]
s_waitcnt lgkmcnt(2)
v_exp_f32 v63, v63
v_mfma_f32_16x16x32_bf16 v[212:215], a[204:207], v[88:91], v[212:215]
ds_read_b128 a[236:239], v25 offset:57344
v_fma_f32 v57, v105, s35, v76
v_mfma_f32_16x16x32_bf16 v[220:223], a[204:207], v[92:95], v[220:223]
ds_read_b128 a[192:195], v26 offset:49152
v_cvt_pk_bf16_f32 v82, v60, v61
v_mfma_f32_16x16x32_bf16 v[224:227], a[208:211], v[88:91], v[224:227]
v_exp_f32 v56, v56
v_mfma_f32_16x16x32_bf16 v[232:235], a[208:211], v[92:95], v[232:235]
ds_read_b128 a[196:199], v26 offset:57344
v_fma_f32 v58, v106, s35, v76
v_mfma_f32_16x16x32_bf16 v[228:231], a[212:215], v[88:91], v[228:231]
v_exp_f32 v57, v57
v_mfma_f32_16x16x32_bf16 v[236:239], a[212:215], v[92:95], v[236:239]
ds_read_b128 a[200:203], v27 offset:49152
v_fma_f32 v59, v107, s35, v76
v_mfma_f32_16x16x32_bf16 v[240:243], a[216:219], v[88:91], v[240:243]
ds_read_b128 a[204:207], v27 offset:57344
v_cvt_pk_bf16_f32 v83, v62, v63
v_mfma_f32_16x16x32_bf16 v[248:251], a[216:219], v[92:95], v[248:251]
v_exp_f32 v58, v58
v_mfma_f32_16x16x32_bf16 v[244:247], a[220:223], v[88:91], v[244:247]
buffer_load_dwordx4 v19, s[16:19], s33 offen offset:3072 nt lds
v_mfma_f32_16x16x32_bf16 v[252:255], a[220:223], v[92:95], v[252:255]
s_add_u32 m0, s32, 147456
ds_read_b128 a[208:211], v24 offset:49408
v_fma_f32 v60, v108, s35, v76
v_mfma_f32_16x16x32_bf16 v[112:115], a[224:227], a[0:3], 0
s_xor_b32 s33, s99, 212992
v_exp_f32 v59, v59
v_mfma_f32_16x16x32_bf16 v[120:123], a[224:227], a[4:7], 0
s_waitcnt lgkmcnt(1)
ds_read_b128 a[212:215], v24 offset:57600
v_fma_f32 v61, v109, s35, v76
v_mfma_f32_16x16x32_bf16 v[116:119], a[228:231], a[0:3], 0
ds_read_b128 a[216:219], v25 offset:49408
v_cvt_pk_bf16_f32 v84, v56, v57
v_mfma_f32_16x16x32_bf16 v[124:127], a[228:231], a[4:7], 0
v_exp_f32 v60, v60
v_mfma_f32_16x16x32_bf16 v[112:115], a[232:235], a[8:11], v[112:115]
ds_read_b128 a[220:223], v25 offset:57600
v_fma_f32 v62, v110, s35, v76
v_mfma_f32_16x16x32_bf16 v[120:123], a[232:235], a[12:15], v[120:123]
v_exp_f32 v61, v61
v_mfma_f32_16x16x32_bf16 v[116:119], a[236:239], a[8:11], v[116:119]
ds_read_b128 a[224:227], v26 offset:49408
v_fma_f32 v63, v111, s35, v76
v_mfma_f32_16x16x32_bf16 v[124:127], a[236:239], a[12:15], v[124:127]
ds_read_b128 a[228:231], v26 offset:57600
v_cvt_pk_bf16_f32 v85, v58, v59
v_mfma_f32_16x16x32_bf16 v[112:115], a[192:195], a[16:19], v[112:115]
s_waitcnt vmcnt(8)
buffer_load_dwordx4 v16, s[12:15], s33 offen offset:0 nt lds
v_mfma_f32_16x16x32_bf16 v[120:123], a[192:195], a[20:23], v[120:123]
v_exp_f32 v62, v62
v_mfma_f32_16x16x32_bf16 v[116:119], a[196:199], a[16:19], v[116:119]
v_exp_f32 v63, v63
v_mfma_f32_16x16x32_bf16 v[124:127], a[196:199], a[20:23], v[124:127]
ds_read_b128 a[232:235], v27 offset:49408
v_cvt_pk_bf16_f32 v86, v60, v61
v_mfma_f32_16x16x32_bf16 v[112:115], a[200:203], a[24:27], v[112:115]
ds_read_b128 a[236:239], v27 offset:57600
v_cvt_pk_bf16_f32 v87, v62, v63
v_mfma_f32_16x16x32_bf16 v[120:123], a[200:203], a[28:31], v[120:123]
s_barrier
ds_read_b64_tr_b16 a[192:193], v48 offset:0
v_or3_b32 v0, v80, v81, v82
v_mfma_f32_16x16x32_bf16 v[116:119], a[204:207], a[24:27], v[116:119]
LA_t36:
s_load_dword s98, s[96:97], 42812
ds_read_b64_tr_b16 a[194:195], v48 offset:8192
v_or3_b32 v1, v83, v84, v85
v_mfma_f32_16x16x32_bf16 v[124:127], a[204:207], a[28:31], v[124:127]
s_waitcnt lgkmcnt(4)
ds_read_b64_tr_b16 a[196:197], v49 offset:0
v_or3_b32 v0, v0, v86, v87
v_mfma_f32_16x16x32_bf16 v[112:115], a[208:211], a[32:35], v[112:115]
ds_read_b64_tr_b16 a[198:199], v49 offset:8192
v_bitop3_b32 v0, v0, v1, s36 bitop3:0xa8
v_mfma_f32_16x16x32_bf16 v[120:123], a[208:211], a[36:39], v[120:123]
ds_read_b64_tr_b16 a[200:201], v50 offset:0
v_cmp_ne_u32 vcc, 0, v0
v_mfma_f32_16x16x32_bf16 v[116:119], a[212:215], a[32:35], v[116:119]
s_cbranch_vccnz LA_stub10
LA_back10:
buffer_load_dwordx4 v17, s[12:15], s33 offen offset:1024 nt lds
v_mfma_f32_16x16x32_bf16 v[124:127], a[212:215], a[36:39], v[124:127]
ds_read_b64_tr_b16 a[202:203], v50 offset:8192
v_mbcnt_lo_u32_b32 v2, -1, 0
v_mfma_f32_16x16x32_bf16 v[112:115], a[216:219], a[40:43], v[112:115]
ds_read_b64_tr_b16 a[204:205], v51 offset:0
v_mbcnt_hi_u32_b32 v2, -1, v2
v_mfma_f32_16x16x32_bf16 v[120:123], a[216:219], a[44:47], v[120:123]
ds_read_b64_tr_b16 a[206:207], v51 offset:8192
v_lshlrev_b32 v2, 4, v2
v_mfma_f32_16x16x32_bf16 v[116:119], a[220:223], a[40:43], v[116:119]
s_cmp_eq_u32 s6, 0
s_cselect_b32 s63, 0, 8192
ds_read_b64_tr_b16 a[208:209], v52 offset:0
ds_read_b64_tr_b16 a[210:211], v52 offset:8192
v_mfma_f32_16x16x32_bf16 v[124:127], a[220:223], a[44:47], v[124:127]
s_add_u32 s63, s63, 147456
ds_read_b64_tr_b16 a[212:213], v53 offset:0
v_add_u32 v3, s63, v2
v_mfma_f32_16x16x32_bf16 v[112:115], a[224:227], a[48:51], v[112:115]
ds_read_b64_tr_b16 a[214:215], v53 offset:8192
v_accvgpr_write_b32 a174, v3
v_mfma_f32_16x16x32_bf16 v[120:123], a[224:227], a[52:55], v[120:123]
s_lshl_b32 s63, s6, 10
s_add_u32 s63, s63, 147456
ds_read_b64_tr_b16 a[216:217], v54 offset:0
v_add_u32 v3, s63, v2
v_mfma_f32_16x16x32_bf16 v[116:119], a[228:231], a[48:51], v[116:119]
ds_read_b64_tr_b16 a[218:219], v54 offset:8192
v_accvgpr_write_b32 a173, v3
v_mfma_f32_16x16x32_bf16 v[124:127], a[228:231], a[52:55], v[124:127]
s_waitcnt lgkmcnt(4)
ds_read_b64_tr_b16 a[220:221], v55 offset:0
ds_read_b64_tr_b16 a[222:223], v55 offset:8192
v_mfma_f32_16x16x32_bf16 v[112:115], a[232:235], a[56:59], v[112:115]
s_cmp_eq_u32 s6, 0
s_cselect_b32 s77, 0x40000000, 0
buffer_load_dwordx4 v18, s[12:15], s33 offen offset:2048 nt lds
v_mfma_f32_16x16x32_bf16 v[120:123], a[232:235], a[60:63], v[120:123]
ds_read_b64_tr_b16 a[224:225], v48 offset:256
ds_read_b64_tr_b16 a[226:227], v48 offset:8448
v_mfma_f32_16x16x32_bf16 v[116:119], a[236:239], a[56:59], v[116:119]
ds_read_b64_tr_b16 a[228:229], v49 offset:256
ds_read_b64_tr_b16 a[230:231], v49 offset:8448
v_mfma_f32_16x16x32_bf16 v[124:127], a[236:239], a[60:63], v[124:127]
ds_read_b64_tr_b16 a[232:233], v50 offset:256
ds_read_b64_tr_b16 a[234:235], v50 offset:8448
v_mfma_f32_16x16x32_bf16 v[64:67], a[176:179], v[80:83], v[64:67]
ds_read_b64_tr_b16 a[236:237], v51 offset:256
ds_read_b64_tr_b16 a[238:239], v51 offset:8448
v_mfma_f32_16x16x32_bf16 v[68:71], a[176:179], v[84:87], v[68:71]
v_mfma_f32_16x16x32_bf16 v[128:131], a[192:195], v[80:83], v[128:131]
v_mfma_f32_16x16x32_bf16 v[136:139], a[192:195], v[84:87], v[136:139]
ds_read_b64_tr_b16 a[192:193], v52 offset:256
v_fma_f32 v56, v112, s35, v72
v_mfma_f32_16x16x32_bf16 v[132:135], a[196:199], v[80:83], v[132:135]
ds_read_b64_tr_b16 a[194:195], v52 offset:8448
v_fma_f32 v57, v113, s35, v72
v_mfma_f32_16x16x32_bf16 v[140:143], a[196:199], v[84:87], v[140:143]
v_exp_f32 v56, v56
v_mfma_f32_16x16x32_bf16 v[144:147], a[200:203], v[80:83], v[144:147]
buffer_load_dwordx4 v19, s[12:15], s33 offen offset:3072 nt lds
v_mfma_f32_16x16x32_bf16 v[152:155], a[200:203], v[84:87], v[152:155]
s_add_u32 m0, s32, 32768
ds_read_b64_tr_b16 a[196:197], v53 offset:256
v_fma_f32 v58, v114, s35, v72
v_mfma_f32_16x16x32_bf16 v[148:151], a[204:207], v[80:83], v[148:151]
s_xor_b32 s33, s99, 196608
v_exp_f32 v57, v57
v_mfma_f32_16x16x32_bf16 v[156:159], a[204:207], v[84:87], v[156:159]
ds_read_b64_tr_b16 a[198:199], v53 offset:8448
v_fma_f32 v59, v115, s35, v72
v_mfma_f32_16x16x32_bf16 v[160:163], a[208:211], v[80:83], v[160:163]
v_exp_f32 v58, v58
v_mfma_f32_16x16x32_bf16 v[168:171], a[208:211], v[84:87], v[168:171]
s_waitcnt lgkmcnt(2)
ds_read_b64_tr_b16 a[200:201], v54 offset:256
v_fma_f32 v60, v116, s35, v72
v_mfma_f32_16x16x32_bf16 v[164:167], a[212:215], v[80:83], v[164:167]
v_exp_f32 v59, v59
v_mfma_f32_16x16x32_bf16 v[172:175], a[212:215], v[84:87], v[172:175]
ds_read_b64_tr_b16 a[202:203], v54 offset:8448
v_fma_f32 v61, v117, s35, v72
v_mfma_f32_16x16x32_bf16 v[176:179], a[216:219], v[80:83], v[176:179]
s_waitcnt vmcnt(8)
ds_read_b64_tr_b16 a[204:205], v55 offset:256
v_cvt_pk_bf16_f32 v88, v56, v57
v_mfma_f32_16x16x32_bf16 v[184:187], a[216:219], v[84:87], v[184:187]
v_exp_f32 v60, v60
v_mfma_f32_16x16x32_bf16 v[180:183], a[220:223], v[80:83], v[180:183]
buffer_load_dwordx4 v16, s[16:19], s33 offen offset:0 nt lds
v_mfma_f32_16x16x32_bf16 v[188:191], a[220:223], v[84:87], v[188:191]
ds_read_b64_tr_b16 a[206:207], v55 offset:8448
v_fma_f32 v62, v118, s35, v72
v_mfma_f32_16x16x32_bf16 v[192:195], a[224:227], v[80:83], v[192:195]
s_barrier
v_exp_f32 v61, v61
v_mfma_f32_16x16x32_bf16 v[200:203], a[224:227], v[84:87], v[200:203]
ds_read_b128 a[208:211], v24 offset:0
v_fma_f32 v63, v119, s35, v72
v_mfma_f32_16x16x32_bf16 v[196:199], a[228:231], v[80:83], v[196:199]
ds_read_b128 a[212:215], v24 offset:8192
v_cvt_pk_bf16_f32 v89, v58, v59
v_mfma_f32_16x16x32_bf16 v[204:207], a[228:231], v[84:87], v[204:207]
v_exp_f32 v62, v62
v_mfma_f32_16x16x32_bf16 v[208:211], a[232:235], v[80:83], v[208:211]
ds_read_b128 a[216:219], v25 offset:0
v_fma_f32 v56, v120, s35, v76
v_mfma_f32_16x16x32_bf16 v[216:219], a[232:235], v[84:87], v[216:219]
v_exp_f32 v63, v63
v_mfma_f32_16x16x32_bf16 v[212:215], a[236:239], v[80:83], v[212:215]
ds_read_b128 a[220:223], v25 offset:8192
v_fma_f32 v57, v121, s35, v76
v_mfma_f32_16x16x32_bf16 v[220:223], a[236:239], v[84:87], v[220:223]
ds_read_b128 a[224:227], v26 offset:0
v_cvt_pk_bf16_f32 v90, v60, v61
v_mfma_f32_16x16x32_bf16 v[224:227], a[192:195], v[80:83], v[224:227]
buffer_load_dwordx4 v17, s[16:19], s33 offen offset:1024 nt lds
v_mfma_f32_16x16x32_bf16 v[232:235], a[192:195], v[84:87], v[232:235]
s_waitcnt lgkmcnt(2)
v_exp_f32 v56, v56
v_mfma_f32_16x16x32_bf16 v[228:231], a[196:199], v[80:83], v[228:231]
ds_read_b128 a[228:231], v26 offset:8192
v_fma_f32 v58, v122, s35, v76
v_mfma_f32_16x16x32_bf16 v[236:239], a[196:199], v[84:87], v[236:239]
v_exp_f32 v57, v57
v_mfma_f32_16x16x32_bf16 v[240:243], a[200:203], v[80:83], v[240:243]
ds_read_b128 a[232:235], v27 offset:0
v_fma_f32 v59, v123, s35, v76
v_mfma_f32_16x16x32_bf16 v[248:251], a[200:203], v[84:87], v[248:251]
ds_read_b128 a[236:239], v27 offset:8192
v_cvt_pk_bf16_f32 v91, v62, v63
v_mfma_f32_16x16x32_bf16 v[244:247], a[204:207], v[80:83], v[244:247]
v_exp_f32 v58, v58
v_mfma_f32_16x16x32_bf16 v[252:255], a[204:207], v[84:87], v[252:255]
ds_read_b128 a[192:195], v24 offset:256
v_fma_f32 v60, v124, s35, v76
v_mfma_f32_16x16x32_bf16 v[96:99], a[208:211], a[0:3], 0
v_exp_f32 v59, v59
v_mfma_f32_16x16x32_bf16 v[104:107], a[208:211], a[4:7], 0
ds_read_b128 a[196:199], v24 offset:8448
v_fma_f32 v61, v125, s35, v76
v_mfma_f32_16x16x32_bf16 v[100:103], a[212:215], a[0:3], 0
buffer_load_dwordx4 v18, s[16:19], s33 offen offset:2048 nt lds
v_mfma_f32_16x16x32_bf16 v[108:111], a[212:215], a[4:7], 0
ds_read_b128 a[200:203], v25 offset:256
v_cvt_pk_bf16_f32 v92, v56, v57
v_mfma_f32_16x16x32_bf16 v[96:99], a[216:219], a[8:11], v[96:99]
v_exp_f32 v60, v60
v_mfma_f32_16x16x32_bf16 v[104:107], a[216:219], a[12:15], v[104:107]
s_waitcnt lgkmcnt(2)
ds_read_b128 a[204:207], v25 offset:8448
v_fma_f32 v62, v126, s35, v76
v_mfma_f32_16x16x32_bf16 v[100:103], a[220:223], a[8:11], v[100:103]
v_exp_f32 v61, v61
v_mfma_f32_16x16x32_bf16 v[108:111], a[220:223], a[12:15], v[108:111]
ds_read_b128 a[208:211], v26 offset:256
v_fma_f32 v63, v127, s35, v76
v_mfma_f32_16x16x32_bf16 v[96:99], a[224:227], a[16:19], v[96:99]
ds_read_b128 a[212:215], v26 offset:8448
v_cvt_pk_bf16_f32 v93, v58, v59
v_mfma_f32_16x16x32_bf16 v[104:107], a[224:227], a[20:23], v[104:107]
s_waitcnt vmcnt(7)
v_exp_f32 v62, v62
v_mfma_f32_16x16x32_bf16 v[100:103], a[228:231], a[16:19], v[100:103]
v_exp_f32 v63, v63
v_mfma_f32_16x16x32_bf16 v[108:111], a[228:231], a[20:23], v[108:111]
ds_read_b128 a[216:219], v27 offset:256
v_cvt_pk_bf16_f32 v94, v60, v61
v_mfma_f32_16x16x32_bf16 v[96:99], a[232:235], a[24:27], v[96:99]
buffer_load_dwordx4 v19, s[16:19], s33 offen offset:3072 nt lds
v_mfma_f32_16x16x32_bf16 v[104:107], a[232:235], a[28:31], v[104:107]
s_add_u32 m0, s32, 16384
ds_read_b128 a[220:223], v27 offset:8448
v_cvt_pk_bf16_f32 v95, v62, v63
v_mfma_f32_16x16x32_bf16 v[100:103], a[236:239], a[24:27], v[100:103]
s_barrier
ds_read_b64_tr_b16 a[224:225], v32 offset:49152
v_or3_b32 v0, v88, v89, v90
v_mfma_f32_16x16x32_bf16 v[108:111], a[236:239], a[28:31], v[108:111]
LA_t38:
s_load_dword s98, s[96:97], 44236
ds_read_b64_tr_b16 a[226:227], v32 offset:57344
v_or3_b32 v1, v91, v92, v93
v_mfma_f32_16x16x32_bf16 v[96:99], a[192:195], a[32:35], v[96:99]
s_xor_b32 s33, s99, 229376
ds_read_b64_tr_b16 a[228:229], v33 offset:49152
v_or3_b32 v0, v0, v94, v95
v_mfma_f32_16x16x32_bf16 v[104:107], a[192:195], a[36:39], v[104:107]
s_waitcnt lgkmcnt(4)
ds_read_b64_tr_b16 a[230:231], v33 offset:57344
v_bitop3_b32 v0, v0, v1, s36 bitop3:0xa8
v_mfma_f32_16x16x32_bf16 v[100:103], a[196:199], a[32:35], v[100:103]
ds_read_b64_tr_b16 a[232:233], v34 offset:49152
v_cmp_ne_u32 vcc, 0, v0
v_mfma_f32_16x16x32_bf16 v[108:111], a[196:199], a[36:39], v[108:111]
s_cbranch_vccnz LA_stub11
LA_back11:
ds_read_b64_tr_b16 a[234:235], v34 offset:57344
ds_read_b64_tr_b16 a[236:237], v35 offset:49152
v_mfma_f32_16x16x32_bf16 v[96:99], a[200:203], a[40:43], v[96:99]
ds_read_b64_tr_b16 a[238:239], v35 offset:57344
ds_read_b64_tr_b16 a[192:193], v36 offset:49152
v_mfma_f32_16x16x32_bf16 v[104:107], a[200:203], a[44:47], v[104:107]
ds_read_b64_tr_b16 a[194:195], v36 offset:57344
ds_read_b64_tr_b16 a[196:197], v37 offset:49152
v_mfma_f32_16x16x32_bf16 v[100:103], a[204:207], a[40:43], v[100:103]
buffer_load_dwordx4 v16, s[12:15], s33 offen offset:0 nt lds
v_mfma_f32_16x16x32_bf16 v[108:111], a[204:207], a[44:47], v[108:111]
ds_read_b64_tr_b16 a[198:199], v37 offset:57344
ds_read_b64_tr_b16 a[200:201], v38 offset:49152
v_mfma_f32_16x16x32_bf16 v[96:99], a[208:211], a[48:51], v[96:99]
ds_read_b64_tr_b16 a[202:203], v38 offset:57344
ds_read_b64_tr_b16 a[204:205], v39 offset:49152
v_mfma_f32_16x16x32_bf16 v[104:107], a[208:211], a[52:55], v[104:107]
ds_read_b64_tr_b16 a[206:207], v39 offset:57344
ds_read_b64_tr_b16 a[208:209], v32 offset:49408
v_mfma_f32_16x16x32_bf16 v[100:103], a[212:215], a[48:51], v[100:103]
ds_read_b64_tr_b16 a[210:211], v32 offset:57600
v_mfma_f32_16x16x32_bf16 v[108:111], a[212:215], a[52:55], v[108:111]
ds_read_b64_tr_b16 a[212:213], v33 offset:49408
ds_read_b64_tr_b16 a[214:215], v33 offset:57600
v_mfma_f32_16x16x32_bf16 v[96:99], a[216:219], a[56:59], v[96:99]
v_mfma_f32_16x16x32_bf16 v[104:107], a[216:219], a[60:63], v[104:107]
s_waitcnt lgkmcnt(5)
ds_read_b64_tr_b16 a[216:217], v34 offset:49408
ds_read_b64_tr_b16 a[218:219], v34 offset:57600
v_mfma_f32_16x16x32_bf16 v[100:103], a[220:223], a[56:59], v[100:103]
v_mfma_f32_16x16x32_bf16 v[108:111], a[220:223], a[60:63], v[108:111]
ds_read_b64_tr_b16 a[220:221], v35 offset:49408
ds_read_b64_tr_b16 a[222:223], v35 offset:57600
v_mfma_f32_16x16x32_bf16 v[64:67], a[176:179], v[88:91], v[64:67]
buffer_load_dwordx4 v17, s[12:15], s33 offen offset:1024 nt lds
v_mfma_f32_16x16x32_bf16 v[68:71], a[176:179], v[92:95], v[68:71]
v_mfma_f32_16x16x32_bf16 v[128:131], a[224:227], v[88:91], v[128:131]
v_mfma_f32_16x16x32_bf16 v[136:139], a[224:227], v[92:95], v[136:139]
ds_read_b64_tr_b16 a[224:225], v36 offset:49408
v_fma_f32 v56, v96, s35, v72
v_mfma_f32_16x16x32_bf16 v[132:135], a[228:231], v[88:91], v[132:135]
ds_read_b64_tr_b16 a[226:227], v36 offset:57600
v_fma_f32 v57, v97, s35, v72
v_mfma_f32_16x16x32_bf16 v[140:143], a[228:231], v[92:95], v[140:143]
v_exp_f32 v56, v56
v_mfma_f32_16x16x32_bf16 v[144:147], a[232:235], v[88:91], v[144:147]
ds_read_b64_tr_b16 a[228:229], v37 offset:49408
v_fma_f32 v58, v98, s35, v72
v_mfma_f32_16x16x32_bf16 v[152:155], a[232:235], v[92:95], v[152:155]
v_exp_f32 v57, v57
v_mfma_f32_16x16x32_bf16 v[148:151], a[236:239], v[88:91], v[148:151]
ds_read_b64_tr_b16 a[230:231], v37 offset:57600
v_fma_f32 v59, v99, s35, v72
v_mfma_f32_16x16x32_bf16 v[156:159], a[236:239], v[92:95], v[156:159]
v_exp_f32 v58, v58
v_mfma_f32_16x16x32_bf16 v[160:163], a[192:195], v[88:91], v[160:163]
buffer_load_dwordx4 v18, s[12:15], s33 offen offset:2048 nt lds
v_mfma_f32_16x16x32_bf16 v[168:171], a[192:195], v[92:95], v[168:171]
ds_read_b64_tr_b16 a[232:233], v38 offset:49408
v_fma_f32 v60, v100, s35, v72
v_mfma_f32_16x16x32_bf16 v[164:167], a[196:199], v[88:91], v[164:167]
v_exp_f32 v59, v59
v_mfma_f32_16x16x32_bf16 v[172:175], a[196:199], v[92:95], v[172:175]
ds_read_b64_tr_b16 a[234:235], v38 offset:57600
v_fma_f32 v61, v101, s35, v72
v_mfma_f32_16x16x32_bf16 v[176:179], a[200:203], v[88:91], v[176:179]
s_waitcnt vmcnt(7)
ds_read_b64_tr_b16 a[236:237], v39 offset:49408
v_cvt_pk_bf16_f32 v80, v56, v57
v_mfma_f32_16x16x32_bf16 v[184:187], a[200:203], v[92:95], v[184:187]
s_waitcnt lgkmcnt(3)
v_exp_f32 v60, v60
v_mfma_f32_16x16x32_bf16 v[180:183], a[204:207], v[88:91], v[180:183]
ds_read_b64_tr_b16 a[238:239], v39 offset:57600
v_fma_f32 v62, v102, s35, v72
v_mfma_f32_16x16x32_bf16 v[188:191], a[204:207], v[92:95], v[188:191]
s_barrier
v_exp_f32 v61, v61
v_mfma_f32_16x16x32_bf16 v[192:195], a[208:211], v[88:91], v[192:195]
ds_read_b128 a[192:195], v28 offset:16384
v_fma_f32 v63, v103, s35, v72
v_mfma_f32_16x16x32_bf16 v[200:203], a[208:211], v[92:95], v[200:203]
ds_read_b128 a[196:199], v28 offset:24576
v_cvt_pk_bf16_f32 v81, v58, v59
v_mfma_f32_16x16x32_bf16 v[196:199], a[212:215], v[88:91], v[196:199]
buffer_load_dwordx4 v19, s[12:15], s33 offen offset:3072 nt lds
v_mfma_f32_16x16x32_bf16 v[204:207], a[212:215], v[92:95], v[204:207]
s_add_u32 m0, s32, 98304
v_exp_f32 v62, v62
v_mfma_f32_16x16x32_bf16 v[208:211], a[216:219], v[88:91], v[208:211]
s_xor_b32 s33, s99, 212992
ds_read_b128 a[200:203], v29 offset:16384
v_fma_f32 v56, v104, s35, v76
v_mfma_f32_16x16x32_bf16 v[216:219], a[216:219], v[92:95], v[216:219]
v_exp_f32 v63, v63
v_mfma_f32_16x16x32_bf16 v[212:215], a[220:223], v[88:91], v[212:215]
ds_read_b128 a[204:207], v29 offset:24576
v_fma_f32 v57, v105, s35, v76
v_mfma_f32_16x16x32_bf16 v[220:223], a[220:223], v[92:95], v[220:223]
ds_read_b128 a[208:211], v30 offset:16384
v_cvt_pk_bf16_f32 v82, v60, v61
v_mfma_f32_16x16x32_bf16 v[224:227], a[224:227], v[88:91], v[224:227]
v_exp_f32 v56, v56
v_mfma_f32_16x16x32_bf16 v[232:235], a[224:227], v[92:95], v[232:235]
ds_read_b128 a[212:215], v30 offset:24576
v_fma_f32 v58, v106, s35, v76
v_mfma_f32_16x16x32_bf16 v[228:231], a[228:231], v[88:91], v[228:231]
v_exp_f32 v57, v57
v_mfma_f32_16x16x32_bf16 v[236:239], a[228:231], v[92:95], v[236:239]
s_waitcnt lgkmcnt(2)
ds_read_b128 a[216:219], v31 offset:16384
v_fma_f32 v59, v107, s35, v76
v_mfma_f32_16x16x32_bf16 v[240:243], a[232:235], v[88:91], v[240:243]
buffer_load_dwordx4 v16, s[16:19], s33 offen offset:0 nt lds
v_mfma_f32_16x16x32_bf16 v[248:251], a[232:235], v[92:95], v[248:251]
ds_read_b128 a[220:223], v31 offset:24576
v_cvt_pk_bf16_f32 v83, v62, v63
v_mfma_f32_16x16x32_bf16 v[244:247], a[236:239], v[88:91], v[244:247]
v_exp_f32 v58, v58
v_mfma_f32_16x16x32_bf16 v[252:255], a[236:239], v[92:95], v[252:255]
ds_read_b128 a[224:227], v28 offset:16640
v_fma_f32 v60, v108, s35, v76
v_mfma_f32_16x16x32_bf16 v[112:115], a[192:195], a[0:3], 0
v_exp_f32 v59, v59
v_mfma_f32_16x16x32_bf16 v[120:123], a[192:195], a[4:7], 0
ds_read_b128 a[228:231], v28 offset:24832
v_fma_f32 v61, v109, s35, v76
v_mfma_f32_16x16x32_bf16 v[116:119], a[196:199], a[0:3], 0
ds_read_b128 a[232:235], v29 offset:16640
v_cvt_pk_bf16_f32 v84, v56, v57
v_mfma_f32_16x16x32_bf16 v[124:127], a[196:199], a[4:7], 0
v_exp_f32 v60, v60
v_mfma_f32_16x16x32_bf16 v[112:115], a[200:203], a[8:11], v[112:115]
ds_read_b128 a[236:239], v29 offset:24832
v_fma_f32 v62, v110, s35, v76
v_mfma_f32_16x16x32_bf16 v[120:123], a[200:203], a[12:15], v[120:123]
v_exp_f32 v61, v61
v_mfma_f32_16x16x32_bf16 v[116:119], a[204:207], a[8:11], v[116:119]
buffer_load_dwordx4 v17, s[16:19], s33 offen offset:1024 nt lds
v_mfma_f32_16x16x32_bf16 v[124:127], a[204:207], a[12:15], v[124:127]
s_waitcnt lgkmcnt(1)
ds_read_b128 a[192:195], v30 offset:16640
v_fma_f32 v63, v111, s35, v76
v_mfma_f32_16x16x32_bf16 v[112:115], a[208:211], a[16:19], v[112:115]
ds_read_b128 a[196:199], v30 offset:24832
v_cvt_pk_bf16_f32 v85, v58, v59
v_mfma_f32_16x16x32_bf16 v[120:123], a[208:211], a[20:23], v[120:123]
s_waitcnt vmcnt(6)
v_exp_f32 v62, v62
v_mfma_f32_16x16x32_bf16 v[116:119], a[212:215], a[16:19], v[116:119]
v_exp_f32 v63, v63
v_mfma_f32_16x16x32_bf16 v[124:127], a[212:215], a[20:23], v[124:127]
ds_read_b128 a[200:203], v31 offset:16640
v_cvt_pk_bf16_f32 v86, v60, v61
v_mfma_f32_16x16x32_bf16 v[112:115], a[216:219], a[24:27], v[112:115]
ds_read_b128 a[204:207], v31 offset:24832
v_cvt_pk_bf16_f32 v87, v62, v63
v_mfma_f32_16x16x32_bf16 v[120:123], a[216:219], a[28:31], v[120:123]
s_barrier
ds_read_b64_tr_b16 a[208:209], v32 offset:32768
v_or3_b32 v0, v80, v81, v82
v_mfma_f32_16x16x32_bf16 v[116:119], a[220:223], a[24:27], v[116:119]
LA_t40:
s_load_dword s98, s[96:97], 44852
ds_read_b64_tr_b16 a[210:211], v32 offset:40960
v_or3_b32 v1, v83, v84, v85
v_mfma_f32_16x16x32_bf16 v[124:127], a[220:223], a[28:31], v[124:127]
ds_read_b64_tr_b16 a[212:213], v33 offset:32768
v_or3_b32 v0, v0, v86, v87
v_mfma_f32_16x16x32_bf16 v[112:115], a[224:227], a[32:35], v[112:115]
buffer_load_dwordx4 v18, s[16:19], s33 offen offset:2048 nt lds
v_mfma_f32_16x16x32_bf16 v[120:123], a[224:227], a[36:39], v[120:123]
ds_read_b64_tr_b16 a[214:215], v33 offset:40960
v_bitop3_b32 v0, v0, v1, s36 bitop3:0xa8
v_mfma_f32_16x16x32_bf16 v[116:119], a[228:231], a[32:35], v[116:119]
ds_read_b64_tr_b16 a[216:217], v34 offset:32768
v_cmp_ne_u32 vcc, 0, v0
v_mfma_f32_16x16x32_bf16 v[124:127], a[228:231], a[36:39], v[124:127]
s_cbranch_vccnz LA_stub12
LA_back12:
ds_read_b64_tr_b16 a[218:219], v34 offset:40960
ds_read_b64_tr_b16 a[220:221], v35 offset:32768
v_mfma_f32_16x16x32_bf16 v[112:115], a[232:235], a[40:43], v[112:115]
ds_read_b64_tr_b16 a[222:223], v35 offset:40960
v_cmp_eq_u64 vcc, 0, v[6:7]
v_mfma_f32_16x16x32_bf16 v[120:123], a[232:235], a[44:47], v[120:123]
s_waitcnt lgkmcnt(5)
ds_read_b64_tr_b16 a[224:225], v36 offset:32768
ds_read_b64_tr_b16 a[226:227], v36 offset:40960
v_mfma_f32_16x16x32_bf16 v[116:119], a[236:239], a[40:43], v[116:119]
s_cbranch_vccnz LA_renonce
LA_nonced:
ds_read_b64_tr_b16 a[228:229], v37 offset:32768
ds_read_b64_tr_b16 a[230:231], v37 offset:40960
v_mfma_f32_16x16x32_bf16 v[124:127], a[236:239], a[44:47], v[124:127]
ds_read_b64_tr_b16 a[232:233], v38 offset:32768
ds_read_b64_tr_b16 a[234:235], v38 offset:40960
v_mfma_f32_16x16x32_bf16 v[112:115], a[192:195], a[48:51], v[112:115]
ds_read_b64_tr_b16 a[236:237], v39 offset:32768
ds_read_b64_tr_b16 a[238:239], v39 offset:40960
v_mfma_f32_16x16x32_bf16 v[120:123], a[192:195], a[52:55], v[120:123]
ds_read_b64_tr_b16 a[192:193], v32 offset:33024
ds_read_b64_tr_b16 a[194:195], v32 offset:41216
v_mfma_f32_16x16x32_bf16 v[116:119], a[196:199], a[48:51], v[116:119]
buffer_load_dwordx4 v19, s[16:19], s33 offen offset:3072 nt lds
v_mfma_f32_16x16x32_bf16 v[124:127], a[196:199], a[52:55], v[124:127]
s_add_u32 m0, s32, 0
ds_read_b64_tr_b16 a[196:197], v33 offset:33024
ds_read_b64_tr_b16 a[198:199], v33 offset:41216
v_mfma_f32_16x16x32_bf16 v[112:115], a[200:203], a[56:59], v[112:115]
s_xor_b32 s33, s99, 245760
v_mfma_f32_16x16x32_bf16 v[120:123], a[200:203], a[60:63], v[120:123]
ds_read_b64_tr_b16 a[200:201], v34 offset:33024
ds_read_b64_tr_b16 a[202:203], v34 offset:41216
v_mfma_f32_16x16x32_bf16 v[116:119], a[204:207], a[56:59], v[116:119]
v_mfma_f32_16x16x32_bf16 v[124:127], a[204:207], a[60:63], v[124:127]
ds_read_b64_tr_b16 a[204:205], v35 offset:33024
ds_read_b64_tr_b16 a[206:207], v35 offset:41216
v_mfma_f32_16x16x32_bf16 v[64:67], a[176:179], v[80:83], v[64:67]
v_mfma_f32_16x16x32_bf16 v[68:71], a[176:179], v[84:87], v[68:71]
v_mfma_f32_16x16x32_bf16 v[128:131], a[208:211], v[80:83], v[128:131]
v_mfma_f32_16x16x32_bf16 v[136:139], a[208:211], v[84:87], v[136:139]
s_waitcnt lgkmcnt(2)
ds_read_b64_tr_b16 a[208:209], v36 offset:33024
v_fma_f32 v56, v112, s35, v72
v_mfma_f32_16x16x32_bf16 v[132:135], a[212:215], v[80:83], v[132:135]
buffer_load_dwordx4 v16, s[12:15], s33 offen offset:0 nt lds
v_mfma_f32_16x16x32_bf16 v[140:143], a[212:215], v[84:87], v[140:143]
ds_read_b64_tr_b16 a[210:211], v36 offset:41216
v_fma_f32 v57, v113, s35, v72
v_mfma_f32_16x16x32_bf16 v[144:147], a[216:219], v[80:83], v[144:147]
v_exp_f32 v56, v56
v_mfma_f32_16x16x32_bf16 v[152:155], a[216:219], v[84:87], v[152:155]
ds_read_b64_tr_b16 a[212:213], v37 offset:33024
v_fma_f32 v58, v114, s35, v72
v_mfma_f32_16x16x32_bf16 v[148:151], a[220:223], v[80:83], v[148:151]
v_exp_f32 v57, v57
v_mfma_f32_16x16x32_bf16 v[156:159], a[220:223], v[84:87], v[156:159]
ds_read_b64_tr_b16 a[214:215], v37 offset:41216
v_fma_f32 v59, v115, s35, v72
v_mfma_f32_16x16x32_bf16 v[160:163], a[224:227], v[80:83], v[160:163]
v_exp_f32 v58, v58
v_mfma_f32_16x16x32_bf16 v[168:171], a[224:227], v[84:87], v[168:171]
ds_read_b64_tr_b16 a[216:217], v38 offset:33024
v_fma_f32 v60, v116, s35, v72
v_mfma_f32_16x16x32_bf16 v[164:167], a[228:231], v[80:83], v[164:167]
v_exp_f32 v59, v59
v_mfma_f32_16x16x32_bf16 v[172:175], a[228:231], v[84:87], v[172:175]
ds_read_b64_tr_b16 a[218:219], v38 offset:41216
v_fma_f32 v61, v117, s35, v72
v_mfma_f32_16x16x32_bf16 v[176:179], a[232:235], v[80:83], v[176:179]
s_waitcnt vmcnt(5)
buffer_load_dwordx4 v17, s[12:15], s33 offen offset:1024 nt lds
v_mfma_f32_16x16x32_bf16 v[184:187], a[232:235], v[84:87], v[184:187]
ds_read_b64_tr_b16 a[220:221], v39 offset:33024
v_cvt_pk_bf16_f32 v88, v56, v57
v_mfma_f32_16x16x32_bf16 v[180:183], a[236:239], v[80:83], v[180:183]
v_exp_f32 v60, v60
v_mfma_f32_16x16x32_bf16 v[188:191], a[236:239], v[84:87], v[188:191]
ds_read_b64_tr_b16 a[222:223], v39 offset:41216
v_fma_f32 v62, v118, s35, v72
v_mfma_f32_16x16x32_bf16 v[192:195], a[192:195], v[80:83], v[192:195]
s_barrier
v_exp_f32 v61, v61
v_mfma_f32_16x16x32_bf16 v[200:203], a[192:195], v[84:87], v[200:203]
ds_read_b128 a[224:227], v20 offset:16384
v_fma_f32 v63, v119, s35, v72
v_mfma_f32_16x16x32_bf16 v[196:199], a[196:199], v[80:83], v[196:199]
ds_read_b128 a[228:231], v20 offset:24576
v_cvt_pk_bf16_f32 v89, v58, v59
v_mfma_f32_16x16x32_bf16 v[204:207], a[196:199], v[84:87], v[204:207]
v_exp_f32 v62, v62
v_mfma_f32_16x16x32_bf16 v[208:211], a[200:203], v[80:83], v[208:211]
ds_read_b128 a[232:235], v21 offset:16384
v_fma_f32 v56, v120, s35, v76
v_mfma_f32_16x16x32_bf16 v[216:219], a[200:203], v[84:87], v[216:219]
s_waitcnt lgkmcnt(3)
v_exp_f32 v63, v63
v_mfma_f32_16x16x32_bf16 v[212:215], a[204:207], v[80:83], v[212:215]
buffer_load_dwordx4 v18, s[12:15], s33 offen offset:2048 nt lds
v_mfma_f32_16x16x32_bf16 v[220:223], a[204:207], v[84:87], v[220:223]
ds_read_b128 a[236:239], v21 offset:24576
v_fma_f32 v57, v121, s35, v76
v_mfma_f32_16x16x32_bf16 v[224:227], a[208:211], v[80:83], v[224:227]
ds_read_b128 a[192:195], v22 offset:16384
v_cvt_pk_bf16_f32 v90, v60, v61
v_mfma_f32_16x16x32_bf16 v[232:235], a[208:211], v[84:87], v[232:235]
v_exp_f32 v56, v56
v_mfma_f32_16x16x32_bf16 v[228:231], a[212:215], v[80:83], v[228:231]
ds_read_b128 a[196:199], v22 offset:24576
v_fma_f32 v58, v122, s35, v76
v_mfma_f32_16x16x32_bf16 v[236:239], a[212:215], v[84:87], v[236:239]
v_exp_f32 v57, v57
v_mfma_f32_16x16x32_bf16 v[240:243], a[216:219], v[80:83], v[240:243]
ds_read_b128 a[200:203], v23 offset:16384
v_fma_f32 v59, v123, s35, v76
v_mfma_f32_16x16x32_bf16 v[248:251], a[216:219], v[84:87], v[248:251]
ds_read_b128 a[204:207], v23 offset:24576
v_cvt_pk_bf16_f32 v91, v62, v63
v_mfma_f32_16x16x32_bf16 v[244:247], a[220:223], v[80:83], v[244:247]
v_exp_f32 v58, v58
v_mfma_f32_16x16x32_bf16 v[252:255], a[220:223], v[84:87], v[252:255]
s_waitcnt lgkmcnt(2)
ds_read_b128 a[208:211], v20 offset:16640
v_fma_f32 v60, v124, s35, v76
v_mfma_f32_16x16x32_bf16 v[96:99], a[224:227], a[0:3], 0
buffer_load_dwordx4 v19, s[12:15], s33 offen offset:3072 nt lds
v_mfma_f32_16x16x32_bf16 v[104:107], a[224:227], a[4:7], 0
s_add_u32 m0, s32, 81920
v_exp_f32 v59, v59
v_mfma_f32_16x16x32_bf16 v[100:103], a[228:231], a[0:3], 0
s_xor_b32 s33, s99, 229376
ds_read_b128 a[212:215], v20 offset:24832
v_fma_f32 v61, v125, s35, v76
v_mfma_f32_16x16x32_bf16 v[108:111], a[228:231], a[4:7], 0
ds_read_b128 a[216:219], v21 offset:16640
v_cvt_pk_bf16_f32 v92, v56, v57
v_mfma_f32_16x16x32_bf16 v[96:99], a[232:235], a[8:11], v[96:99]
v_exp_f32 v60, v60
v_mfma_f32_16x16x32_bf16 v[104:107], a[232:235], a[12:15], v[104:107]
ds_read_b128 a[220:223], v21 offset:24832
v_fma_f32 v62, v126, s35, v76
v_mfma_f32_16x16x32_bf16 v[100:103], a[236:239], a[8:11], v[100:103]
v_exp_f32 v61, v61
v_mfma_f32_16x16x32_bf16 v[108:111], a[236:239], a[12:15], v[108:111]
ds_read_b128 a[224:227], v22 offset:16640
v_fma_f32 v63, v127, s35, v76
v_mfma_f32_16x16x32_bf16 v[96:99], a[192:195], a[16:19], v[96:99]
ds_read_b128 a[228:231], v22 offset:24832
v_cvt_pk_bf16_f32 v93, v58, v59
v_mfma_f32_16x16x32_bf16 v[104:107], a[192:195], a[20:23], v[104:107]
s_waitcnt vmcnt(4)
v_exp_f32 v62, v62
v_mfma_f32_16x16x32_bf16 v[100:103], a[196:199], a[16:19], v[100:103]
buffer_load_dwordx4 v16, s[16:19], s33 offen offset:0 nt lds
v_mfma_f32_16x16x32_bf16 v[108:111], a[196:199], a[20:23], v[108:111]
s_waitcnt lgkmcnt(2)
v_exp_f32 v63, v63
v_mfma_f32_16x16x32_bf16 v[96:99], a[200:203], a[24:27], v[96:99]
ds_read_b128 a[232:235], v23 offset:16640
v_cvt_pk_bf16_f32 v94, v60, v61
v_mfma_f32_16x16x32_bf16 v[104:107], a[200:203], a[28:31], v[104:107]
ds_read_b128 a[236:239], v23 offset:24832
v_cvt_pk_bf16_f32 v95, v62, v63
v_mfma_f32_16x16x32_bf16 v[100:103], a[204:207], a[24:27], v[100:103]
s_barrier
ds_read_b64_tr_b16 a[192:193], v40 offset:32768
v_or3_b32 v0, v88, v89, v90
v_mfma_f32_16x16x32_bf16 v[108:111], a[204:207], a[28:31], v[108:111]
LA_t42:
s_load_dword s98, s[96:97], 44852
ds_read_b64_tr_b16 a[194:195], v40 offset:40960
v_or3_b32 v1, v91, v92, v93
v_mfma_f32_16x16x32_bf16 v[96:99], a[208:211], a[32:35], v[96:99]
ds_read_b64_tr_b16 a[196:197], v41 offset:32768
v_or3_b32 v0, v0, v94, v95
v_mfma_f32_16x16x32_bf16 v[104:107], a[208:211], a[36:39], v[104:107]
ds_read_b64_tr_b16 a[198:199], v41 offset:40960
v_bitop3_b32 v0, v0, v1, s36 bitop3:0xa8
v_mfma_f32_16x16x32_bf16 v[100:103], a[212:215], a[32:35], v[100:103]
ds_read_b64_tr_b16 a[200:201], v42 offset:32768
v_cmp_ne_u32 vcc, 0, v0
v_mfma_f32_16x16x32_bf16 v[108:111], a[212:215], a[36:39], v[108:111]
s_cbranch_vccnz LA_stub13
LA_back13:
ds_read_b64_tr_b16 a[202:203], v42 offset:40960
ds_read_b64_tr_b16 a[204:205], v43 offset:32768
v_mfma_f32_16x16x32_bf16 v[96:99], a[216:219], a[40:43], v[96:99]
buffer_load_dwordx4 v17, s[16:19], s33 offen offset:1024 nt lds
v_mfma_f32_16x16x32_bf16 v[104:107], a[216:219], a[44:47], v[104:107]
ds_read_b64_tr_b16 a[206:207], v43 offset:40960
ds_read_b64_tr_b16 a[208:209], v44 offset:32768
v_mfma_f32_16x16x32_bf16 v[100:103], a[220:223], a[40:43], v[100:103]
ds_read_b64_tr_b16 a[210:211], v44 offset:40960
ds_read_b64_tr_b16 a[212:213], v45 offset:32768
v_mfma_f32_16x16x32_bf16 v[108:111], a[220:223], a[44:47], v[108:111]
s_waitcnt lgkmcnt(6)
ds_read_b64_tr_b16 a[214:215], v45 offset:40960
ds_read_b64_tr_b16 a[216:217], v46 offset:32768
v_mfma_f32_16x16x32_bf16 v[96:99], a[224:227], a[48:51], v[96:99]
ds_read_b64_tr_b16 a[218:219], v46 offset:40960
ds_read_b64_tr_b16 a[220:221], v47 offset:32768
v_mfma_f32_16x16x32_bf16 v[104:107], a[224:227], a[52:55], v[104:107]
ds_read_b64_tr_b16 a[222:223], v47 offset:40960
ds_read_b64_tr_b16 a[224:225], v40 offset:33024
v_mfma_f32_16x16x32_bf16 v[100:103], a[228:231], a[48:51], v[100:103]
ds_read_b64_tr_b16 a[226:227], v40 offset:41216
v_mfma_f32_16x16x32_bf16 v[108:111], a[228:231], a[52:55], v[108:111]
ds_read_b64_tr_b16 a[228:229], v41 offset:33024
ds_read_b64_tr_b16 a[230:231], v41 offset:41216
v_mfma_f32_16x16x32_bf16 v[96:99], a[232:235], a[56:59], v[96:99]
v_mfma_f32_16x16x32_bf16 v[104:107], a[232:235], a[60:63], v[104:107]
ds_read_b64_tr_b16 a[232:233], v42 offset:33024
ds_read_b64_tr_b16 a[234:235], v42 offset:41216
v_mfma_f32_16x16x32_bf16 v[100:103], a[236:239], a[56:59], v[100:103]
buffer_load_dwordx4 v18, s[16:19], s33 offen offset:2048 nt lds
v_mfma_f32_16x16x32_bf16 v[108:111], a[236:239], a[60:63], v[108:111]
ds_read_b64_tr_b16 a[236:237], v43 offset:33024
ds_read_b64_tr_b16 a[238:239], v43 offset:41216
v_mfma_f32_16x16x32_bf16 v[64:67], a[176:179], v[88:91], v[64:67]
v_mfma_f32_16x16x32_bf16 v[68:71], a[176:179], v[92:95], v[68:71]
v_mfma_f32_16x16x32_bf16 v[128:131], a[192:195], v[88:91], v[128:131]
v_mfma_f32_16x16x32_bf16 v[136:139], a[192:195], v[92:95], v[136:139]
ds_read_b64_tr_b16 a[192:193], v44 offset:33024
v_fma_f32 v56, v96, s35, v72
v_mfma_f32_16x16x32_bf16 v[132:135], a[196:199], v[88:91], v[132:135]
ds_read_b64_tr_b16 a[194:195], v44 offset:41216
v_fma_f32 v57, v97, s35, v72
v_mfma_f32_16x16x32_bf16 v[140:143], a[196:199], v[92:95], v[140:143]
s_waitcnt lgkmcnt(2)
v_exp_f32 v56, v56
v_mfma_f32_16x16x32_bf16 v[144:147], a[200:203], v[88:91], v[144:147]
ds_read_b64_tr_b16 a[196:197], v45 offset:33024
v_fma_f32 v58, v98, s35, v72
v_mfma_f32_16x16x32_bf16 v[152:155], a[200:203], v[92:95], v[152:155]
v_exp_f32 v57, v57
v_mfma_f32_16x16x32_bf16 v[148:151], a[204:207], v[88:91], v[148:151]
buffer_load_dwordx4 v19, s[16:19], s33 offen offset:3072 nt lds
v_mfma_f32_16x16x32_bf16 v[156:159], a[204:207], v[92:95], v[156:159]
s_add_u32 m0, s32, 114688
ds_read_b64_tr_b16 a[198:199], v45 offset:41216
v_fma_f32 v59, v99, s35, v72
v_mfma_f32_16x16x32_bf16 v[160:163], a[208:211], v[88:91], v[160:163]
s_xor_b32 s33, s99, 245760
v_exp_f32 v58, v58
v_mfma_f32_16x16x32_bf16 v[168:171], a[208:211], v[92:95], v[168:171]
ds_read_b64_tr_b16 a[200:201], v46 offset:33024
v_fma_f32 v60, v100, s35, v72
v_mfma_f32_16x16x32_bf16 v[164:167], a[212:215], v[88:91], v[164:167]
v_exp_f32 v59, v59
v_mfma_f32_16x16x32_bf16 v[172:175], a[212:215], v[92:95], v[172:175]
ds_read_b64_tr_b16 a[202:203], v46 offset:41216
v_fma_f32 v61, v101, s35, v72
v_mfma_f32_16x16x32_bf16 v[176:179], a[216:219], v[88:91], v[176:179]
s_waitcnt vmcnt(4)
ds_read_b64_tr_b16 a[204:205], v47 offset:33024
v_cvt_pk_bf16_f32 v80, v56, v57
v_mfma_f32_16x16x32_bf16 v[184:187], a[216:219], v[92:95], v[184:187]
v_exp_f32 v60, v60
v_mfma_f32_16x16x32_bf16 v[180:183], a[220:223], v[88:91], v[180:183]
ds_read_b64_tr_b16 a[206:207], v47 offset:41216
v_fma_f32 v62, v102, s35, v72
v_mfma_f32_16x16x32_bf16 v[188:191], a[220:223], v[92:95], v[188:191]
s_barrier
v_exp_f32 v61, v61
v_mfma_f32_16x16x32_bf16 v[192:195], a[224:227], v[88:91], v[192:195]
buffer_load_dwordx4 v16, s[16:19], s33 offen offset:0 nt lds
v_mfma_f32_16x16x32_bf16 v[200:203], a[224:227], v[92:95], v[200:203]
ds_read_b128 a[208:211], v20 offset:0
v_fma_f32 v63, v103, s35, v72
v_mfma_f32_16x16x32_bf16 v[196:199], a[228:231], v[88:91], v[196:199]
ds_read_b128 a[212:215], v20 offset:8192
v_cvt_pk_bf16_f32 v81, v58, v59
v_mfma_f32_16x16x32_bf16 v[204:207], a[228:231], v[92:95], v[204:207]
v_exp_f32 v62, v62
v_mfma_f32_16x16x32_bf16 v[208:211], a[232:235], v[88:91], v[208:211]
ds_read_b128 a[216:219], v21 offset:0
v_fma_f32 v56, v104, s35, v76
v_mfma_f32_16x16x32_bf16 v[216:219], a[232:235], v[92:95], v[216:219]
v_exp_f32 v63, v63
v_mfma_f32_16x16x32_bf16 v[212:215], a[236:239], v[88:91], v[212:215]
ds_read_b128 a[220:223], v21 offset:8192
v_fma_f32 v57, v105, s35, v76
v_mfma_f32_16x16x32_bf16 v[220:223], a[236:239], v[92:95], v[220:223]
s_waitcnt lgkmcnt(2)
ds_read_b128 a[224:227], v22 offset:0
v_cvt_pk_bf16_f32 v82, v60, v61
v_mfma_f32_16x16x32_bf16 v[224:227], a[192:195], v[88:91], v[224:227]
v_exp_f32 v56, v56
v_mfma_f32_16x16x32_bf16 v[232:235], a[192:195], v[92:95], v[232:235]
ds_read_b128 a[228:231], v22 offset:8192
v_fma_f32 v58, v106, s35, v76
v_mfma_f32_16x16x32_bf16 v[228:231], a[196:199], v[88:91], v[228:231]
buffer_load_dwordx4 v17, s[16:19], s33 offen offset:1024 nt lds
v_mfma_f32_16x16x32_bf16 v[236:239], a[196:199], v[92:95], v[236:239]
v_exp_f32 v57, v57
v_mfma_f32_16x16x32_bf16 v[240:243], a[200:203], v[88:91], v[240:243]
ds_read_b128 a[232:235], v23 offset:0
v_fma_f32 v59, v107, s35, v76
v_mfma_f32_16x16x32_bf16 v[248:251], a[200:203], v[92:95], v[248:251]
ds_read_b128 a[236:239], v23 offset:8192
v_cvt_pk_bf16_f32 v83, v62, v63
v_mfma_f32_16x16x32_bf16 v[244:247], a[204:207], v[88:91], v[244:247]
v_exp_f32 v58, v58
v_mfma_f32_16x16x32_bf16 v[252:255], a[204:207], v[92:95], v[252:255]
ds_read_b128 a[192:195], v20 offset:256
v_fma_f32 v60, v108, s35, v76
v_mfma_f32_16x16x32_bf16 v[112:115], a[208:211], a[0:3], 0
v_exp_f32 v59, v59
v_mfma_f32_16x16x32_bf16 v[120:123], a[208:211], a[4:7], 0
ds_read_b128 a[196:199], v20 offset:8448
v_fma_f32 v61, v109, s35, v76
v_mfma_f32_16x16x32_bf16 v[116:119], a[212:215], a[0:3], 0
ds_read_b128 a[200:203], v21 offset:256
v_cvt_pk_bf16_f32 v84, v56, v57
v_mfma_f32_16x16x32_bf16 v[124:127], a[212:215], a[4:7], 0
s_waitcnt lgkmcnt(3)
v_exp_f32 v60, v60
v_mfma_f32_16x16x32_bf16 v[112:115], a[216:219], a[8:11], v[112:115]
buffer_load_dwordx4 v18, s[16:19], s33 offen offset:2048 nt lds
v_mfma_f32_16x16x32_bf16 v[120:123], a[216:219], a[12:15], v[120:123]
ds_read_b128 a[204:207], v21 offset:8448
v_fma_f32 v62, v110, s35, v76
v_mfma_f32_16x16x32_bf16 v[116:119], a[220:223], a[8:11], v[116:119]
v_exp_f32 v61, v61
v_mfma_f32_16x16x32_bf16 v[124:127], a[220:223], a[12:15], v[124:127]
ds_read_b128 a[208:211], v22 offset:256
v_fma_f32 v63, v111, s35, v76
v_mfma_f32_16x16x32_bf16 v[112:115], a[224:227], a[16:19], v[112:115]
ds_read_b128 a[212:215], v22 offset:8448
v_cvt_pk_bf16_f32 v85, v58, v59
v_mfma_f32_16x16x32_bf16 v[120:123], a[224:227], a[20:23], v[120:123]
s_waitcnt vmcnt(3)
v_exp_f32 v62, v62
v_mfma_f32_16x16x32_bf16 v[116:119], a[228:231], a[16:19], v[116:119]
v_exp_f32 v63, v63
v_mfma_f32_16x16x32_bf16 v[124:127], a[228:231], a[20:23], v[124:127]
ds_read_b128 a[216:219], v23 offset:256
v_cvt_pk_bf16_f32 v86, v60, v61
v_mfma_f32_16x16x32_bf16 v[112:115], a[232:235], a[24:27], v[112:115]
ds_read_b128 a[220:223], v23 offset:8448
v_cvt_pk_bf16_f32 v87, v62, v63
v_mfma_f32_16x16x32_bf16 v[120:123], a[232:235], a[28:31], v[120:123]
s_barrier
ds_read_b64_tr_b16 a[224:225], v40 offset:16384
v_or3_b32 v0, v80, v81, v82
v_mfma_f32_16x16x32_bf16 v[116:119], a[236:239], a[24:27], v[116:119]
LA_t44:
s_load_dword s98, s[96:97], 44852
buffer_load_dwordx4 v19, s[16:19], s33 offen offset:3072 nt lds
v_mfma_f32_16x16x32_bf16 v[124:127], a[236:239], a[28:31], v[124:127]
s_waitcnt lgkmcnt(3)
ds_read_b64_tr_b16 a[226:227], v40 offset:24576
v_or3_b32 v1, v83, v84, v85
v_mfma_f32_16x16x32_bf16 v[112:115], a[192:195], a[32:35], v[112:115]
s_add_u32 m0, s32, 131072
ds_read_b64_tr_b16 a[228:229], v41 offset:16384
v_or3_b32 v0, v0, v86, v87
v_mfma_f32_16x16x32_bf16 v[120:123], a[192:195], a[36:39], v[120:123]
s_add_u32 s33, s56, 0
ds_read_b64_tr_b16 a[230:231], v41 offset:24576
v_bitop3_b32 v0, v0, v1, s36 bitop3:0xa8
v_mfma_f32_16x16x32_bf16 v[116:119], a[196:199], a[32:35], v[116:119]
ds_read_b64_tr_b16 a[232:233], v42 offset:16384
v_cmp_ne_u32 vcc, 0, v0
v_mfma_f32_16x16x32_bf16 v[124:127], a[196:199], a[36:39], v[124:127]
s_cbranch_vccnz LA_stub14
LA_back14:
buffer_load_dwordx4 v8, s[24:27], s33 offen offset:0 lds
v_mfma_f32_16x16x32_bf16 v[112:115], a[200:203], a[40:43], v[112:115]
ds_read_b64_tr_b16 a[234:235], v42 offset:24576
ds_read_b64_tr_b16 a[236:237], v43 offset:16384
v_mfma_f32_16x16x32_bf16 v[120:123], a[200:203], a[44:47], v[120:123]
ds_read_b64_tr_b16 a[238:239], v43 offset:24576
ds_read_b64_tr_b16 a[192:193], v44 offset:16384
v_mfma_f32_16x16x32_bf16 v[116:119], a[204:207], a[40:43], v[116:119]
ds_read_b64_tr_b16 a[194:195], v44 offset:24576
ds_read_b64_tr_b16 a[196:197], v45 offset:16384
v_mfma_f32_16x16x32_bf16 v[124:127], a[204:207], a[44:47], v[124:127]
ds_read_b64_tr_b16 a[198:199], v45 offset:24576
ds_read_b64_tr_b16 a[200:201], v46 offset:16384
v_mfma_f32_16x16x32_bf16 v[112:115], a[208:211], a[48:51], v[112:115]
buffer_load_dwordx4 v9, s[24:27], s33 offen offset:1024 lds
v_mfma_f32_16x16x32_bf16 v[120:123], a[208:211], a[52:55], v[120:123]
ds_read_b64_tr_b16 a[202:203], v46 offset:24576
ds_read_b64_tr_b16 a[204:205], v47 offset:16384
v_mfma_f32_16x16x32_bf16 v[116:119], a[212:215], a[48:51], v[116:119]
ds_read_b64_tr_b16 a[206:207], v47 offset:24576
ds_read_b64_tr_b16 a[208:209], v40 offset:16640
v_mfma_f32_16x16x32_bf16 v[124:127], a[212:215], a[52:55], v[124:127]
s_waitcnt lgkmcnt(6)
ds_read_b64_tr_b16 a[210:211], v40 offset:24832
ds_read_b64_tr_b16 a[212:213], v41 offset:16640
v_mfma_f32_16x16x32_bf16 v[112:115], a[216:219], a[56:59], v[112:115]
ds_read_b64_tr_b16 a[214:215], v41 offset:24832
v_mfma_f32_16x16x32_bf16 v[120:123], a[216:219], a[60:63], v[120:123]
buffer_load_dwordx4 v10, s[24:27], s33 offen offset:2048 lds
v_mfma_f32_16x16x32_bf16 v[116:119], a[220:223], a[56:59], v[116:119]
ds_read_b64_tr_b16 a[216:217], v42 offset:16640
ds_read_b64_tr_b16 a[218:219], v42 offset:24832
v_mfma_f32_16x16x32_bf16 v[124:127], a[220:223], a[60:63], v[124:127]
ds_read_b64_tr_b16 a[220:221], v43 offset:16640
ds_read_b64_tr_b16 a[222:223], v43 offset:24832
v_mfma_f32_16x16x32_bf16 v[64:67], a[176:179], v[80:83], v[64:67]
v_mfma_f32_16x16x32_bf16 v[68:71], a[176:179], v[84:87], v[68:71]
v_mfma_f32_16x16x32_bf16 v[128:131], a[224:227], v[80:83], v[128:131]
buffer_load_dwordx4 v11, s[24:27], s33 offen offset:3072 lds
v_mfma_f32_16x16x32_bf16 v[136:139], a[224:227], v[84:87], v[136:139]
s_add_u32 m0, s32, 65536
ds_read_b64_tr_b16 a[224:225], v44 offset:16640
v_fma_f32 v56, v112, s35, v72
v_mfma_f32_16x16x32_bf16 v[132:135], a[228:231], v[80:83], v[132:135]
s_add_u32 s33, s56, 114688
ds_read_b64_tr_b16 a[226:227], v44 offset:24832
v_fma_f32 v57, v113, s35, v72
v_mfma_f32_16x16x32_bf16 v[140:143], a[228:231], v[84:87], v[140:143]
v_exp_f32 v56, v56
v_mfma_f32_16x16x32_bf16 v[144:147], a[232:235], v[80:83], v[144:147]
ds_read_b64_tr_b16 a[228:229], v45 offset:16640
v_fma_f32 v58, v114, s35, v72
v_mfma_f32_16x16x32_bf16 v[152:155], a[232:235], v[84:87], v[152:155]
buffer_load_dwordx4 v8, s[24:27], s33 offen offset:0 lds
v_mfma_f32_16x16x32_bf16 v[148:151], a[236:239], v[80:83], v[148:151]
v_exp_f32 v57, v57
v_mfma_f32_16x16x32_bf16 v[156:159], a[236:239], v[84:87], v[156:159]
ds_read_b64_tr_b16 a[230:231], v45 offset:24832
v_fma_f32 v59, v115, s35, v72
v_mfma_f32_16x16x32_bf16 v[160:163], a[192:195], v[80:83], v[160:163]
v_exp_f32 v58, v58
v_mfma_f32_16x16x32_bf16 v[168:171], a[192:195], v[84:87], v[168:171]
s_waitcnt lgkmcnt(1)
ds_read_b64_tr_b16 a[232:233], v46 offset:16640
v_fma_f32 v60, v116, s35, v72
v_mfma_f32_16x16x32_bf16 v[164:167], a[196:199], v[80:83], v[164:167]
buffer_load_dwordx4 v9, s[24:27], s33 offen offset:1024 lds
v_mfma_f32_16x16x32_bf16 v[172:175], a[196:199], v[84:87], v[172:175]
v_exp_f32 v59, v59
v_mfma_f32_16x16x32_bf16 v[176:179], a[200:203], v[80:83], v[176:179]
ds_read_b64_tr_b16 a[234:235], v46 offset:24832
v_fma_f32 v61, v117, s35, v72
v_mfma_f32_16x16x32_bf16 v[184:187], a[200:203], v[84:87], v[184:187]
s_waitcnt vmcnt(6)
ds_read_b64_tr_b16 a[236:237], v47 offset:16640
v_cvt_pk_bf16_f32 v88, v56, v57
v_mfma_f32_16x16x32_bf16 v[180:183], a[204:207], v[80:83], v[180:183]
v_exp_f32 v60, v60
v_mfma_f32_16x16x32_bf16 v[188:191], a[204:207], v[84:87], v[188:191]
buffer_load_dwordx4 v10, s[24:27], s33 offen offset:2048 lds
v_mfma_f32_16x16x32_bf16 v[192:195], a[208:211], v[80:83], v[192:195]
ds_read_b64_tr_b16 a[238:239], v47 offset:24832
v_fma_f32 v62, v118, s35, v72
v_mfma_f32_16x16x32_bf16 v[200:203], a[208:211], v[84:87], v[200:203]
s_barrier
v_exp_f32 v61, v61
v_mfma_f32_16x16x32_bf16 v[196:199], a[212:215], v[80:83], v[196:199]
ds_read_b64_tr_b16 a[192:193], v40 offset:49152
v_fma_f32 v63, v119, s35, v72
v_mfma_f32_16x16x32_bf16 v[204:207], a[212:215], v[84:87], v[204:207]
ds_read_b64_tr_b16 a[194:195], v40 offset:57344
v_cvt_pk_bf16_f32 v89, v58, v59
v_mfma_f32_16x16x32_bf16 v[208:211], a[216:219], v[80:83], v[208:211]
buffer_load_dwordx4 v11, s[24:27], s33 offen offset:3072 lds
v_mfma_f32_16x16x32_bf16 v[216:219], a[216:219], v[84:87], v[216:219]
s_add_u32 m0, s32, 49152
v_exp_f32 v62, v62
v_mfma_f32_16x16x32_bf16 v[212:215], a[220:223], v[80:83], v[212:215]
s_add_u32 s33, s57, 0
ds_read_b64_tr_b16 a[196:197], v41 offset:49152
v_fma_f32 v56, v120, s35, v76
v_mfma_f32_16x16x32_bf16 v[220:223], a[220:223], v[84:87], v[220:223]
v_exp_f32 v63, v63
v_mfma_f32_16x16x32_bf16 v[224:227], a[224:227], v[80:83], v[224:227]
ds_read_b64_tr_b16 a[198:199], v41 offset:57344
v_fma_f32 v57, v121, s35, v76
v_mfma_f32_16x16x32_bf16 v[232:235], a[224:227], v[84:87], v[232:235]
s_waitcnt lgkmcnt(2)
buffer_load_dwordx4 v8, s[24:27], s33 offen offset:0 lds
v_mfma_f32_16x16x32_bf16 v[228:231], a[228:231], v[80:83], v[228:231]
ds_read_b64_tr_b16 a[200:201], v42 offset:49152
v_cvt_pk_bf16_f32 v90, v60, v61
v_mfma_f32_16x16x32_bf16 v[236:239], a[228:231], v[84:87], v[236:239]
v_exp_f32 v56, v56
v_mfma_f32_16x16x32_bf16 v[240:243], a[232:235], v[80:83], v[240:243]
ds_read_b64_tr_b16 a[202:203], v42 offset:57344
v_fma_f32 v58, v122, s35, v76
v_mfma_f32_16x16x32_bf16 v[248:251], a[232:235], v[84:87], v[248:251]
v_exp_f32 v57, v57
v_mfma_f32_16x16x32_bf16 v[244:247], a[236:239], v[80:83], v[244:247]
buffer_load_dwordx4 v9, s[24:27], s33 offen offset:1024 lds
v_mfma_f32_16x16x32_bf16 v[252:255], a[236:239], v[84:87], v[252:255]
ds_read_b64_tr_b16 a[204:205], v43 offset:49152
v_fma_f32 v59, v123, s35, v76
v_cvt_pk_bf16_f32 v91, v62, v63
v_exp_f32 v58, v58
v_fma_f32 v60, v124, s35, v76
v_exp_f32 v59, v59
v_fma_f32 v61, v125, s35, v76
v_cvt_pk_bf16_f32 v92, v56, v57
v_exp_f32 v60, v60
v_fma_f32 v62, v126, s35, v76
v_exp_f32 v61, v61
v_fma_f32 v63, v127, s35, v76
v_cvt_pk_bf16_f32 v93, v58, v59
v_exp_f32 v62, v62
v_exp_f32 v63, v63
v_cvt_pk_bf16_f32 v94, v60, v61
v_cvt_pk_bf16_f32 v95, v62, v63
v_or3_b32 v0, v88, v89, v90
v_or3_b32 v1, v91, v92, v93
v_or3_b32 v0, v0, v94, v95
v_bitop3_b32 v0, v0, v1, s36 bitop3:0xa8
v_cmp_ne_u32 vcc, 0, v0
s_cbranch_vccnz LA_stub15
LA_back15:
v_xor_b32 v20, 0x0, v5
v_xor_b32 v21, 0x20, v5
v_xor_b32 v22, 0x40, v5
v_xor_b32 v23, 0x60, v5
v_xor_b32 v24, 0x10000, v5
v_xor_b32 v25, 0x10020, v5
v_xor_b32 v26, 0x10040, v5
v_xor_b32 v27, 0x10060, v5
v_xor_b32 v28, 0x20000, v5
v_xor_b32 v29, 0x20020, v5
v_xor_b32 v30, 0x20040, v5
v_xor_b32 v31, 0x20060, v5
v_mfma_f32_16x16x32_bf16 v[64:67], a[176:179], v[88:91], v[64:67]
ds_read_b64_tr_b16 a[206:207], v43 offset:57344
v_accvgpr_read_b32 v16, a174
v_mfma_f32_16x16x32_bf16 v[68:71], a[176:179], v[92:95], v[68:71]
ds_read_b64_tr_b16 a[208:209], v44 offset:49152
v_accvgpr_read_b32 v17, a173
v_mfma_f32_16x16x32_bf16 v[128:131], a[192:195], v[88:91], v[128:131]
ds_read_b64_tr_b16 a[210:211], v44 offset:57344
ds_read_b64_tr_b16 a[212:213], v45 offset:49152
v_mfma_f32_16x16x32_bf16 v[136:139], a[192:195], v[92:95], v[136:139]
s_waitcnt lgkmcnt(5)
buffer_load_dwordx4 v10, s[24:27], s33 offen offset:2048 lds
v_mfma_f32_16x16x32_bf16 v[132:135], a[196:199], v[88:91], v[132:135]
v_rcp_f32 v56, v64
v_mfma_f32_16x16x32_bf16 v[140:143], a[196:199], v[92:95], v[140:143]
v_rcp_f32 v57, v68
v_mfma_f32_16x16x32_bf16 v[144:147], a[200:203], v[88:91], v[144:147]
ds_read_b64_tr_b16 a[214:215], v45 offset:57344
ds_read_b64_tr_b16 a[216:217], v46 offset:49152
v_mfma_f32_16x16x32_bf16 v[152:155], a[200:203], v[92:95], v[152:155]
s_waitcnt lgkmcnt(2)
ds_read_b64_tr_b16 a[218:219], v46 offset:57344
ds_read_b64_tr_b16 a[220:221], v47 offset:49152
v_mfma_f32_16x16x32_bf16 v[148:151], a[204:207], v[88:91], v[148:151]
buffer_load_dwordx4 v11, s[24:27], s33 offen offset:3072 lds
v_mfma_f32_16x16x32_bf16 v[156:159], a[204:207], v[92:95], v[156:159]
s_add_u32 m0, s32, 32768
ds_read_b64_tr_b16 a[222:223], v47 offset:57344
v_cvt_pk_bf16_f32 v128, v128, v129
v_mfma_f32_16x16x32_bf16 v[160:163], a[208:211], v[88:91], v[160:163]
s_add_u32 s33, s57, 114688
ds_read_b64_tr_b16 a[224:225], v40 offset:49408
v_cvt_pk_bf16_f32 v129, v130, v131
v_mfma_f32_16x16x32_bf16 v[168:171], a[208:211], v[92:95], v[168:171]
s_waitcnt lgkmcnt(4)
ds_read_b64_tr_b16 a[226:227], v40 offset:57600
v_cvt_pk_bf16_f32 v130, v132, v133
v_mfma_f32_16x16x32_bf16 v[164:167], a[212:215], v[88:91], v[164:167]
ds_read_b64_tr_b16 a[228:229], v41 offset:49408
v_cvt_pk_bf16_f32 v131, v134, v135
v_mfma_f32_16x16x32_bf16 v[172:175], a[212:215], v[92:95], v[172:175]
s_waitcnt lgkmcnt(4)
buffer_load_dwordx4 v8, s[24:27], s33 offen offset:0 lds
v_mfma_f32_16x16x32_bf16 v[176:179], a[216:219], v[88:91], v[176:179]
ds_read_b64_tr_b16 a[230:231], v41 offset:57600
v_cvt_pk_bf16_f32 v136, v136, v137
v_mfma_f32_16x16x32_bf16 v[184:187], a[216:219], v[92:95], v[184:187]
s_waitcnt lgkmcnt(3)
ds_read_b64_tr_b16 a[232:233], v42 offset:49408
v_cvt_pk_bf16_f32 v137, v138, v139
v_mfma_f32_16x16x32_bf16 v[180:183], a[220:223], v[88:91], v[180:183]
ds_read_b64_tr_b16 a[234:235], v42 offset:57600
v_cvt_pk_bf16_f32 v138, v140, v141
v_mfma_f32_16x16x32_bf16 v[188:191], a[220:223], v[92:95], v[188:191]
s_waitcnt lgkmcnt(3)
ds_read_b64_tr_b16 a[236:237], v43 offset:49408
v_cvt_pk_bf16_f32 v139, v142, v143
v_mfma_f32_16x16x32_bf16 v[192:195], a[224:227], v[88:91], v[192:195]
ds_read_b64_tr_b16 a[238:239], v43 offset:57600
v_cvt_pk_bf16_f32 v144, v144, v145
v_mfma_f32_16x16x32_bf16 v[200:203], a[224:227], v[92:95], v[200:203]
s_waitcnt lgkmcnt(4)
buffer_load_dwordx4 v9, s[24:27], s33 offen offset:1024 lds
v_mfma_f32_16x16x32_bf16 v[196:199], a[228:231], v[88:91], v[196:199]
ds_read_b64_tr_b16 a[192:193], v44 offset:49408
ds_read_b64_tr_b16 a[194:195], v44 offset:57600
v_mfma_f32_16x16x32_bf16 v[204:207], a[228:231], v[92:95], v[204:207]
s_waitcnt lgkmcnt(4)
ds_read_b64_tr_b16 a[196:197], v45 offset:49408
v_cvt_pk_bf16_f32 v145, v146, v147
v_mfma_f32_16x16x32_bf16 v[208:211], a[232:235], v[88:91], v[208:211]
ds_read_b64_tr_b16 a[198:199], v45 offset:57600
v_cvt_pk_bf16_f32 v146, v148, v149
v_mfma_f32_16x16x32_bf16 v[216:219], a[232:235], v[92:95], v[216:219]
s_waitcnt lgkmcnt(4)
ds_read_b64_tr_b16 a[200:201], v46 offset:49408
v_cvt_pk_bf16_f32 v147, v150, v151
v_mfma_f32_16x16x32_bf16 v[212:215], a[236:239], v[88:91], v[212:215]
ds_read_b64_tr_b16 a[202:203], v46 offset:57600
v_cvt_pk_bf16_f32 v152, v152, v153
v_mfma_f32_16x16x32_bf16 v[220:223], a[236:239], v[92:95], v[220:223]
s_waitcnt lgkmcnt(4)
buffer_load_dwordx4 v10, s[24:27], s33 offen offset:2048 lds
v_mfma_f32_16x16x32_bf16 v[224:227], a[192:195], v[88:91], v[224:227]
s_waitcnt vmcnt(11)
ds_read_b64_tr_b16 a[204:205], v47 offset:49408
ds_read_b64_tr_b16 a[206:207], v47 offset:57600
v_mfma_f32_16x16x32_bf16 v[232:235], a[192:195], v[92:95], v[232:235]
s_waitcnt lgkmcnt(4)
v_cvt_pk_bf16_f32 v153, v154, v155
v_cvt_pk_bf16_f32 v154, v156, v157
v_mfma_f32_16x16x32_bf16 v[228:231], a[196:199], v[88:91], v[228:231]
s_barrier
ds_read_b64_tr_b16 a[208:209], v28 offset:0
ds_read_b64_tr_b16 a[210:211], v28 offset:2048
v_mfma_f32_16x16x32_bf16 v[236:239], a[196:199], v[92:95], v[236:239]
s_waitcnt lgkmcnt(4)
ds_read_b64_tr_b16 a[212:213], v29 offset:0
v_cvt_pk_bf16_f32 v155, v158, v159
v_mfma_f32_16x16x32_bf16 v[240:243], a[200:203], v[88:91], v[240:243]
LA_t46:
s_load_dword s98, s[96:97], 44852
ds_read_b64_tr_b16 a[214:215], v29 offset:2048
v_cvt_pk_bf16_f32 v160, v160, v161
v_mfma_f32_16x16x32_bf16 v[248:251], a[200:203], v[92:95], v[248:251]
s_waitcnt lgkmcnt(4)
buffer_load_dwordx4 v11, s[24:27], s33 offen offset:3072 lds
v_mfma_f32_16x16x32_bf16 v[244:247], a[204:207], v[88:91], v[244:247]
s_add_u32 m0, s32, 16384
ds_read_b64_tr_b16 a[216:217], v30 offset:0
ds_read_b64_tr_b16 a[218:219], v30 offset:2048
v_mfma_f32_16x16x32_bf16 v[252:255], a[204:207], v[92:95], v[252:255]
s_waitcnt lgkmcnt(4)
ds_read_b64_tr_b16 a[220:221], v31 offset:0
v_cvt_pk_bf16_f32 v161, v162, v163
v_mfma_f32_16x16x32_bf16 v[96:99], a[208:211], v[128:131], 0
s_add_u32 s33, s58, 0
ds_read_b64_tr_b16 a[222:223], v31 offset:2048
v_cvt_pk_bf16_f32 v162, v164, v165
v_mfma_f32_16x16x32_bf16 v[100:103], a[208:211], v[136:139], 0
s_waitcnt lgkmcnt(4)
ds_read_b64_tr_b16 a[224:225], v28 offset:4096
v_cvt_pk_bf16_f32 v163, v166, v167
v_mfma_f32_16x16x32_bf16 v[104:107], a[212:215], v[128:131], 0
ds_read_b64_tr_b16 a[226:227], v28 offset:6144
v_cvt_pk_bf16_f32 v168, v168, v169
v_mfma_f32_16x16x32_bf16 v[108:111], a[212:215], v[136:139], 0
s_waitcnt lgkmcnt(4)
buffer_load_dwordx4 v8, s[24:27], s33 offen offset:0 lds
v_mfma_f32_16x16x32_bf16 v[112:115], a[216:219], v[128:131], 0
ds_read_b64_tr_b16 a[228:229], v29 offset:4096
ds_read_b64_tr_b16 a[230:231], v29 offset:6144
v_mfma_f32_16x16x32_bf16 v[116:119], a[216:219], v[136:139], 0
s_waitcnt lgkmcnt(4)
ds_read_b64_tr_b16 a[232:233], v30 offset:4096
v_cvt_pk_bf16_f32 v169, v170, v171
v_mfma_f32_16x16x32_bf16 v[120:123], a[220:223], v[128:131], 0
ds_read_b64_tr_b16 a[234:235], v30 offset:6144
v_cvt_pk_bf16_f32 v170, v172, v173
v_mfma_f32_16x16x32_bf16 v[124:127], a[220:223], v[136:139], 0
s_waitcnt lgkmcnt(4)
ds_read_b64_tr_b16 a[236:237], v31 offset:4096
v_cvt_pk_bf16_f32 v171, v174, v175
v_mfma_f32_16x16x32_bf16 v[96:99], a[224:227], v[144:147], v[96:99]
ds_read_b64_tr_b16 a[238:239], v31 offset:6144
v_cvt_pk_bf16_f32 v176, v176, v177
v_mfma_f32_16x16x32_bf16 v[100:103], a[224:227], v[152:155], v[100:103]
s_waitcnt lgkmcnt(4)
buffer_load_dwordx4 v9, s[24:27], s33 offen offset:1024 lds
v_mfma_f32_16x16x32_bf16 v[104:107], a[228:231], v[144:147], v[104:107]
ds_read_b64_tr_b16 a[192:193], v28 offset:8192
ds_read_b64_tr_b16 a[194:195], v28 offset:10240
v_mfma_f32_16x16x32_bf16 v[108:111], a[228:231], v[152:155], v[108:111]
s_waitcnt lgkmcnt(4)
ds_read_b64_tr_b16 a[196:197], v29 offset:8192
v_cvt_pk_bf16_f32 v177, v178, v179
v_mfma_f32_16x16x32_bf16 v[112:115], a[232:235], v[144:147], v[112:115]
ds_read_b64_tr_b16 a[198:199], v29 offset:10240
v_cvt_pk_bf16_f32 v178, v180, v181
v_mfma_f32_16x16x32_bf16 v[116:119], a[232:235], v[152:155], v[116:119]
s_waitcnt lgkmcnt(4)
ds_read_b64_tr_b16 a[200:201], v30 offset:8192
v_cvt_pk_bf16_f32 v179, v182, v183
v_mfma_f32_16x16x32_bf16 v[120:123], a[236:239], v[144:147], v[120:123]
ds_read_b64_tr_b16 a[202:203], v30 offset:10240
v_cvt_pk_bf16_f32 v184, v184, v185
v_mfma_f32_16x16x32_bf16 v[124:127], a[236:239], v[152:155], v[124:127]
s_waitcnt lgkmcnt(4)
buffer_load_dwordx4 v10, s[24:27], s33 offen offset:2048 lds
v_mfma_f32_16x16x32_bf16 v[96:99], a[192:195], v[160:163], v[96:99]
ds_read_b64_tr_b16 a[204:205], v31 offset:8192
ds_read_b64_tr_b16 a[206:207], v31 offset:10240
v_mfma_f32_16x16x32_bf16 v[100:103], a[192:195], v[168:171], v[100:103]
s_waitcnt lgkmcnt(4)
ds_read_b64_tr_b16 a[208:209], v28 offset:12288
v_cvt_pk_bf16_f32 v185, v186, v187
v_mfma_f32_16x16x32_bf16 v[104:107], a[196:199], v[160:163], v[104:107]
ds_read_b64_tr_b16 a[210:211], v28 offset:14336
v_cvt_pk_bf16_f32 v186, v188, v189
v_mfma_f32_16x16x32_bf16 v[108:111], a[196:199], v[168:171], v[108:111]
s_waitcnt lgkmcnt(4)
ds_read_b64_tr_b16 a[212:213], v29 offset:12288
v_cvt_pk_bf16_f32 v187, v190, v191
v_mfma_f32_16x16x32_bf16 v[112:115], a[200:203], v[160:163], v[112:115]
ds_read_b64_tr_b16 a[214:215], v29 offset:14336
v_cvt_pk_bf16_f32 v192, v192, v193
v_mfma_f32_16x16x32_bf16 v[116:119], a[200:203], v[168:171], v[116:119]
s_waitcnt lgkmcnt(4)
buffer_load_dwordx4 v11, s[24:27], s33 offen offset:3072 lds
v_mfma_f32_16x16x32_bf16 v[120:123], a[204:207], v[160:163], v[120:123]
s_add_u32 m0, s32, 98304
ds_read_b64_tr_b16 a[216:217], v30 offset:12288
ds_read_b64_tr_b16 a[218:219], v30 offset:14336
v_mfma_f32_16x16x32_bf16 v[124:127], a[204:207], v[168:171], v[124:127]
s_waitcnt lgkmcnt(4)
ds_read_b64_tr_b16 a[220:221], v31 offset:12288
v_cvt_pk_bf16_f32 v193, v194, v195
v_mfma_f32_16x16x32_bf16 v[96:99], a[208:211], v[176:179], v[96:99]
s_waitcnt vmcnt(12)
ds_read_b64_tr_b16 a[222:223], v31 offset:14336
v_cvt_pk_bf16_f32 v194, v196, v197
v_mfma_f32_16x16x32_bf16 v[100:103], a[208:211], v[184:187], v[100:103]
s_waitcnt lgkmcnt(4)
v_cvt_pk_bf16_f32 v195, v198, v199
v_cvt_pk_bf16_f32 v200, v200, v201
v_mfma_f32_16x16x32_bf16 v[104:107], a[212:215], v[176:179], v[104:107]
s_barrier
ds_read_b64_tr_b16 a[224:225], v24 offset:0
ds_read_b64_tr_b16 a[226:227], v24 offset:2048
v_mfma_f32_16x16x32_bf16 v[108:111], a[212:215], v[184:187], v[108:111]
s_waitcnt lgkmcnt(4)
ds_read_b64_tr_b16 a[228:229], v25 offset:0
v_cvt_pk_bf16_f32 v201, v202, v203
v_mfma_f32_16x16x32_bf16 v[112:115], a[216:219], v[176:179], v[112:115]
s_add_u32 s33, s58, 114688
ds_read_b64_tr_b16 a[230:231], v25 offset:2048
v_cvt_pk_bf16_f32 v202, v204, v205
v_mfma_f32_16x16x32_bf16 v[116:119], a[216:219], v[184:187], v[116:119]
s_waitcnt lgkmcnt(4)
buffer_load_dwordx4 v8, s[24:27], s33 offen offset:0 lds
v_mfma_f32_16x16x32_bf16 v[120:123], a[220:223], v[176:179], v[120:123]
ds_read_b64_tr_b16 a[232:233], v26 offset:0
ds_read_b64_tr_b16 a[234:235], v26 offset:2048
v_mfma_f32_16x16x32_bf16 v[124:127], a[220:223], v[184:187], v[124:127]
s_waitcnt lgkmcnt(4)
ds_read_b64_tr_b16 a[236:237], v27 offset:0
v_cvt_pk_bf16_f32 v203, v206, v207
v_mfma_f32_16x16x32_bf16 v[96:99], a[224:227], v[192:195], v[96:99]
ds_read_b64_tr_b16 a[238:239], v27 offset:2048
v_cvt_pk_bf16_f32 v208, v208, v209
v_mfma_f32_16x16x32_bf16 v[100:103], a[224:227], v[200:203], v[100:103]
s_waitcnt lgkmcnt(4)
ds_read_b64_tr_b16 a[192:193], v24 offset:4096
v_cvt_pk_bf16_f32 v209, v210, v211
v_mfma_f32_16x16x32_bf16 v[104:107], a[228:231], v[192:195], v[104:107]
ds_read_b64_tr_b16 a[194:195], v24 offset:6144
v_cvt_pk_bf16_f32 v210, v212, v213
v_mfma_f32_16x16x32_bf16 v[108:111], a[228:231], v[200:203], v[108:111]
s_waitcnt lgkmcnt(4)
buffer_load_dwordx4 v9, s[24:27], s33 offen offset:1024 lds
v_mfma_f32_16x16x32_bf16 v[112:115], a[232:235], v[192:195], v[112:115]
ds_read_b64_tr_b16 a[196:197], v25 offset:4096
ds_read_b64_tr_b16 a[198:199], v25 offset:6144
v_mfma_f32_16x16x32_bf16 v[116:119], a[232:235], v[200:203], v[116:119]
s_waitcnt lgkmcnt(4)
ds_read_b64_tr_b16 a[200:201], v26 offset:4096
v_cvt_pk_bf16_f32 v211, v214, v215
v_mfma_f32_16x16x32_bf16 v[120:123], a[236:239], v[192:195], v[120:123]
ds_read_b64_tr_b16 a[202:203], v26 offset:6144
v_cvt_pk_bf16_f32 v216, v216, v217
v_mfma_f32_16x16x32_bf16 v[124:127], a[236:239], v[200:203], v[124:127]
s_waitcnt lgkmcnt(4)
ds_read_b64_tr_b16 a[204:205], v27 offset:4096
v_cvt_pk_bf16_f32 v217, v218, v219
v_mfma_f32_16x16x32_bf16 v[96:99], a[192:195], v[208:211], v[96:99]
ds_read_b64_tr_b16 a[206:207], v27 offset:6144
v_cvt_pk_bf16_f32 v218, v220, v221
v_cvt_pk_bf16_f32 v219, v222, v223
s_nop 1
v_mfma_f32_16x16x32_bf16 v[100:103], a[192:195], v[216:219], v[100:103]
s_waitcnt lgkmcnt(4)
buffer_load_dwordx4 v10, s[24:27], s33 offen offset:2048 lds
v_mfma_f32_16x16x32_bf16 v[104:107], a[196:199], v[208:211], v[104:107]
ds_read_b64_tr_b16 a[208:209], v24 offset:8192
ds_read_b64_tr_b16 a[210:211], v24 offset:10240
v_mfma_f32_16x16x32_bf16 v[108:111], a[196:199], v[216:219], v[108:111]
s_waitcnt lgkmcnt(4)
ds_read_b64_tr_b16 a[212:213], v25 offset:8192
v_cvt_pk_bf16_f32 v224, v224, v225
v_mfma_f32_16x16x32_bf16 v[112:115], a[200:203], v[208:211], v[112:115]
ds_read_b64_tr_b16 a[214:215], v25 offset:10240
v_cvt_pk_bf16_f32 v225, v226, v227
v_mfma_f32_16x16x32_bf16 v[116:119], a[200:203], v[216:219], v[116:119]
s_waitcnt lgkmcnt(4)
ds_read_b64_tr_b16 a[216:217], v26 offset:8192
v_cvt_pk_bf16_f32 v226, v228, v229
v_mfma_f32_16x16x32_bf16 v[120:123], a[204:207], v[208:211], v[120:123]
ds_read_b64_tr_b16 a[218:219], v26 offset:10240
v_cvt_pk_bf16_f32 v227, v230, v231
v_mfma_f32_16x16x32_bf16 v[124:127], a[204:207], v[216:219], v[124:127]
s_waitcnt lgkmcnt(4)
buffer_load_dwordx4 v11, s[24:27], s33 offen offset:3072 lds
v_mfma_f32_16x16x32_bf16 v[96:99], a[208:211], v[224:227], v[96:99]
s_add_u32 m0, s32, 0
ds_read_b64_tr_b16 a[220:221], v27 offset:8192
ds_read_b64_tr_b16 a[222:223], v27 offset:10240
v_cvt_pk_bf16_f32 v232, v232, v233
v_cvt_pk_bf16_f32 v233, v234, v235
v_cvt_pk_bf16_f32 v234, v236, v237
v_cvt_pk_bf16_f32 v235, v238, v239
s_nop 1
v_mfma_f32_16x16x32_bf16 v[100:103], a[208:211], v[232:235], v[100:103]
s_waitcnt lgkmcnt(4)
ds_read_b64_tr_b16 a[224:225], v24 offset:12288
v_cvt_pk_bf16_f32 v240, v240, v241
v_mfma_f32_16x16x32_bf16 v[104:107], a[212:215], v[224:227], v[104:107]
s_add_u32 s33, s59, 0
ds_read_b64_tr_b16 a[226:227], v24 offset:14336
v_cvt_pk_bf16_f32 v241, v242, v243
v_mfma_f32_16x16x32_bf16 v[108:111], a[212:215], v[232:235], v[108:111]
s_waitcnt lgkmcnt(4)
ds_read_b64_tr_b16 a[228:229], v25 offset:12288
v_cvt_pk_bf16_f32 v242, v244, v245
v_mfma_f32_16x16x32_bf16 v[112:115], a[216:219], v[224:227], v[112:115]
ds_read_b64_tr_b16 a[230:231], v25 offset:14336
v_cvt_pk_bf16_f32 v243, v246, v247
v_mfma_f32_16x16x32_bf16 v[116:119], a[216:219], v[232:235], v[116:119]
s_waitcnt lgkmcnt(4)
buffer_load_dwordx4 v8, s[24:27], s33 offen offset:0 lds
v_mfma_f32_16x16x32_bf16 v[120:123], a[220:223], v[224:227], v[120:123]
ds_read_b64_tr_b16 a[232:233], v26 offset:12288
ds_read_b64_tr_b16 a[234:235], v26 offset:14336
v_mfma_f32_16x16x32_bf16 v[124:127], a[220:223], v[232:235], v[124:127]
s_waitcnt lgkmcnt(4)
ds_read_b64_tr_b16 a[236:237], v27 offset:12288
v_cvt_pk_bf16_f32 v248, v248, v249
v_mfma_f32_16x16x32_bf16 v[96:99], a[224:227], v[240:243], v[96:99]
s_waitcnt vmcnt(13)
ds_read_b64_tr_b16 a[238:239], v27 offset:14336
v_cvt_pk_bf16_f32 v249, v250, v251
v_cvt_pk_bf16_f32 v250, v252, v253
v_cvt_pk_bf16_f32 v251, v254, v255
s_nop 1
v_mfma_f32_16x16x32_bf16 v[100:103], a[224:227], v[248:251], v[100:103]
s_waitcnt lgkmcnt(4)
v_mfma_f32_16x16x32_bf16 v[104:107], a[228:231], v[240:243], v[104:107]
s_barrier
ds_read_b64_tr_b16 a[192:193], v20 offset:49152
ds_read_b64_tr_b16 a[194:195], v20 offset:51200
v_mfma_f32_16x16x32_bf16 v[108:111], a[228:231], v[248:251], v[108:111]
s_waitcnt lgkmcnt(4)
buffer_load_dwordx4 v9, s[24:27], s33 offen offset:1024 lds
v_mfma_f32_16x16x32_bf16 v[112:115], a[232:235], v[240:243], v[112:115]
LA_t48:
s_load_dword s98, s[96:97], 44852
ds_read_b64_tr_b16 a[196:197], v21 offset:49152
ds_read_b64_tr_b16 a[198:199], v21 offset:51200
v_mfma_f32_16x16x32_bf16 v[116:119], a[232:235], v[248:251], v[116:119]
s_waitcnt lgkmcnt(4)
ds_read_b64_tr_b16 a[200:201], v20 offset:53248
ds_read_b64_tr_b16 a[202:203], v20 offset:55296
v_mfma_f32_16x16x32_bf16 v[120:123], a[236:239], v[240:243], v[120:123]
ds_read_b64_tr_b16 a[204:205], v21 offset:53248
v_mul_f32 v96, v96, v56
v_mfma_f32_16x16x32_bf16 v[124:127], a[236:239], v[248:251], v[124:127]
s_waitcnt lgkmcnt(5)
ds_read_b64_tr_b16 a[206:207], v21 offset:55296
v_mul_f32 v97, v97, v56
v_mfma_f32_16x16x32_bf16 v[132:135], a[192:195], v[128:131], 0
buffer_load_dwordx4 v10, s[24:27], s33 offen offset:2048 lds
v_mfma_f32_16x16x32_bf16 v[140:143], a[192:195], v[136:139], 0
s_waitcnt lgkmcnt(4)
ds_read_b64_tr_b16 a[208:209], v20 offset:57344
v_mul_f32 v98, v98, v56
v_mfma_f32_16x16x32_bf16 v[148:151], a[196:199], v[128:131], 0
ds_read_b64_tr_b16 a[210:211], v20 offset:59392
v_mul_f32 v99, v99, v56
v_mfma_f32_16x16x32_bf16 v[156:159], a[196:199], v[136:139], 0
s_waitcnt lgkmcnt(3)
ds_read_b64_tr_b16 a[212:213], v21 offset:57344
v_mul_f32 v104, v104, v56
v_mfma_f32_16x16x32_bf16 v[132:135], a[200:203], v[144:147], v[132:135]
ds_read_b64_tr_b16 a[214:215], v21 offset:59392
v_mul_f32 v105, v105, v56
v_mfma_f32_16x16x32_bf16 v[140:143], a[200:203], v[152:155], v[140:143]
s_waitcnt lgkmcnt(4)
buffer_load_dwordx4 v11, s[24:27], s33 offen offset:3072 lds
v_mfma_f32_16x16x32_bf16 v[148:151], a[204:207], v[144:147], v[148:151]
s_add_u32 m0, s32, 81920
ds_read_b64_tr_b16 a[216:217], v20 offset:61440
ds_read_b64_tr_b16 a[218:219], v20 offset:63488
v_mfma_f32_16x16x32_bf16 v[156:159], a[204:207], v[152:155], v[156:159]
s_waitcnt lgkmcnt(4)
ds_read_b64_tr_b16 a[220:221], v21 offset:61440
v_mul_f32 v106, v106, v56
v_mfma_f32_16x16x32_bf16 v[132:135], a[208:211], v[160:163], v[132:135]
s_waitcnt vmcnt(12)
ds_read_b64_tr_b16 a[222:223], v21 offset:63488
v_mul_f32 v107, v107, v56
v_mfma_f32_16x16x32_bf16 v[140:143], a[208:211], v[168:171], v[140:143]
s_waitcnt lgkmcnt(4)
v_cvt_pk_bf16_f32 v72, v96, v97
v_cvt_pk_bf16_f32 v73, v98, v99
v_mfma_f32_16x16x32_bf16 v[148:151], a[212:215], v[160:163], v[148:151]
s_barrier
ds_read_b64_tr_b16 a[224:225], v20 offset:32768
ds_read_b64_tr_b16 a[226:227], v20 offset:34816
v_mfma_f32_16x16x32_bf16 v[156:159], a[212:215], v[168:171], v[156:159]
s_waitcnt lgkmcnt(4)
ds_read_b64_tr_b16 a[228:229], v21 offset:32768
v_cvt_pk_bf16_f32 v74, v104, v105
v_mfma_f32_16x16x32_bf16 v[132:135], a[216:219], v[176:179], v[132:135]
s_add_u32 s33, s59, 114688
ds_read_b64_tr_b16 a[230:231], v21 offset:34816
v_cvt_pk_bf16_f32 v75, v106, v107
v_mfma_f32_16x16x32_bf16 v[140:143], a[216:219], v[184:187], v[140:143]
s_waitcnt lgkmcnt(4)
buffer_load_dwordx4 v8, s[24:27], s33 offen offset:0 lds
v_mfma_f32_16x16x32_bf16 v[148:151], a[220:223], v[176:179], v[148:151]
ds_read_b64_tr_b16 a[232:233], v20 offset:36864
ds_read_b64_tr_b16 a[234:235], v20 offset:38912
v_mfma_f32_16x16x32_bf16 v[156:159], a[220:223], v[184:187], v[156:159]
s_waitcnt lgkmcnt(4)
ds_write_b128 v16, v[72:75] offset:0
v_mfma_f32_16x16x32_bf16 v[132:135], a[224:227], v[192:195], v[132:135]
s_add_u32 s34, s77, 12288
ds_read_b64_tr_b16 a[236:237], v21 offset:36864
ds_read_b64_tr_b16 a[238:239], v21 offset:38912
v_mfma_f32_16x16x32_bf16 v[140:143], a[224:227], v[200:203], v[140:143]
s_waitcnt lgkmcnt(5)
buffer_store_dwordx4 v[72:75], v4, s[28:31], s34 offen sc1
v_mfma_f32_16x16x32_bf16 v[148:151], a[228:231], v[192:195], v[148:151]
ds_read_b64_tr_b16 a[192:193], v20 offset:40960
ds_read_b64_tr_b16 a[194:195], v20 offset:43008
v_mfma_f32_16x16x32_bf16 v[156:159], a[228:231], v[200:203], v[156:159]
s_waitcnt lgkmcnt(5)
buffer_load_dwordx4 v9, s[24:27], s33 offen offset:1024 lds
v_mfma_f32_16x16x32_bf16 v[132:135], a[232:235], v[208:211], v[132:135]
ds_read_b64_tr_b16 a[196:197], v21 offset:40960
ds_read_b64_tr_b16 a[198:199], v21 offset:43008
v_mfma_f32_16x16x32_bf16 v[140:143], a[232:235], v[216:219], v[140:143]
s_waitcnt lgkmcnt(4)
ds_read_b64_tr_b16 a[200:201], v20 offset:45056
v_mul_f32 v100, v100, v57
v_mfma_f32_16x16x32_bf16 v[148:151], a[236:239], v[208:211], v[148:151]
ds_read_b64_tr_b16 a[202:203], v20 offset:47104
v_mul_f32 v101, v101, v57
v_mfma_f32_16x16x32_bf16 v[156:159], a[236:239], v[216:219], v[156:159]
s_waitcnt lgkmcnt(4)
ds_read_b64_tr_b16 a[204:205], v21 offset:45056
v_mul_f32 v102, v102, v57
v_mfma_f32_16x16x32_bf16 v[132:135], a[192:195], v[224:227], v[132:135]
ds_read_b64_tr_b16 a[206:207], v21 offset:47104
v_mul_f32 v103, v103, v57
v_mfma_f32_16x16x32_bf16 v[140:143], a[192:195], v[232:235], v[140:143]
s_waitcnt lgkmcnt(4)
buffer_load_dwordx4 v10, s[24:27], s33 offen offset:2048 lds
v_mfma_f32_16x16x32_bf16 v[148:151], a[196:199], v[224:227], v[148:151]
ds_read_b64_tr_b16 a[208:209], v22 offset:49152
ds_read_b64_tr_b16 a[210:211], v22 offset:51200
v_mfma_f32_16x16x32_bf16 v[156:159], a[196:199], v[232:235], v[156:159]
s_waitcnt lgkmcnt(4)
ds_read_b64_tr_b16 a[212:213], v23 offset:49152
v_mul_f32 v108, v108, v57
v_mfma_f32_16x16x32_bf16 v[132:135], a[200:203], v[240:243], v[132:135]
ds_read_b64_tr_b16 a[214:215], v23 offset:51200
v_mul_f32 v109, v109, v57
v_mfma_f32_16x16x32_bf16 v[140:143], a[200:203], v[248:251], v[140:143]
s_waitcnt lgkmcnt(4)
ds_read_b64_tr_b16 a[216:217], v22 offset:53248
v_mul_f32 v110, v110, v57
v_mfma_f32_16x16x32_bf16 v[148:151], a[204:207], v[240:243], v[148:151]
ds_read_b64_tr_b16 a[218:219], v22 offset:55296
v_mul_f32 v111, v111, v57
v_mfma_f32_16x16x32_bf16 v[156:159], a[204:207], v[248:251], v[156:159]
s_waitcnt lgkmcnt(4)
buffer_load_dwordx4 v11, s[24:27], s33 offen offset:3072 lds
v_mfma_f32_16x16x32_bf16 v[164:167], a[208:211], v[128:131], 0
s_add_u32 m0, s32, 114688
ds_read_b64_tr_b16 a[220:221], v23 offset:53248
ds_read_b64_tr_b16 a[222:223], v23 offset:55296
v_mfma_f32_16x16x32_bf16 v[172:175], a[208:211], v[136:139], 0
s_waitcnt lgkmcnt(4)
ds_read_b64_tr_b16 a[224:225], v22 offset:57344
v_cvt_pk_bf16_f32 v76, v100, v101
v_mfma_f32_16x16x32_bf16 v[180:183], a[212:215], v[128:131], 0
s_add_u32 s33, s60, 0
ds_read_b64_tr_b16 a[226:227], v22 offset:59392
v_cvt_pk_bf16_f32 v77, v102, v103
v_mfma_f32_16x16x32_bf16 v[188:191], a[212:215], v[136:139], 0
s_waitcnt lgkmcnt(4)
ds_read_b64_tr_b16 a[228:229], v23 offset:57344
v_cvt_pk_bf16_f32 v78, v108, v109
v_mfma_f32_16x16x32_bf16 v[164:167], a[216:219], v[144:147], v[164:167]
ds_read_b64_tr_b16 a[230:231], v23 offset:59392
v_cvt_pk_bf16_f32 v79, v110, v111
v_mfma_f32_16x16x32_bf16 v[172:175], a[216:219], v[152:155], v[172:175]
s_waitcnt lgkmcnt(4)
buffer_load_dwordx4 v8, s[24:27], s33 offen offset:0 lds
v_mfma_f32_16x16x32_bf16 v[180:183], a[220:223], v[144:147], v[180:183]
s_mov_b32 s34, 14336
ds_read_b64_tr_b16 a[232:233], v22 offset:61440
ds_read_b64_tr_b16 a[234:235], v22 offset:63488
v_mfma_f32_16x16x32_bf16 v[188:191], a[220:223], v[152:155], v[188:191]
s_waitcnt lgkmcnt(4)
buffer_store_dwordx4 v[76:79], v4, s[28:31], s34 offen sc1
v_mfma_f32_16x16x32_bf16 v[164:167], a[224:227], v[160:163], v[164:167]
ds_read_b64_tr_b16 a[236:237], v23 offset:61440
ds_read_b64_tr_b16 a[238:239], v23 offset:63488
v_mfma_f32_16x16x32_bf16 v[172:175], a[224:227], v[168:171], v[172:175]
s_waitcnt lgkmcnt(4)
ds_read_b64_tr_b16 a[192:193], v22 offset:32768
v_mul_f32 v112, v112, v56
v_mfma_f32_16x16x32_bf16 v[180:183], a[228:231], v[160:163], v[180:183]
ds_read_b64_tr_b16 a[194:195], v22 offset:34816
v_mul_f32 v113, v113, v56
v_mfma_f32_16x16x32_bf16 v[188:191], a[228:231], v[168:171], v[188:191]
s_waitcnt lgkmcnt(4)
buffer_load_dwordx4 v9, s[24:27], s33 offen offset:1024 lds
v_mfma_f32_16x16x32_bf16 v[164:167], a[232:235], v[176:179], v[164:167]
ds_read_b64_tr_b16 a[196:197], v23 offset:32768
ds_read_b64_tr_b16 a[198:199], v23 offset:34816
v_mfma_f32_16x16x32_bf16 v[172:175], a[232:235], v[184:187], v[172:175]
s_waitcnt lgkmcnt(4)
ds_read_b64_tr_b16 a[200:201], v22 offset:36864
v_mul_f32 v114, v114, v56
v_mfma_f32_16x16x32_bf16 v[180:183], a[236:239], v[176:179], v[180:183]
ds_read_b64_tr_b16 a[202:203], v22 offset:38912
v_mul_f32 v115, v115, v56
v_mfma_f32_16x16x32_bf16 v[188:191], a[236:239], v[184:187], v[188:191]
s_waitcnt lgkmcnt(4)
ds_read_b64_tr_b16 a[204:205], v23 offset:36864
v_mul_f32 v120, v120, v56
v_mfma_f32_16x16x32_bf16 v[164:167], a[192:195], v[192:195], v[164:167]
ds_read_b64_tr_b16 a[206:207], v23 offset:38912
v_mul_f32 v121, v121, v56
v_mfma_f32_16x16x32_bf16 v[172:175], a[192:195], v[200:203], v[172:175]
s_waitcnt lgkmcnt(4)
buffer_load_dwordx4 v10, s[24:27], s33 offen offset:2048 lds
v_mfma_f32_16x16x32_bf16 v[180:183], a[196:199], v[192:195], v[180:183]
ds_read_b64_tr_b16 a[208:209], v22 offset:40960
ds_read_b64_tr_b16 a[210:211], v22 offset:43008
v_mfma_f32_16x16x32_bf16 v[188:191], a[196:199], v[200:203], v[188:191]
s_waitcnt lgkmcnt(4)
ds_read_b64_tr_b16 a[212:213], v23 offset:40960
v_mul_f32 v122, v122, v56
v_mfma_f32_16x16x32_bf16 v[164:167], a[200:203], v[208:211], v[164:167]
ds_read_b64_tr_b16 a[214:215], v23 offset:43008
v_mul_f32 v123, v123, v56
v_mfma_f32_16x16x32_bf16 v[172:175], a[200:203], v[216:219], v[172:175]
s_waitcnt lgkmcnt(4)
ds_read_b64_tr_b16 a[216:217], v22 offset:45056
v_cvt_pk_bf16_f32 v80, v112, v113
v_mfma_f32_16x16x32_bf16 v[180:183], a[204:207], v[208:211], v[180:183]
ds_read_b64_tr_b16 a[218:219], v22 offset:47104
v_cvt_pk_bf16_f32 v81, v114, v115
v_mfma_f32_16x16x32_bf16 v[188:191], a[204:207], v[216:219], v[188:191]
s_waitcnt lgkmcnt(4)
buffer_load_dwordx4 v11, s[24:27], s33 offen offset:3072 lds
v_mfma_f32_16x16x32_bf16 v[164:167], a[208:211], v[224:227], v[164:167]
s_waitcnt vmcnt(18)
ds_read_b64_tr_b16 a[220:221], v23 offset:45056
ds_read_b64_tr_b16 a[222:223], v23 offset:47104
v_mfma_f32_16x16x32_bf16 v[172:175], a[208:211], v[232:235], v[172:175]
s_waitcnt lgkmcnt(4)
v_cvt_pk_bf16_f32 v82, v120, v121
v_cvt_pk_bf16_f32 v83, v122, v123
v_mfma_f32_16x16x32_bf16 v[180:183], a[212:215], v[224:227], v[180:183]
s_barrier
ds_read_b64_tr_b16 a[224:225], v20 offset:16384
ds_read_b64_tr_b16 a[226:227], v20 offset:18432
v_mfma_f32_16x16x32_bf16 v[188:191], a[212:215], v[232:235], v[188:191]
s_waitcnt lgkmcnt(4)
ds_read_b64_tr_b16 a[228:229], v21 offset:16384
ds_read_b64_tr_b16 a[230:231], v21 offset:18432
v_mfma_f32_16x16x32_bf16 v[164:167], a[216:219], v[240:243], v[164:167]
LA_t50:
s_load_dword s98, s[96:97], 44852
ds_read_b64_tr_b16 a[232:233], v20 offset:20480
ds_read_b64_tr_b16 a[234:235], v20 offset:22528
v_mfma_f32_16x16x32_bf16 v[172:175], a[216:219], v[248:251], v[172:175]
s_waitcnt lgkmcnt(6)
ds_read_b64_tr_b16 a[236:237], v21 offset:20480
ds_read_b64_tr_b16 a[238:239], v21 offset:22528
v_mfma_f32_16x16x32_bf16 v[180:183], a[220:223], v[240:243], v[180:183]
s_add_u32 m0, s32, 131072
ds_read_b64_tr_b16 a[192:193], v20 offset:24576
ds_read_b64_tr_b16 a[194:195], v20 offset:26624
v_mfma_f32_16x16x32_bf16 v[188:191], a[220:223], v[248:251], v[188:191]
s_waitcnt lgkmcnt(8)
ds_read_b64_tr_b16 a[196:197], v21 offset:24576
ds_read_b64_tr_b16 a[198:199], v21 offset:26624
s_mov_b32 s34, 13312
buffer_store_dwordx4 v[80:83], v4, s[28:31], s34 offen sc1
v_mul_f32 v116, v116, v57
v_mul_f32 v117, v117, v57
v_mul_f32 v118, v118, v57
v_mul_f32 v119, v119, v57
v_mul_f32 v124, v124, v57
v_mul_f32 v125, v125, v57
v_mul_f32 v126, v126, v57
v_mul_f32 v127, v127, v57
v_cvt_pk_bf16_f32 v84, v116, v117
v_cvt_pk_bf16_f32 v85, v118, v119
v_cvt_pk_bf16_f32 v86, v124, v125
v_cvt_pk_bf16_f32 v87, v126, v127
s_mov_b32 s34, 15360
buffer_store_dwordx4 v[84:87], v4, s[28:31], s34 offen sc1
v_mfma_f32_16x16x32_bf16 v[96:99], a[224:227], v[128:131], 0
s_add_u32 s33, s60, 114688
buffer_load_dwordx4 v8, s[24:27], s33 offen offset:0 lds
v_mfma_f32_16x16x32_bf16 v[100:103], a[224:227], v[136:139], 0
s_waitcnt lgkmcnt(6)
ds_read_b64_tr_b16 a[200:201], v20 offset:28672
v_mul_f32 v132, v132, v56
v_mfma_f32_16x16x32_bf16 v[104:107], a[228:231], v[128:131], 0
ds_read_b64_tr_b16 a[202:203], v20 offset:30720
v_mul_f32 v133, v133, v56
v_mfma_f32_16x16x32_bf16 v[108:111], a[228:231], v[136:139], 0
s_waitcnt vmcnt(17)
ds_read_b64_tr_b16 a[204:205], v21 offset:28672
v_mul_f32 v134, v134, v56
v_mfma_f32_16x16x32_bf16 v[96:99], a[232:235], v[144:147], v[96:99]
ds_read_b64_tr_b16 a[206:207], v21 offset:30720
v_mul_f32 v135, v135, v56
v_mfma_f32_16x16x32_bf16 v[100:103], a[232:235], v[152:155], v[100:103]
s_waitcnt lgkmcnt(4)
buffer_load_dwordx4 v9, s[24:27], s33 offen offset:1024 lds
v_mfma_f32_16x16x32_bf16 v[104:107], a[236:239], v[144:147], v[104:107]
s_barrier
ds_read_b64_tr_b16 a[208:209], v24 offset:32768
v_mul_f32 v148, v148, v56
v_mfma_f32_16x16x32_bf16 v[108:111], a[236:239], v[152:155], v[108:111]
ds_read_b64_tr_b16 a[210:211], v24 offset:34816
v_mul_f32 v149, v149, v56
v_mfma_f32_16x16x32_bf16 v[96:99], a[192:195], v[160:163], v[96:99]
ds_read_b64_tr_b16 a[212:213], v25 offset:32768
v_mul_f32 v150, v150, v56
v_mfma_f32_16x16x32_bf16 v[100:103], a[192:195], v[168:171], v[100:103]
ds_read_b64_tr_b16 a[214:215], v25 offset:34816
v_mul_f32 v151, v151, v56
v_mfma_f32_16x16x32_bf16 v[104:107], a[196:199], v[160:163], v[104:107]
buffer_load_dwordx4 v10, s[24:27], s33 offen offset:2048 lds
v_mfma_f32_16x16x32_bf16 v[108:111], a[196:199], v[168:171], v[108:111]
s_waitcnt lgkmcnt(3)
ds_read_b64_tr_b16 a[216:217], v24 offset:36864
v_cvt_pk_bf16_f32 v88, v132, v133
v_mfma_f32_16x16x32_bf16 v[96:99], a[200:203], v[176:179], v[96:99]
ds_read_b64_tr_b16 a[218:219], v24 offset:38912
v_cvt_pk_bf16_f32 v89, v134, v135
v_mfma_f32_16x16x32_bf16 v[100:103], a[200:203], v[184:187], v[100:103]
ds_read_b64_tr_b16 a[220:221], v25 offset:36864
v_cvt_pk_bf16_f32 v90, v148, v149
v_mfma_f32_16x16x32_bf16 v[104:107], a[204:207], v[176:179], v[104:107]
ds_read_b64_tr_b16 a[222:223], v25 offset:38912
v_cvt_pk_bf16_f32 v91, v150, v151
v_mfma_f32_16x16x32_bf16 v[108:111], a[204:207], v[184:187], v[108:111]
s_waitcnt lgkmcnt(4)
buffer_load_dwordx4 v11, s[24:27], s33 offen offset:3072 lds
v_mfma_f32_16x16x32_bf16 v[96:99], a[208:211], v[192:195], v[96:99]
s_add_u32 m0, s32, 65536
ds_write_b128 v16, v[88:91] offset:1024
v_mfma_f32_16x16x32_bf16 v[100:103], a[208:211], v[200:203], v[100:103]
s_add_u32 s33, s61, 0
ds_read_b64_tr_b16 a[224:225], v24 offset:40960
ds_read_b64_tr_b16 a[226:227], v24 offset:43008
v_mfma_f32_16x16x32_bf16 v[104:107], a[212:215], v[192:195], v[104:107]
s_add_u32 s34, s77, 28672
buffer_store_dwordx4 v[88:91], v4, s[28:31], s34 offen sc1
v_mfma_f32_16x16x32_bf16 v[108:111], a[212:215], v[200:203], v[108:111]
s_waitcnt lgkmcnt(3)
ds_read_b64_tr_b16 a[228:229], v25 offset:40960
v_mul_f32 v140, v140, v57
v_mfma_f32_16x16x32_bf16 v[96:99], a[216:219], v[208:211], v[96:99]
ds_read_b64_tr_b16 a[230:231], v25 offset:43008
v_mul_f32 v141, v141, v57
v_mfma_f32_16x16x32_bf16 v[100:103], a[216:219], v[216:219], v[100:103]
buffer_load_dwordx4 v8, s[24:27], s33 offen offset:0 lds
v_mfma_f32_16x16x32_bf16 v[104:107], a[220:223], v[208:211], v[104:107]
ds_read_b64_tr_b16 a[232:233], v24 offset:45056
ds_read_b64_tr_b16 a[234:235], v24 offset:47104
v_mfma_f32_16x16x32_bf16 v[108:111], a[220:223], v[216:219], v[108:111]
s_waitcnt lgkmcnt(4)
ds_read_b64_tr_b16 a[236:237], v25 offset:45056
v_mul_f32 v142, v142, v57
v_mfma_f32_16x16x32_bf16 v[96:99], a[224:227], v[224:227], v[96:99]
ds_read_b64_tr_b16 a[238:239], v25 offset:47104
v_mul_f32 v143, v143, v57
v_mfma_f32_16x16x32_bf16 v[100:103], a[224:227], v[232:235], v[100:103]
s_waitcnt lgkmcnt(4)
ds_read_b64_tr_b16 a[192:193], v22 offset:16384
v_mul_f32 v156, v156, v57
v_mfma_f32_16x16x32_bf16 v[104:107], a[228:231], v[224:227], v[104:107]
ds_read_b64_tr_b16 a[194:195], v22 offset:18432
v_mul_f32 v157, v157, v57
v_mfma_f32_16x16x32_bf16 v[108:111], a[228:231], v[232:235], v[108:111]
s_waitcnt lgkmcnt(4)
buffer_load_dwordx4 v9, s[24:27], s33 offen offset:1024 lds
v_mfma_f32_16x16x32_bf16 v[96:99], a[232:235], v[240:243], v[96:99]
ds_read_b64_tr_b16 a[196:197], v23 offset:16384
ds_read_b64_tr_b16 a[198:199], v23 offset:18432
v_mfma_f32_16x16x32_bf16 v[100:103], a[232:235], v[248:251], v[100:103]
s_waitcnt lgkmcnt(4)
ds_read_b64_tr_b16 a[200:201], v22 offset:20480
v_mul_f32 v158, v158, v57
v_mfma_f32_16x16x32_bf16 v[104:107], a[236:239], v[240:243], v[104:107]
ds_read_b64_tr_b16 a[202:203], v22 offset:22528
v_mul_f32 v159, v159, v57
v_mfma_f32_16x16x32_bf16 v[108:111], a[236:239], v[248:251], v[108:111]
s_waitcnt lgkmcnt(4)
ds_read_b64_tr_b16 a[204:205], v23 offset:20480
v_cvt_pk_bf16_f32 v92, v140, v141
v_mfma_f32_16x16x32_bf16 v[112:115], a[192:195], v[128:131], 0
ds_read_b64_tr_b16 a[206:207], v23 offset:22528
v_cvt_pk_bf16_f32 v93, v142, v143
v_mfma_f32_16x16x32_bf16 v[116:119], a[192:195], v[136:139], 0
s_waitcnt lgkmcnt(4)
buffer_load_dwordx4 v10, s[24:27], s33 offen offset:2048 lds
v_mfma_f32_16x16x32_bf16 v[120:123], a[196:199], v[128:131], 0
ds_read_b64_tr_b16 a[208:209], v22 offset:24576
ds_read_b64_tr_b16 a[210:211], v22 offset:26624
v_mfma_f32_16x16x32_bf16 v[124:127], a[196:199], v[136:139], 0
s_waitcnt lgkmcnt(4)
ds_read_b64_tr_b16 a[212:213], v23 offset:24576
v_cvt_pk_bf16_f32 v94, v156, v157
v_mfma_f32_16x16x32_bf16 v[112:115], a[200:203], v[144:147], v[112:115]
ds_read_b64_tr_b16 a[214:215], v23 offset:26624
v_cvt_pk_bf16_f32 v95, v158, v159
v_mfma_f32_16x16x32_bf16 v[116:119], a[200:203], v[152:155], v[116:119]
s_waitcnt lgkmcnt(4)
ds_read_b64_tr_b16 a[216:217], v22 offset:28672
ds_read_b64_tr_b16 a[218:219], v22 offset:30720
v_mfma_f32_16x16x32_bf16 v[120:123], a[204:207], v[144:147], v[120:123]
s_mov_b32 s34, 30720
buffer_load_dwordx4 v11, s[24:27], s33 offen offset:3072 lds
v_mfma_f32_16x16x32_bf16 v[124:127], a[204:207], v[152:155], v[124:127]
s_waitcnt lgkmcnt(4)
buffer_store_dwordx4 v[92:95], v4, s[28:31], s34 offen sc1
v_mfma_f32_16x16x32_bf16 v[112:115], a[208:211], v[160:163], v[112:115]
s_add_u32 m0, s32, 49152
ds_read_b64_tr_b16 a[220:221], v23 offset:28672
ds_read_b64_tr_b16 a[222:223], v23 offset:30720
v_mfma_f32_16x16x32_bf16 v[116:119], a[208:211], v[168:171], v[116:119]
s_waitcnt lgkmcnt(4)
ds_read_b64_tr_b16 a[224:225], v26 offset:32768
v_mul_f32 v164, v164, v56
v_mfma_f32_16x16x32_bf16 v[120:123], a[212:215], v[160:163], v[120:123]
s_add_u32 s33, s61, 114688
ds_read_b64_tr_b16 a[226:227], v26 offset:34816
v_mul_f32 v165, v165, v56
v_mfma_f32_16x16x32_bf16 v[124:127], a[212:215], v[168:171], v[124:127]
s_waitcnt lgkmcnt(4)
buffer_load_dwordx4 v8, s[24:27], s33 offen offset:0 lds
v_mfma_f32_16x16x32_bf16 v[112:115], a[216:219], v[176:179], v[112:115]
ds_read_b64_tr_b16 a[228:229], v27 offset:32768
ds_read_b64_tr_b16 a[230:231], v27 offset:34816
v_mfma_f32_16x16x32_bf16 v[116:119], a[216:219], v[184:187], v[116:119]
s_waitcnt lgkmcnt(4)
ds_read_b64_tr_b16 a[232:233], v26 offset:36864
v_mul_f32 v166, v166, v56
v_mfma_f32_16x16x32_bf16 v[120:123], a[220:223], v[176:179], v[120:123]
ds_read_b64_tr_b16 a[234:235], v26 offset:38912
v_mul_f32 v167, v167, v56
v_mfma_f32_16x16x32_bf16 v[124:127], a[220:223], v[184:187], v[124:127]
s_waitcnt lgkmcnt(4)
ds_read_b64_tr_b16 a[236:237], v27 offset:36864
v_mul_f32 v180, v180, v56
v_mfma_f32_16x16x32_bf16 v[112:115], a[224:227], v[192:195], v[112:115]
ds_read_b64_tr_b16 a[238:239], v27 offset:38912
v_mul_f32 v181, v181, v56
v_mfma_f32_16x16x32_bf16 v[116:119], a[224:227], v[200:203], v[116:119]
s_waitcnt lgkmcnt(4)
buffer_load_dwordx4 v9, s[24:27], s33 offen offset:1024 lds
v_mfma_f32_16x16x32_bf16 v[120:123], a[228:231], v[192:195], v[120:123]
ds_read_b64_tr_b16 a[192:193], v26 offset:40960
ds_read_b64_tr_b16 a[194:195], v26 offset:43008
v_mfma_f32_16x16x32_bf16 v[124:127], a[228:231], v[200:203], v[124:127]
s_waitcnt lgkmcnt(4)
ds_read_b64_tr_b16 a[196:197], v27 offset:40960
v_mul_f32 v182, v182, v56
v_mfma_f32_16x16x32_bf16 v[112:115], a[232:235], v[208:211], v[112:115]
ds_read_b64_tr_b16 a[198:199], v27 offset:43008
v_mul_f32 v183, v183, v56
v_mfma_f32_16x16x32_bf16 v[116:119], a[232:235], v[216:219], v[116:119]
s_waitcnt lgkmcnt(4)
ds_read_b64_tr_b16 a[200:201], v26 offset:45056
v_cvt_pk_bf16_f32 v72, v164, v165
v_mfma_f32_16x16x32_bf16 v[120:123], a[236:239], v[208:211], v[120:123]
ds_read_b64_tr_b16 a[202:203], v26 offset:47104
v_cvt_pk_bf16_f32 v73, v166, v167
v_mfma_f32_16x16x32_bf16 v[124:127], a[236:239], v[216:219], v[124:127]
s_waitcnt lgkmcnt(4)
buffer_load_dwordx4 v10, s[24:27], s33 offen offset:2048 lds
v_mfma_f32_16x16x32_bf16 v[112:115], a[192:195], v[224:227], v[112:115]
s_waitcnt vmcnt(25)
ds_read_b64_tr_b16 a[204:205], v27 offset:45056
ds_read_b64_tr_b16 a[206:207], v27 offset:47104
v_mfma_f32_16x16x32_bf16 v[116:119], a[192:195], v[232:235], v[116:119]
s_waitcnt lgkmcnt(4)
v_cvt_pk_bf16_f32 v74, v180, v181
v_cvt_pk_bf16_f32 v75, v182, v183
v_mfma_f32_16x16x32_bf16 v[120:123], a[196:199], v[224:227], v[120:123]
s_barrier
ds_read_b64_tr_b16 a[208:209], v20 offset:0
ds_read_b64_tr_b16 a[210:211], v20 offset:2048
v_mfma_f32_16x16x32_bf16 v[124:127], a[196:199], v[232:235], v[124:127]
s_waitcnt lgkmcnt(4)
ds_read_b64_tr_b16 a[212:213], v21 offset:0
ds_read_b64_tr_b16 a[214:215], v21 offset:2048
v_mfma_f32_16x16x32_bf16 v[112:115], a[200:203], v[240:243], v[112:115]
LA_t52:
s_load_dword s98, s[96:97], 44852
buffer_load_dwordx4 v11, s[24:27], s33 offen offset:3072 lds
v_mfma_f32_16x16x32_bf16 v[116:119], a[200:203], v[248:251], v[116:119]
s_waitcnt lgkmcnt(4)
ds_read_b64_tr_b16 a[216:217], v20 offset:4096
ds_read_b64_tr_b16 a[218:219], v20 offset:6144
v_mfma_f32_16x16x32_bf16 v[120:123], a[204:207], v[240:243], v[120:123]
s_add_u32 m0, s32, 32768
ds_read_b64_tr_b16 a[220:221], v21 offset:4096
ds_read_b64_tr_b16 a[222:223], v21 offset:6144
v_mfma_f32_16x16x32_bf16 v[124:127], a[204:207], v[248:251], v[124:127]
s_waitcnt lgkmcnt(6)
ds_read_b64_tr_b16 a[224:225], v20 offset:8192
ds_read_b64_tr_b16 a[226:227], v20 offset:10240
s_mov_b32 s34, 29696
buffer_store_dwordx4 v[72:75], v4, s[28:31], s34 offen sc1
v_mul_f32 v172, v172, v57
v_mul_f32 v173, v173, v57
v_mul_f32 v174, v174, v57
v_mul_f32 v175, v175, v57
v_mul_f32 v188, v188, v57
v_mul_f32 v189, v189, v57
v_mul_f32 v190, v190, v57
v_mul_f32 v191, v191, v57
v_cvt_pk_bf16_f32 v76, v172, v173
v_cvt_pk_bf16_f32 v77, v174, v175
v_cvt_pk_bf16_f32 v78, v188, v189
v_cvt_pk_bf16_f32 v79, v190, v191
s_mov_b32 s34, 31744
buffer_store_dwordx4 v[76:79], v4, s[28:31], s34 offen sc1
v_mfma_f32_16x16x32_bf16 v[132:135], a[208:211], v[128:131], 0
s_add_u32 s33, s62, 0
ds_read_b64_tr_b16 a[228:229], v21 offset:8192
v_mul_f32 v96, v96, v56
v_mfma_f32_16x16x32_bf16 v[140:143], a[208:211], v[136:139], 0
s_waitcnt lgkmcnt(7)
buffer_load_dwordx4 v8, s[24:27], s33 offen offset:0 lds
v_mfma_f32_16x16x32_bf16 v[148:151], a[212:215], v[128:131], 0
ds_read_b64_tr_b16 a[230:231], v21 offset:10240
v_mul_f32 v97, v97, v56
v_mfma_f32_16x16x32_bf16 v[156:159], a[212:215], v[136:139], 0
s_waitcnt lgkmcnt(4)
ds_read_b64_tr_b16 a[232:233], v20 offset:12288
v_mul_f32 v98, v98, v56
v_mfma_f32_16x16x32_bf16 v[132:135], a[216:219], v[144:147], v[132:135]
ds_read_b64_tr_b16 a[234:235], v20 offset:14336
v_mul_f32 v99, v99, v56
v_mfma_f32_16x16x32_bf16 v[140:143], a[216:219], v[152:155], v[140:143]
s_waitcnt vmcnt(24)
ds_read_b64_tr_b16 a[236:237], v21 offset:12288
v_mul_f32 v104, v104, v56
v_mfma_f32_16x16x32_bf16 v[148:151], a[220:223], v[144:147], v[148:151]
buffer_load_dwordx4 v9, s[24:27], s33 offen offset:1024 lds
v_mfma_f32_16x16x32_bf16 v[156:159], a[220:223], v[152:155], v[156:159]
s_waitcnt lgkmcnt(3)
ds_read_b64_tr_b16 a[238:239], v21 offset:14336
v_mul_f32 v105, v105, v56
v_mfma_f32_16x16x32_bf16 v[132:135], a[224:227], v[160:163], v[132:135]
s_barrier
ds_read_b64_tr_b16 a[192:193], v24 offset:16384
v_mul_f32 v106, v106, v56
v_mfma_f32_16x16x32_bf16 v[140:143], a[224:227], v[168:171], v[140:143]
ds_read_b64_tr_b16 a[194:195], v24 offset:18432
v_mul_f32 v107, v107, v56
v_mfma_f32_16x16x32_bf16 v[148:151], a[228:231], v[160:163], v[148:151]
ds_read_b64_tr_b16 a[196:197], v25 offset:16384
v_cvt_pk_bf16_f32 v80, v96, v97
v_mfma_f32_16x16x32_bf16 v[156:159], a[228:231], v[168:171], v[156:159]
s_waitcnt lgkmcnt(4)
buffer_load_dwordx4 v10, s[24:27], s33 offen offset:2048 lds
v_mfma_f32_16x16x32_bf16 v[132:135], a[232:235], v[176:179], v[132:135]
ds_read_b64_tr_b16 a[198:199], v25 offset:18432
v_cvt_pk_bf16_f32 v81, v98, v99
v_mfma_f32_16x16x32_bf16 v[140:143], a[232:235], v[184:187], v[140:143]
s_waitcnt lgkmcnt(3)
ds_read_b64_tr_b16 a[200:201], v24 offset:20480
v_cvt_pk_bf16_f32 v82, v104, v105
v_mfma_f32_16x16x32_bf16 v[148:151], a[236:239], v[176:179], v[148:151]
ds_read_b64_tr_b16 a[202:203], v24 offset:22528
v_cvt_pk_bf16_f32 v83, v106, v107
v_mfma_f32_16x16x32_bf16 v[156:159], a[236:239], v[184:187], v[156:159]
s_waitcnt lgkmcnt(3)
ds_write_b128 v16, v[80:83] offset:2048
v_mfma_f32_16x16x32_bf16 v[132:135], a[192:195], v[192:195], v[132:135]
s_add_u32 s34, s77, 45056
ds_read_b64_tr_b16 a[204:205], v25 offset:20480
ds_read_b64_tr_b16 a[206:207], v25 offset:22528
v_mfma_f32_16x16x32_bf16 v[140:143], a[192:195], v[200:203], v[140:143]
s_waitcnt lgkmcnt(5)
buffer_load_dwordx4 v11, s[24:27], s33 offen offset:3072 lds
v_mfma_f32_16x16x32_bf16 v[148:151], a[196:199], v[192:195], v[148:151]
s_add_u32 m0, s32, 16384
ds_read_b64_tr_b16 a[208:209], v24 offset:24576
ds_read_b64_tr_b16 a[210:211], v24 offset:26624
v_mfma_f32_16x16x32_bf16 v[156:159], a[196:199], v[200:203], v[156:159]
s_waitcnt lgkmcnt(5)
buffer_store_dwordx4 v[80:83], v4, s[28:31], s34 offen sc1
v_mfma_f32_16x16x32_bf16 v[132:135], a[200:203], v[208:211], v[132:135]
s_add_u32 s33, s62, 114688
ds_read_b64_tr_b16 a[212:213], v25 offset:24576
ds_read_b64_tr_b16 a[214:215], v25 offset:26624
v_mfma_f32_16x16x32_bf16 v[140:143], a[200:203], v[216:219], v[140:143]
s_waitcnt lgkmcnt(4)
ds_read_b64_tr_b16 a[216:217], v24 offset:28672
v_mul_f32 v100, v100, v57
v_mfma_f32_16x16x32_bf16 v[148:151], a[204:207], v[208:211], v[148:151]
ds_read_b64_tr_b16 a[218:219], v24 offset:30720
v_mul_f32 v101, v101, v57
v_mfma_f32_16x16x32_bf16 v[156:159], a[204:207], v[216:219], v[156:159]
s_waitcnt lgkmcnt(4)
buffer_load_dwordx4 v8, s[24:27], s33 offen offset:0 lds
v_mfma_f32_16x16x32_bf16 v[132:135], a[208:211], v[224:227], v[132:135]
ds_read_b64_tr_b16 a[220:221], v25 offset:28672
ds_read_b64_tr_b16 a[222:223], v25 offset:30720
v_mfma_f32_16x16x32_bf16 v[140:143], a[208:211], v[232:235], v[140:143]
s_waitcnt lgkmcnt(4)
ds_read_b64_tr_b16 a[224:225], v22 offset:0
v_mul_f32 v102, v102, v57
v_mfma_f32_16x16x32_bf16 v[148:151], a[212:215], v[224:227], v[148:151]
ds_read_b64_tr_b16 a[226:227], v22 offset:2048
v_mul_f32 v103, v103, v57
v_mfma_f32_16x16x32_bf16 v[156:159], a[212:215], v[232:235], v[156:159]
s_waitcnt lgkmcnt(4)
ds_read_b64_tr_b16 a[228:229], v23 offset:0
v_mul_f32 v108, v108, v57
v_mfma_f32_16x16x32_bf16 v[132:135], a[216:219], v[240:243], v[132:135]
ds_read_b64_tr_b16 a[230:231], v23 offset:2048
v_mul_f32 v109, v109, v57
v_mfma_f32_16x16x32_bf16 v[140:143], a[216:219], v[248:251], v[140:143]
s_waitcnt lgkmcnt(4)
buffer_load_dwordx4 v9, s[24:27], s33 offen offset:1024 lds
v_mfma_f32_16x16x32_bf16 v[148:151], a[220:223], v[240:243], v[148:151]
ds_read_b64_tr_b16 a[232:233], v22 offset:4096
ds_read_b64_tr_b16 a[234:235], v22 offset:6144
v_mfma_f32_16x16x32_bf16 v[156:159], a[220:223], v[248:251], v[156:159]
s_waitcnt lgkmcnt(4)
ds_read_b64_tr_b16 a[236:237], v23 offset:4096
v_mul_f32 v110, v110, v57
v_mfma_f32_16x16x32_bf16 v[164:167], a[224:227], v[128:131], 0
ds_read_b64_tr_b16 a[238:239], v23 offset:6144
v_mul_f32 v111, v111, v57
v_mfma_f32_16x16x32_bf16 v[172:175], a[224:227], v[136:139], 0
s_waitcnt lgkmcnt(4)
ds_read_b64_tr_b16 a[192:193], v22 offset:8192
v_cvt_pk_bf16_f32 v84, v100, v101
v_mfma_f32_16x16x32_bf16 v[180:183], a[228:231], v[128:131], 0
ds_read_b64_tr_b16 a[194:195], v22 offset:10240
v_cvt_pk_bf16_f32 v85, v102, v103
v_mfma_f32_16x16x32_bf16 v[188:191], a[228:231], v[136:139], 0
s_waitcnt lgkmcnt(4)
buffer_load_dwordx4 v10, s[24:27], s33 offen offset:2048 lds
v_mfma_f32_16x16x32_bf16 v[164:167], a[232:235], v[144:147], v[164:167]
ds_read_b64_tr_b16 a[196:197], v23 offset:8192
ds_read_b64_tr_b16 a[198:199], v23 offset:10240
v_mfma_f32_16x16x32_bf16 v[172:175], a[232:235], v[152:155], v[172:175]
s_waitcnt lgkmcnt(4)
ds_read_b64_tr_b16 a[200:201], v22 offset:12288
v_cvt_pk_bf16_f32 v86, v108, v109
v_mfma_f32_16x16x32_bf16 v[180:183], a[236:239], v[144:147], v[180:183]
ds_read_b64_tr_b16 a[202:203], v22 offset:14336
v_cvt_pk_bf16_f32 v87, v110, v111
v_mfma_f32_16x16x32_bf16 v[188:191], a[236:239], v[152:155], v[188:191]
s_waitcnt lgkmcnt(4)
ds_read_b64_tr_b16 a[204:205], v23 offset:12288
ds_read_b64_tr_b16 a[206:207], v23 offset:14336
v_mfma_f32_16x16x32_bf16 v[164:167], a[192:195], v[160:163], v[164:167]
s_mov_b32 s34, 47104
buffer_load_dwordx4 v11, s[24:27], s33 offen offset:3072 lds
v_mfma_f32_16x16x32_bf16 v[172:175], a[192:195], v[168:171], v[172:175]
s_waitcnt lgkmcnt(4)
buffer_store_dwordx4 v[84:87], v4, s[28:31], s34 offen sc1
v_mfma_f32_16x16x32_bf16 v[180:183], a[196:199], v[160:163], v[180:183]
ds_read_b64_tr_b16 a[208:209], v26 offset:16384
ds_read_b64_tr_b16 a[210:211], v26 offset:18432
v_mfma_f32_16x16x32_bf16 v[188:191], a[196:199], v[168:171], v[188:191]
s_waitcnt lgkmcnt(4)
ds_read_b64_tr_b16 a[212:213], v27 offset:16384
v_mul_f32 v112, v112, v56
v_mfma_f32_16x16x32_bf16 v[164:167], a[200:203], v[176:179], v[164:167]
ds_read_b64_tr_b16 a[214:215], v27 offset:18432
v_mul_f32 v113, v113, v56
v_mfma_f32_16x16x32_bf16 v[172:175], a[200:203], v[184:187], v[172:175]
s_waitcnt lgkmcnt(4)
ds_read_b64_tr_b16 a[216:217], v26 offset:20480
v_mul_f32 v114, v114, v56
v_mfma_f32_16x16x32_bf16 v[180:183], a[204:207], v[176:179], v[180:183]
ds_read_b64_tr_b16 a[218:219], v26 offset:22528
v_mul_f32 v115, v115, v56
v_mfma_f32_16x16x32_bf16 v[188:191], a[204:207], v[184:187], v[188:191]
s_waitcnt lgkmcnt(4)
ds_read_b64_tr_b16 a[220:221], v27 offset:20480
v_mul_f32 v120, v120, v56
v_mfma_f32_16x16x32_bf16 v[164:167], a[208:211], v[192:195], v[164:167]
ds_read_b64_tr_b16 a[222:223], v27 offset:22528
v_mul_f32 v121, v121, v56
v_mfma_f32_16x16x32_bf16 v[172:175], a[208:211], v[200:203], v[172:175]
s_waitcnt lgkmcnt(4)
ds_read_b64_tr_b16 a[224:225], v26 offset:24576
v_mul_f32 v122, v122, v56
v_mfma_f32_16x16x32_bf16 v[180:183], a[212:215], v[192:195], v[180:183]
ds_read_b64_tr_b16 a[226:227], v26 offset:26624
v_mul_f32 v123, v123, v56
v_mfma_f32_16x16x32_bf16 v[188:191], a[212:215], v[200:203], v[188:191]
s_waitcnt lgkmcnt(4)
ds_read_b64_tr_b16 a[228:229], v27 offset:24576
v_cvt_pk_bf16_f32 v88, v112, v113
v_mfma_f32_16x16x32_bf16 v[164:167], a[216:219], v[208:211], v[164:167]
ds_read_b64_tr_b16 a[230:231], v27 offset:26624
v_cvt_pk_bf16_f32 v89, v114, v115
v_mfma_f32_16x16x32_bf16 v[172:175], a[216:219], v[216:219], v[172:175]
s_waitcnt lgkmcnt(4)
ds_read_b64_tr_b16 a[232:233], v26 offset:28672
v_cvt_pk_bf16_f32 v90, v120, v121
v_mfma_f32_16x16x32_bf16 v[180:183], a[220:223], v[208:211], v[180:183]
ds_read_b64_tr_b16 a[234:235], v26 offset:30720
v_cvt_pk_bf16_f32 v91, v122, v123
v_mfma_f32_16x16x32_bf16 v[188:191], a[220:223], v[216:219], v[188:191]
s_waitcnt lgkmcnt(4)
ds_read_b64_tr_b16 a[236:237], v27 offset:28672
ds_read_b64_tr_b16 a[238:239], v27 offset:30720
v_mfma_f32_16x16x32_bf16 v[164:167], a[224:227], v[224:227], v[164:167]
s_waitcnt vmcnt(28)
v_mfma_f32_16x16x32_bf16 v[172:175], a[224:227], v[232:235], v[172:175]
s_waitcnt lgkmcnt(4)
v_mfma_f32_16x16x32_bf16 v[180:183], a[228:231], v[224:227], v[180:183]
s_barrier
ds_read_b64_tr_b16 a[192:193], v24 offset:49152
ds_read_b64_tr_b16 a[194:195], v24 offset:51200
v_mfma_f32_16x16x32_bf16 v[188:191], a[228:231], v[232:235], v[188:191]
s_waitcnt lgkmcnt(4)
ds_read_b64_tr_b16 a[196:197], v25 offset:49152
ds_read_b64_tr_b16 a[198:199], v25 offset:51200
v_mfma_f32_16x16x32_bf16 v[164:167], a[232:235], v[240:243], v[164:167]
LA_t54:
s_load_dword s98, s[96:97], 44852
ds_read_b64_tr_b16 a[200:201], v24 offset:53248
ds_read_b64_tr_b16 a[202:203], v24 offset:55296
v_mfma_f32_16x16x32_bf16 v[172:175], a[232:235], v[248:251], v[172:175]
s_waitcnt lgkmcnt(6)
ds_read_b64_tr_b16 a[204:205], v25 offset:53248
ds_read_b64_tr_b16 a[206:207], v25 offset:55296
v_mfma_f32_16x16x32_bf16 v[180:183], a[236:239], v[240:243], v[180:183]
s_mov_b32 s34, 46080
buffer_store_dwordx4 v[88:91], v4, s[28:31], s34 offen sc1
v_mfma_f32_16x16x32_bf16 v[188:191], a[236:239], v[248:251], v[188:191]
s_waitcnt lgkmcnt(6)
ds_read_b64_tr_b16 a[208:209], v24 offset:57344
v_mul_f32 v116, v116, v57
v_mul_f32 v117, v117, v57
v_mul_f32 v118, v118, v57
v_mul_f32 v119, v119, v57
v_mul_f32 v124, v124, v57
v_mul_f32 v125, v125, v57
v_mul_f32 v126, v126, v57
v_mul_f32 v127, v127, v57
v_cvt_pk_bf16_f32 v92, v116, v117
v_cvt_pk_bf16_f32 v93, v118, v119
v_cvt_pk_bf16_f32 v94, v124, v125
v_cvt_pk_bf16_f32 v95, v126, v127
s_mov_b32 s34, 48128
buffer_store_dwordx4 v[92:95], v4, s[28:31], s34 offen sc1
v_mfma_f32_16x16x32_bf16 v[96:99], a[192:195], v[128:131], 0
ds_read_b64_tr_b16 a[210:211], v24 offset:59392
v_mul_f32 v132, v132, v56
v_mfma_f32_16x16x32_bf16 v[100:103], a[192:195], v[136:139], 0
s_waitcnt lgkmcnt(4)
ds_read_b64_tr_b16 a[212:213], v25 offset:57344
v_mul_f32 v133, v133, v56
v_mfma_f32_16x16x32_bf16 v[104:107], a[196:199], v[128:131], 0
ds_read_b64_tr_b16 a[214:215], v25 offset:59392
v_mul_f32 v134, v134, v56
v_mfma_f32_16x16x32_bf16 v[108:111], a[196:199], v[136:139], 0
ds_read_b64_tr_b16 a[216:217], v24 offset:61440
v_mul_f32 v135, v135, v56
v_mfma_f32_16x16x32_bf16 v[96:99], a[200:203], v[144:147], v[96:99]
ds_read_b64_tr_b16 a[218:219], v24 offset:63488
v_mul_f32 v148, v148, v56
v_mfma_f32_16x16x32_bf16 v[100:103], a[200:203], v[152:155], v[100:103]
s_waitcnt lgkmcnt(4)
ds_read_b64_tr_b16 a[220:221], v25 offset:61440
v_mul_f32 v149, v149, v56
v_mfma_f32_16x16x32_bf16 v[104:107], a[204:207], v[144:147], v[104:107]
s_waitcnt vmcnt(24)
ds_read_b64_tr_b16 a[222:223], v25 offset:63488
v_mul_f32 v150, v150, v56
v_mfma_f32_16x16x32_bf16 v[108:111], a[204:207], v[152:155], v[108:111]
s_barrier
ds_read_b64_tr_b16 a[224:225], v28 offset:0
v_mul_f32 v151, v151, v56
v_mfma_f32_16x16x32_bf16 v[96:99], a[208:211], v[160:163], v[96:99]
ds_read_b64_tr_b16 a[226:227], v28 offset:2048
v_cvt_pk_bf16_f32 v72, v132, v133
v_mfma_f32_16x16x32_bf16 v[100:103], a[208:211], v[168:171], v[100:103]
s_waitcnt lgkmcnt(4)
ds_read_b64_tr_b16 a[228:229], v29 offset:0
v_cvt_pk_bf16_f32 v73, v134, v135
v_mfma_f32_16x16x32_bf16 v[104:107], a[212:215], v[160:163], v[104:107]
ds_read_b64_tr_b16 a[230:231], v29 offset:2048
v_cvt_pk_bf16_f32 v74, v148, v149
v_mfma_f32_16x16x32_bf16 v[108:111], a[212:215], v[168:171], v[108:111]
ds_read_b64_tr_b16 a[232:233], v28 offset:4096
v_cvt_pk_bf16_f32 v75, v150, v151
v_mfma_f32_16x16x32_bf16 v[96:99], a[216:219], v[176:179], v[96:99]
ds_write_b128 v16, v[72:75] offset:3072
v_mfma_f32_16x16x32_bf16 v[100:103], a[216:219], v[184:187], v[100:103]
s_waitcnt lgkmcnt(4)
ds_read_b64_tr_b16 a[234:235], v28 offset:6144
ds_read_b64_tr_b16 a[236:237], v29 offset:4096
v_mfma_f32_16x16x32_bf16 v[104:107], a[220:223], v[176:179], v[104:107]
s_add_u32 s34, s77, 61440
buffer_store_dwordx4 v[72:75], v4, s[28:31], s34 offen sc1
v_mfma_f32_16x16x32_bf16 v[108:111], a[220:223], v[184:187], v[108:111]
ds_read_b64_tr_b16 a[238:239], v29 offset:6144
v_mul_f32 v140, v140, v57
v_mfma_f32_16x16x32_bf16 v[96:99], a[224:227], v[192:195], v[96:99]
ds_read_b64_tr_b16 a[192:193], v28 offset:8192
v_mul_f32 v141, v141, v57
v_mfma_f32_16x16x32_bf16 v[100:103], a[224:227], v[200:203], v[100:103]
s_waitcnt lgkmcnt(4)
ds_read_b64_tr_b16 a[194:195], v28 offset:10240
v_mul_f32 v142, v142, v57
v_mfma_f32_16x16x32_bf16 v[104:107], a[228:231], v[192:195], v[104:107]
ds_read_b64_tr_b16 a[196:197], v29 offset:8192
v_mul_f32 v143, v143, v57
v_mfma_f32_16x16x32_bf16 v[108:111], a[228:231], v[200:203], v[108:111]
s_waitcnt lgkmcnt(4)
ds_read_b64_tr_b16 a[198:199], v29 offset:10240
v_mul_f32 v156, v156, v57
v_mfma_f32_16x16x32_bf16 v[96:99], a[232:235], v[208:211], v[96:99]
ds_read_b64_tr_b16 a[200:201], v28 offset:12288
v_mul_f32 v157, v157, v57
v_mfma_f32_16x16x32_bf16 v[100:103], a[232:235], v[216:219], v[100:103]
s_waitcnt lgkmcnt(4)
ds_read_b64_tr_b16 a[202:203], v28 offset:14336
v_mul_f32 v158, v158, v57
v_mfma_f32_16x16x32_bf16 v[104:107], a[236:239], v[208:211], v[104:107]
ds_read_b64_tr_b16 a[204:205], v29 offset:12288
v_mul_f32 v159, v159, v57
v_mfma_f32_16x16x32_bf16 v[108:111], a[236:239], v[216:219], v[108:111]
s_waitcnt lgkmcnt(4)
ds_read_b64_tr_b16 a[206:207], v29 offset:14336
v_cvt_pk_bf16_f32 v76, v140, v141
v_mfma_f32_16x16x32_bf16 v[96:99], a[192:195], v[224:227], v[96:99]
ds_read_b64_tr_b16 a[208:209], v26 offset:49152
v_cvt_pk_bf16_f32 v77, v142, v143
v_mfma_f32_16x16x32_bf16 v[100:103], a[192:195], v[232:235], v[100:103]
s_waitcnt lgkmcnt(4)
ds_read_b64_tr_b16 a[210:211], v26 offset:51200
v_cvt_pk_bf16_f32 v78, v156, v157
v_mfma_f32_16x16x32_bf16 v[104:107], a[196:199], v[224:227], v[104:107]
ds_read_b64_tr_b16 a[212:213], v27 offset:49152
v_cvt_pk_bf16_f32 v79, v158, v159
v_mfma_f32_16x16x32_bf16 v[108:111], a[196:199], v[232:235], v[108:111]
s_waitcnt lgkmcnt(4)
ds_read_b64_tr_b16 a[214:215], v27 offset:51200
ds_read_b64_tr_b16 a[216:217], v26 offset:53248
v_mfma_f32_16x16x32_bf16 v[96:99], a[200:203], v[240:243], v[96:99]
s_mov_b32 s34, 63488
buffer_store_dwordx4 v[76:79], v4, s[28:31], s34 offen sc1
v_mfma_f32_16x16x32_bf16 v[100:103], a[200:203], v[248:251], v[100:103]
s_waitcnt lgkmcnt(4)
ds_read_b64_tr_b16 a[218:219], v26 offset:55296
v_mul_f32 v164, v164, v56
v_mfma_f32_16x16x32_bf16 v[104:107], a[204:207], v[240:243], v[104:107]
ds_read_b64_tr_b16 a[220:221], v27 offset:53248
v_mul_f32 v165, v165, v56
v_mfma_f32_16x16x32_bf16 v[108:111], a[204:207], v[248:251], v[108:111]
s_waitcnt lgkmcnt(4)
ds_read_b64_tr_b16 a[222:223], v27 offset:55296
v_mul_f32 v166, v166, v56
v_mfma_f32_16x16x32_bf16 v[112:115], a[208:211], v[128:131], 0
ds_read_b64_tr_b16 a[224:225], v26 offset:57344
v_mul_f32 v167, v167, v56
v_mfma_f32_16x16x32_bf16 v[116:119], a[208:211], v[136:139], 0
s_waitcnt lgkmcnt(4)
ds_read_b64_tr_b16 a[226:227], v26 offset:59392
v_mul_f32 v180, v180, v56
v_mfma_f32_16x16x32_bf16 v[120:123], a[212:215], v[128:131], 0
ds_read_b64_tr_b16 a[228:229], v27 offset:57344
v_mul_f32 v181, v181, v56
v_mfma_f32_16x16x32_bf16 v[124:127], a[212:215], v[136:139], 0
s_waitcnt lgkmcnt(4)
ds_read_b64_tr_b16 a[230:231], v27 offset:59392
v_mul_f32 v182, v182, v56
v_mfma_f32_16x16x32_bf16 v[112:115], a[216:219], v[144:147], v[112:115]
ds_read_b64_tr_b16 a[232:233], v26 offset:61440
v_mul_f32 v183, v183, v56
v_mfma_f32_16x16x32_bf16 v[116:119], a[216:219], v[152:155], v[116:119]
s_waitcnt lgkmcnt(4)
ds_read_b64_tr_b16 a[234:235], v26 offset:63488
v_cvt_pk_bf16_f32 v80, v164, v165
v_mfma_f32_16x16x32_bf16 v[120:123], a[220:223], v[144:147], v[120:123]
ds_read_b64_tr_b16 a[236:237], v27 offset:61440
v_cvt_pk_bf16_f32 v81, v166, v167
v_mfma_f32_16x16x32_bf16 v[124:127], a[220:223], v[152:155], v[124:127]
s_waitcnt lgkmcnt(4)
ds_read_b64_tr_b16 a[238:239], v27 offset:63488
v_cvt_pk_bf16_f32 v82, v180, v181
v_mfma_f32_16x16x32_bf16 v[112:115], a[224:227], v[160:163], v[112:115]
ds_read_b64_tr_b16 a[192:193], v30 offset:0
v_cvt_pk_bf16_f32 v83, v182, v183
v_mfma_f32_16x16x32_bf16 v[116:119], a[224:227], v[168:171], v[116:119]
s_waitcnt lgkmcnt(4)
ds_read_b64_tr_b16 a[194:195], v30 offset:2048
ds_read_b64_tr_b16 a[196:197], v31 offset:0
v_mfma_f32_16x16x32_bf16 v[120:123], a[228:231], v[160:163], v[120:123]
s_mov_b32 s34, 62464
buffer_store_dwordx4 v[80:83], v4, s[28:31], s34 offen sc1
v_mfma_f32_16x16x32_bf16 v[124:127], a[228:231], v[168:171], v[124:127]
s_waitcnt lgkmcnt(4)
ds_read_b64_tr_b16 a[198:199], v31 offset:2048
v_mul_f32 v172, v172, v57
v_mfma_f32_16x16x32_bf16 v[112:115], a[232:235], v[176:179], v[112:115]
ds_read_b64_tr_b16 a[200:201], v30 offset:4096
v_mul_f32 v173, v173, v57
v_mfma_f32_16x16x32_bf16 v[116:119], a[232:235], v[184:187], v[116:119]
s_waitcnt lgkmcnt(4)
ds_read_b64_tr_b16 a[202:203], v30 offset:6144
v_mul_f32 v174, v174, v57
v_mfma_f32_16x16x32_bf16 v[120:123], a[236:239], v[176:179], v[120:123]
ds_read_b64_tr_b16 a[204:205], v31 offset:4096
v_mul_f32 v175, v175, v57
v_mfma_f32_16x16x32_bf16 v[124:127], a[236:239], v[184:187], v[124:127]
s_waitcnt lgkmcnt(4)
ds_read_b64_tr_b16 a[206:207], v31 offset:6144
v_mul_f32 v188, v188, v57
v_mfma_f32_16x16x32_bf16 v[112:115], a[192:195], v[192:195], v[112:115]
ds_read_b64_tr_b16 a[208:209], v30 offset:8192
v_mul_f32 v189, v189, v57
v_mfma_f32_16x16x32_bf16 v[116:119], a[192:195], v[200:203], v[116:119]
s_waitcnt lgkmcnt(4)
ds_read_b64_tr_b16 a[210:211], v30 offset:10240
v_mul_f32 v190, v190, v57
v_mfma_f32_16x16x32_bf16 v[120:123], a[196:199], v[192:195], v[120:123]
ds_read_b64_tr_b16 a[212:213], v31 offset:8192
v_mul_f32 v191, v191, v57
v_mfma_f32_16x16x32_bf16 v[124:127], a[196:199], v[200:203], v[124:127]
s_waitcnt lgkmcnt(4)
ds_read_b64_tr_b16 a[214:215], v31 offset:10240
v_cvt_pk_bf16_f32 v84, v172, v173
v_mfma_f32_16x16x32_bf16 v[112:115], a[200:203], v[208:211], v[112:115]
ds_read_b64_tr_b16 a[216:217], v30 offset:12288
v_cvt_pk_bf16_f32 v85, v174, v175
v_mfma_f32_16x16x32_bf16 v[116:119], a[200:203], v[216:219], v[116:119]
s_waitcnt lgkmcnt(4)
ds_read_b64_tr_b16 a[218:219], v30 offset:14336
v_cvt_pk_bf16_f32 v86, v188, v189
v_mfma_f32_16x16x32_bf16 v[120:123], a[204:207], v[208:211], v[120:123]
s_waitcnt vmcnt(22)
ds_read_b64_tr_b16 a[220:221], v31 offset:12288
v_cvt_pk_bf16_f32 v87, v190, v191
v_mfma_f32_16x16x32_bf16 v[124:127], a[204:207], v[216:219], v[124:127]
s_waitcnt lgkmcnt(4)
ds_read_b64_tr_b16 a[222:223], v31 offset:14336
v_mfma_f32_16x16x32_bf16 v[112:115], a[208:211], v[224:227], v[112:115]
s_barrier
ds_read_b64_tr_b16 a[224:225], v24 offset:0
ds_read_b64_tr_b16 a[226:227], v24 offset:2048
v_mfma_f32_16x16x32_bf16 v[116:119], a[208:211], v[232:235], v[116:119]
s_waitcnt lgkmcnt(5)
ds_read_b64_tr_b16 a[228:229], v25 offset:0
ds_read_b64_tr_b16 a[230:231], v25 offset:2048
v_mfma_f32_16x16x32_bf16 v[120:123], a[212:215], v[224:227], v[120:123]
LA_t56:
s_load_dword s98, s[96:97], 44852
ds_read_b64_tr_b16 a[232:233], v24 offset:4096
ds_read_b64_tr_b16 a[234:235], v24 offset:6144
v_mfma_f32_16x16x32_bf16 v[124:127], a[212:215], v[232:235], v[124:127]
s_waitcnt lgkmcnt(7)
ds_read_b64_tr_b16 a[236:237], v25 offset:4096
ds_read_b64_tr_b16 a[238:239], v25 offset:6144
v_mfma_f32_16x16x32_bf16 v[112:115], a[216:219], v[240:243], v[112:115]
s_mov_b32 s34, 64512
buffer_store_dwordx4 v[84:87], v4, s[28:31], s34 offen sc1
v_mfma_f32_16x16x32_bf16 v[116:119], a[216:219], v[248:251], v[116:119]
s_waitcnt lgkmcnt(6)
ds_read_b64_tr_b16 a[192:193], v24 offset:8192
v_mul_f32 v96, v96, v56
v_mfma_f32_16x16x32_bf16 v[120:123], a[220:223], v[240:243], v[120:123]
ds_read_b64_tr_b16 a[194:195], v24 offset:10240
v_mul_f32 v97, v97, v56
v_mfma_f32_16x16x32_bf16 v[124:127], a[220:223], v[248:251], v[124:127]
ds_read_b64_tr_b16 a[196:197], v25 offset:8192
v_mul_f32 v98, v98, v56
v_mfma_f32_16x16x32_bf16 v[132:135], a[224:227], v[128:131], 0
ds_read_b64_tr_b16 a[198:199], v25 offset:10240
v_mul_f32 v99, v99, v56
v_mfma_f32_16x16x32_bf16 v[140:143], a[224:227], v[136:139], 0
s_waitcnt lgkmcnt(4)
ds_read_b64_tr_b16 a[200:201], v24 offset:12288
v_mul_f32 v104, v104, v56
v_mfma_f32_16x16x32_bf16 v[148:151], a[228:231], v[128:131], 0
ds_read_b64_tr_b16 a[202:203], v24 offset:14336
v_mul_f32 v105, v105, v56
v_mfma_f32_16x16x32_bf16 v[156:159], a[228:231], v[136:139], 0
s_waitcnt vmcnt(18)
ds_read_b64_tr_b16 a[204:205], v25 offset:12288
v_mul_f32 v106, v106, v56
v_mfma_f32_16x16x32_bf16 v[132:135], a[232:235], v[144:147], v[132:135]
ds_read_b64_tr_b16 a[206:207], v25 offset:14336
v_mul_f32 v107, v107, v56
v_mfma_f32_16x16x32_bf16 v[140:143], a[232:235], v[152:155], v[140:143]
s_barrier
ds_read_b64_tr_b16 a[208:209], v20 offset:49152
v_cvt_pk_bf16_f32 v88, v96, v97
v_mfma_f32_16x16x32_bf16 v[148:151], a[236:239], v[144:147], v[148:151]
ds_read_b64_tr_b16 a[210:211], v20 offset:51200
v_cvt_pk_bf16_f32 v89, v98, v99
v_mfma_f32_16x16x32_bf16 v[156:159], a[236:239], v[152:155], v[156:159]
s_waitcnt lgkmcnt(4)
ds_read_b64_tr_b16 a[212:213], v21 offset:49152
v_cvt_pk_bf16_f32 v90, v104, v105
v_mfma_f32_16x16x32_bf16 v[132:135], a[192:195], v[160:163], v[132:135]
ds_read_b64_tr_b16 a[214:215], v21 offset:51200
v_cvt_pk_bf16_f32 v91, v106, v107
v_mfma_f32_16x16x32_bf16 v[140:143], a[192:195], v[168:171], v[140:143]
ds_write_b128 v16, v[88:91] offset:4096
v_mfma_f32_16x16x32_bf16 v[148:151], a[196:199], v[160:163], v[148:151]
s_add_u32 s34, s77, 77824
buffer_store_dwordx4 v[88:91], v4, s[28:31], s34 offen sc1
v_mfma_f32_16x16x32_bf16 v[156:159], a[196:199], v[168:171], v[156:159]
ds_read_b64_tr_b16 a[216:217], v20 offset:53248
v_mul_f32 v100, v100, v57
v_mfma_f32_16x16x32_bf16 v[132:135], a[200:203], v[176:179], v[132:135]
ds_read_b64_tr_b16 a[218:219], v20 offset:55296
v_mul_f32 v101, v101, v57
v_mfma_f32_16x16x32_bf16 v[140:143], a[200:203], v[184:187], v[140:143]
s_waitcnt lgkmcnt(3)
ds_read_b64_tr_b16 a[220:221], v21 offset:53248
v_mul_f32 v102, v102, v57
v_mfma_f32_16x16x32_bf16 v[148:151], a[204:207], v[176:179], v[148:151]
ds_read_b64_tr_b16 a[222:223], v21 offset:55296
v_mul_f32 v103, v103, v57
v_mfma_f32_16x16x32_bf16 v[156:159], a[204:207], v[184:187], v[156:159]
ds_read_b64_tr_b16 a[224:225], v20 offset:57344
v_mul_f32 v108, v108, v57
v_mfma_f32_16x16x32_bf16 v[132:135], a[208:211], v[192:195], v[132:135]
ds_read_b64_tr_b16 a[226:227], v20 offset:59392
v_mul_f32 v109, v109, v57
v_mfma_f32_16x16x32_bf16 v[140:143], a[208:211], v[200:203], v[140:143]
ds_read_b64_tr_b16 a[228:229], v21 offset:57344
v_mul_f32 v110, v110, v57
v_mfma_f32_16x16x32_bf16 v[148:151], a[212:215], v[192:195], v[148:151]
ds_read_b64_tr_b16 a[230:231], v21 offset:59392
v_mul_f32 v111, v111, v57
v_mfma_f32_16x16x32_bf16 v[156:159], a[212:215], v[200:203], v[156:159]
s_waitcnt lgkmcnt(4)
ds_read_b64_tr_b16 a[232:233], v20 offset:61440
v_cvt_pk_bf16_f32 v92, v100, v101
v_mfma_f32_16x16x32_bf16 v[132:135], a[216:219], v[208:211], v[132:135]
ds_read_b64_tr_b16 a[234:235], v20 offset:63488
v_cvt_pk_bf16_f32 v93, v102, v103
v_mfma_f32_16x16x32_bf16 v[140:143], a[216:219], v[216:219], v[140:143]
ds_read_b64_tr_b16 a[236:237], v21 offset:61440
v_cvt_pk_bf16_f32 v94, v108, v109
v_mfma_f32_16x16x32_bf16 v[148:151], a[220:223], v[208:211], v[148:151]
ds_read_b64_tr_b16 a[238:239], v21 offset:63488
v_cvt_pk_bf16_f32 v95, v110, v111
v_mfma_f32_16x16x32_bf16 v[156:159], a[220:223], v[216:219], v[156:159]
s_waitcnt lgkmcnt(4)
ds_read_b64_tr_b16 a[192:193], v26 offset:0
ds_read_b64_tr_b16 a[194:195], v26 offset:2048
v_mfma_f32_16x16x32_bf16 v[132:135], a[224:227], v[224:227], v[132:135]
s_mov_b32 s34, 79872
buffer_store_dwordx4 v[92:95], v4, s[28:31], s34 offen sc1
v_mfma_f32_16x16x32_bf16 v[140:143], a[224:227], v[232:235], v[140:143]
ds_read_b64_tr_b16 a[196:197], v27 offset:0
v_mul_f32 v112, v112, v56
v_mfma_f32_16x16x32_bf16 v[148:151], a[228:231], v[224:227], v[148:151]
ds_read_b64_tr_b16 a[198:199], v27 offset:2048
v_mul_f32 v113, v113, v56
v_mfma_f32_16x16x32_bf16 v[156:159], a[228:231], v[232:235], v[156:159]
s_waitcnt lgkmcnt(4)
ds_read_b64_tr_b16 a[200:201], v26 offset:4096
v_mul_f32 v114, v114, v56
v_mfma_f32_16x16x32_bf16 v[132:135], a[232:235], v[240:243], v[132:135]
ds_read_b64_tr_b16 a[202:203], v26 offset:6144
v_mul_f32 v115, v115, v56
v_mfma_f32_16x16x32_bf16 v[140:143], a[232:235], v[248:251], v[140:143]
ds_read_b64_tr_b16 a[204:205], v27 offset:4096
v_mul_f32 v120, v120, v56
v_mfma_f32_16x16x32_bf16 v[148:151], a[236:239], v[240:243], v[148:151]
ds_read_b64_tr_b16 a[206:207], v27 offset:6144
v_mul_f32 v121, v121, v56
v_mfma_f32_16x16x32_bf16 v[156:159], a[236:239], v[248:251], v[156:159]
s_waitcnt lgkmcnt(4)
ds_read_b64_tr_b16 a[208:209], v26 offset:8192
v_mul_f32 v122, v122, v56
v_mfma_f32_16x16x32_bf16 v[164:167], a[192:195], v[128:131], 0
ds_read_b64_tr_b16 a[210:211], v26 offset:10240
v_mul_f32 v123, v123, v56
v_mfma_f32_16x16x32_bf16 v[172:175], a[192:195], v[136:139], 0
ds_read_b64_tr_b16 a[212:213], v27 offset:8192
v_cvt_pk_bf16_f32 v72, v112, v113
v_mfma_f32_16x16x32_bf16 v[180:183], a[196:199], v[128:131], 0
ds_read_b64_tr_b16 a[214:215], v27 offset:10240
v_cvt_pk_bf16_f32 v73, v114, v115
v_mfma_f32_16x16x32_bf16 v[188:191], a[196:199], v[136:139], 0
s_waitcnt lgkmcnt(4)
ds_read_b64_tr_b16 a[216:217], v26 offset:12288
v_cvt_pk_bf16_f32 v74, v120, v121
v_mfma_f32_16x16x32_bf16 v[164:167], a[200:203], v[144:147], v[164:167]
ds_read_b64_tr_b16 a[218:219], v26 offset:14336
v_cvt_pk_bf16_f32 v75, v122, v123
v_mfma_f32_16x16x32_bf16 v[172:175], a[200:203], v[152:155], v[172:175]
s_mov_b32 s34, 78848
buffer_store_dwordx4 v[72:75], v4, s[28:31], s34 offen sc1
v_mfma_f32_16x16x32_bf16 v[180:183], a[204:207], v[144:147], v[180:183]
ds_read_b64_tr_b16 a[220:221], v27 offset:12288
v_mul_f32 v116, v116, v57
v_mfma_f32_16x16x32_bf16 v[188:191], a[204:207], v[152:155], v[188:191]
s_waitcnt lgkmcnt(3)
ds_read_b64_tr_b16 a[222:223], v27 offset:14336
v_mul_f32 v117, v117, v57
v_mfma_f32_16x16x32_bf16 v[164:167], a[208:211], v[160:163], v[164:167]
ds_read_b64_tr_b16 a[224:225], v22 offset:49152
v_mul_f32 v118, v118, v57
v_mfma_f32_16x16x32_bf16 v[172:175], a[208:211], v[168:171], v[172:175]
ds_read_b64_tr_b16 a[226:227], v22 offset:51200
v_mul_f32 v119, v119, v57
v_mfma_f32_16x16x32_bf16 v[180:183], a[212:215], v[160:163], v[180:183]
ds_read_b64_tr_b16 a[228:229], v23 offset:49152
v_mul_f32 v124, v124, v57
v_mfma_f32_16x16x32_bf16 v[188:191], a[212:215], v[168:171], v[188:191]
s_waitcnt lgkmcnt(4)
ds_read_b64_tr_b16 a[230:231], v23 offset:51200
v_mul_f32 v125, v125, v57
v_mfma_f32_16x16x32_bf16 v[164:167], a[216:219], v[176:179], v[164:167]
ds_read_b64_tr_b16 a[232:233], v22 offset:53248
v_mul_f32 v126, v126, v57
v_mfma_f32_16x16x32_bf16 v[172:175], a[216:219], v[184:187], v[172:175]
s_waitcnt lgkmcnt(4)
ds_read_b64_tr_b16 a[234:235], v22 offset:55296
v_mul_f32 v127, v127, v57
v_mfma_f32_16x16x32_bf16 v[180:183], a[220:223], v[176:179], v[180:183]
ds_read_b64_tr_b16 a[236:237], v23 offset:53248
v_cvt_pk_bf16_f32 v76, v116, v117
v_mfma_f32_16x16x32_bf16 v[188:191], a[220:223], v[184:187], v[188:191]
s_waitcnt lgkmcnt(4)
ds_read_b64_tr_b16 a[238:239], v23 offset:55296
v_cvt_pk_bf16_f32 v77, v118, v119
v_mfma_f32_16x16x32_bf16 v[164:167], a[224:227], v[192:195], v[164:167]
ds_read_b64_tr_b16 a[192:193], v22 offset:57344
v_cvt_pk_bf16_f32 v78, v124, v125
v_mfma_f32_16x16x32_bf16 v[172:175], a[224:227], v[200:203], v[172:175]
s_waitcnt lgkmcnt(4)
ds_read_b64_tr_b16 a[194:195], v22 offset:59392
v_cvt_pk_bf16_f32 v79, v126, v127
v_mfma_f32_16x16x32_bf16 v[180:183], a[228:231], v[192:195], v[180:183]
s_mov_b32 s34, 80896
buffer_store_dwordx4 v[76:79], v4, s[28:31], s34 offen sc1
v_mfma_f32_16x16x32_bf16 v[188:191], a[228:231], v[200:203], v[188:191]
s_waitcnt lgkmcnt(3)
ds_read_b64_tr_b16 a[196:197], v23 offset:57344
ds_read_b64_tr_b16 a[198:199], v23 offset:59392
v_mfma_f32_16x16x32_bf16 v[164:167], a[232:235], v[208:211], v[164:167]
s_waitcnt vmcnt(4)
buffer_store_dwordx2 v[6:7], v13, s[28:31], 0 offen offset:384 sc1
v_mfma_f32_16x16x32_bf16 v[172:175], a[232:235], v[216:219], v[172:175]
s_waitcnt lgkmcnt(3)
ds_read_b64_tr_b16 a[200:201], v22 offset:61440
v_mul_f32 v132, v132, v56
v_mfma_f32_16x16x32_bf16 v[180:183], a[236:239], v[208:211], v[180:183]
ds_read_b64_tr_b16 a[202:203], v22 offset:63488
v_mul_f32 v133, v133, v56
v_mfma_f32_16x16x32_bf16 v[188:191], a[236:239], v[216:219], v[188:191]
s_waitcnt lgkmcnt(4)
ds_read_b64_tr_b16 a[204:205], v23 offset:61440
v_mul_f32 v134, v134, v56
v_mfma_f32_16x16x32_bf16 v[164:167], a[192:195], v[224:227], v[164:167]
ds_read_b64_tr_b16 a[206:207], v23 offset:63488
v_mul_f32 v135, v135, v56
v_mfma_f32_16x16x32_bf16 v[172:175], a[192:195], v[232:235], v[172:175]
s_waitcnt lgkmcnt(4)
v_mul_f32 v148, v148, v56
v_mul_f32 v149, v149, v56
v_mfma_f32_16x16x32_bf16 v[180:183], a[196:199], v[224:227], v[180:183]
s_barrier
ds_read_b64_tr_b16 a[208:209], v20 offset:32768
ds_read_b64_tr_b16 a[210:211], v20 offset:34816
v_mfma_f32_16x16x32_bf16 v[188:191], a[196:199], v[232:235], v[188:191]
s_waitcnt lgkmcnt(4)
ds_read_b64_tr_b16 a[212:213], v21 offset:32768
v_mul_f32 v150, v150, v56
v_mfma_f32_16x16x32_bf16 v[164:167], a[200:203], v[240:243], v[164:167]
LA_t58:
s_load_dword s98, s[96:97], 44852
ds_read_b64_tr_b16 a[214:215], v21 offset:34816
v_mul_f32 v151, v151, v56
v_mfma_f32_16x16x32_bf16 v[172:175], a[200:203], v[248:251], v[172:175]
s_waitcnt lgkmcnt(4)
ds_read_b64_tr_b16 a[216:217], v20 offset:36864
v_cvt_pk_bf16_f32 v80, v132, v133
v_mfma_f32_16x16x32_bf16 v[180:183], a[204:207], v[240:243], v[180:183]
ds_read_b64_tr_b16 a[218:219], v20 offset:38912
v_cvt_pk_bf16_f32 v81, v134, v135
v_mfma_f32_16x16x32_bf16 v[188:191], a[204:207], v[248:251], v[188:191]
s_waitcnt lgkmcnt(4)
ds_read_b64_tr_b16 a[220:221], v21 offset:36864
v_cvt_pk_bf16_f32 v82, v148, v149
v_mfma_f32_16x16x32_bf16 v[96:99], a[208:211], v[128:131], 0
ds_read_b64_tr_b16 a[222:223], v21 offset:38912
v_cvt_pk_bf16_f32 v83, v150, v151
v_mfma_f32_16x16x32_bf16 v[100:103], a[208:211], v[136:139], 0
s_waitcnt lgkmcnt(4)
ds_write_b128 v16, v[80:83] offset:5120
v_mfma_f32_16x16x32_bf16 v[104:107], a[212:215], v[128:131], 0
s_add_u32 s34, s77, 94208
ds_read_b64_tr_b16 a[224:225], v20 offset:40960
ds_read_b64_tr_b16 a[226:227], v20 offset:43008
v_mfma_f32_16x16x32_bf16 v[108:111], a[212:215], v[136:139], 0
s_waitcnt lgkmcnt(5)
buffer_store_dwordx4 v[80:83], v4, s[28:31], s34 offen sc1
v_mfma_f32_16x16x32_bf16 v[96:99], a[216:219], v[144:147], v[96:99]
ds_read_b64_tr_b16 a[228:229], v21 offset:40960
ds_read_b64_tr_b16 a[230:231], v21 offset:43008
v_mfma_f32_16x16x32_bf16 v[100:103], a[216:219], v[152:155], v[100:103]
s_waitcnt lgkmcnt(5)
ds_read_b64_tr_b16 a[232:233], v20 offset:45056
v_mul_f32 v140, v140, v57
v_mfma_f32_16x16x32_bf16 v[104:107], a[220:223], v[144:147], v[104:107]
ds_read_b64_tr_b16 a[234:235], v20 offset:47104
v_mul_f32 v141, v141, v57
v_mfma_f32_16x16x32_bf16 v[108:111], a[220:223], v[152:155], v[108:111]
s_waitcnt lgkmcnt(4)
ds_read_b64_tr_b16 a[236:237], v21 offset:45056
v_mul_f32 v142, v142, v57
v_mfma_f32_16x16x32_bf16 v[96:99], a[224:227], v[160:163], v[96:99]
ds_read_b64_tr_b16 a[238:239], v21 offset:47104
v_mul_f32 v143, v143, v57
v_mfma_f32_16x16x32_bf16 v[100:103], a[224:227], v[168:171], v[100:103]
s_waitcnt lgkmcnt(4)
v_mul_f32 v156, v156, v57
v_mul_f32 v157, v157, v57
v_mfma_f32_16x16x32_bf16 v[104:107], a[228:231], v[160:163], v[104:107]
s_barrier
ds_read_b64_tr_b16 a[192:193], v20 offset:16384
ds_read_b64_tr_b16 a[194:195], v20 offset:18432
v_mfma_f32_16x16x32_bf16 v[108:111], a[228:231], v[168:171], v[108:111]
s_waitcnt lgkmcnt(4)
ds_read_b64_tr_b16 a[196:197], v21 offset:16384
v_mul_f32 v158, v158, v57
v_mfma_f32_16x16x32_bf16 v[96:99], a[232:235], v[176:179], v[96:99]
ds_read_b64_tr_b16 a[198:199], v21 offset:18432
v_mul_f32 v159, v159, v57
v_mfma_f32_16x16x32_bf16 v[100:103], a[232:235], v[184:187], v[100:103]
s_waitcnt lgkmcnt(4)
ds_read_b64_tr_b16 a[200:201], v20 offset:20480
v_cvt_pk_bf16_f32 v84, v140, v141
v_mfma_f32_16x16x32_bf16 v[104:107], a[236:239], v[176:179], v[104:107]
ds_read_b64_tr_b16 a[202:203], v20 offset:22528
v_cvt_pk_bf16_f32 v85, v142, v143
v_mfma_f32_16x16x32_bf16 v[108:111], a[236:239], v[184:187], v[108:111]
s_waitcnt lgkmcnt(4)
ds_read_b64_tr_b16 a[204:205], v21 offset:20480
v_cvt_pk_bf16_f32 v86, v156, v157
v_mfma_f32_16x16x32_bf16 v[96:99], a[192:195], v[192:195], v[96:99]
ds_read_b64_tr_b16 a[206:207], v21 offset:22528
v_cvt_pk_bf16_f32 v87, v158, v159
v_mfma_f32_16x16x32_bf16 v[100:103], a[192:195], v[200:203], v[100:103]
s_waitcnt lgkmcnt(4)
ds_read_b64_tr_b16 a[208:209], v20 offset:24576
ds_read_b64_tr_b16 a[210:211], v20 offset:26624
v_mfma_f32_16x16x32_bf16 v[104:107], a[196:199], v[192:195], v[104:107]
s_mov_b32 s34, 96256
buffer_store_dwordx4 v[84:87], v4, s[28:31], s34 offen sc1
v_mfma_f32_16x16x32_bf16 v[108:111], a[196:199], v[200:203], v[108:111]
s_waitcnt lgkmcnt(4)
ds_read_b64_tr_b16 a[212:213], v21 offset:24576
v_mul_f32 v164, v164, v56
v_mfma_f32_16x16x32_bf16 v[96:99], a[200:203], v[208:211], v[96:99]
ds_read_b64_tr_b16 a[214:215], v21 offset:26624
v_mul_f32 v165, v165, v56
v_mfma_f32_16x16x32_bf16 v[100:103], a[200:203], v[216:219], v[100:103]
s_waitcnt lgkmcnt(4)
ds_read_b64_tr_b16 a[216:217], v20 offset:28672
v_mul_f32 v166, v166, v56
v_mfma_f32_16x16x32_bf16 v[104:107], a[204:207], v[208:211], v[104:107]
ds_read_b64_tr_b16 a[218:219], v20 offset:30720
v_mul_f32 v167, v167, v56
v_mfma_f32_16x16x32_bf16 v[108:111], a[204:207], v[216:219], v[108:111]
s_waitcnt lgkmcnt(4)
ds_read_b64_tr_b16 a[220:221], v21 offset:28672
v_mul_f32 v180, v180, v56
v_mfma_f32_16x16x32_bf16 v[96:99], a[208:211], v[224:227], v[96:99]
ds_read_b64_tr_b16 a[222:223], v21 offset:30720
v_mul_f32 v181, v181, v56
v_mfma_f32_16x16x32_bf16 v[100:103], a[208:211], v[232:235], v[100:103]
s_waitcnt lgkmcnt(4)
ds_read_b64_tr_b16 a[224:225], v22 offset:32768
v_mul_f32 v182, v182, v56
v_mfma_f32_16x16x32_bf16 v[104:107], a[212:215], v[224:227], v[104:107]
ds_read_b64_tr_b16 a[226:227], v22 offset:34816
v_mul_f32 v183, v183, v56
v_mfma_f32_16x16x32_bf16 v[108:111], a[212:215], v[232:235], v[108:111]
s_waitcnt lgkmcnt(4)
ds_read_b64_tr_b16 a[228:229], v23 offset:32768
v_cvt_pk_bf16_f32 v88, v164, v165
v_mfma_f32_16x16x32_bf16 v[96:99], a[216:219], v[240:243], v[96:99]
ds_read_b64_tr_b16 a[230:231], v23 offset:34816
v_cvt_pk_bf16_f32 v89, v166, v167
v_mfma_f32_16x16x32_bf16 v[100:103], a[216:219], v[248:251], v[100:103]
s_waitcnt lgkmcnt(4)
ds_read_b64_tr_b16 a[232:233], v22 offset:36864
v_cvt_pk_bf16_f32 v90, v180, v181
v_mfma_f32_16x16x32_bf16 v[104:107], a[220:223], v[240:243], v[104:107]
ds_read_b64_tr_b16 a[234:235], v22 offset:38912
v_cvt_pk_bf16_f32 v91, v182, v183
v_mfma_f32_16x16x32_bf16 v[108:111], a[220:223], v[248:251], v[108:111]
s_waitcnt lgkmcnt(4)
ds_read_b64_tr_b16 a[236:237], v23 offset:36864
ds_read_b64_tr_b16 a[238:239], v23 offset:38912
v_mfma_f32_16x16x32_bf16 v[112:115], a[224:227], v[128:131], 0
s_mov_b32 s34, 95232
buffer_store_dwordx4 v[88:91], v4, s[28:31], s34 offen sc1
v_mfma_f32_16x16x32_bf16 v[116:119], a[224:227], v[136:139], 0
s_waitcnt lgkmcnt(4)
ds_read_b64_tr_b16 a[192:193], v22 offset:40960
v_mul_f32 v172, v172, v57
v_mfma_f32_16x16x32_bf16 v[120:123], a[228:231], v[128:131], 0
ds_read_b64_tr_b16 a[194:195], v22 offset:43008
v_mul_f32 v173, v173, v57
v_mfma_f32_16x16x32_bf16 v[124:127], a[228:231], v[136:139], 0
s_waitcnt lgkmcnt(4)
ds_read_b64_tr_b16 a[196:197], v23 offset:40960
v_mul_f32 v174, v174, v57
v_mfma_f32_16x16x32_bf16 v[112:115], a[232:235], v[144:147], v[112:115]
ds_read_b64_tr_b16 a[198:199], v23 offset:43008
v_mul_f32 v175, v175, v57
v_mfma_f32_16x16x32_bf16 v[116:119], a[232:235], v[152:155], v[116:119]
s_waitcnt lgkmcnt(4)
ds_read_b64_tr_b16 a[200:201], v22 offset:45056
v_mul_f32 v188, v188, v57
v_mfma_f32_16x16x32_bf16 v[120:123], a[236:239], v[144:147], v[120:123]
ds_read_b64_tr_b16 a[202:203], v22 offset:47104
v_mul_f32 v189, v189, v57
v_mfma_f32_16x16x32_bf16 v[124:127], a[236:239], v[152:155], v[124:127]
s_waitcnt lgkmcnt(4)
ds_read_b64_tr_b16 a[204:205], v23 offset:45056
v_mul_f32 v190, v190, v57
v_mfma_f32_16x16x32_bf16 v[112:115], a[192:195], v[160:163], v[112:115]
ds_read_b64_tr_b16 a[206:207], v23 offset:47104
v_mul_f32 v191, v191, v57
v_mfma_f32_16x16x32_bf16 v[116:119], a[192:195], v[168:171], v[116:119]
s_waitcnt lgkmcnt(4)
ds_read_b64_tr_b16 a[208:209], v22 offset:16384
v_cvt_pk_bf16_f32 v92, v172, v173
v_mfma_f32_16x16x32_bf16 v[120:123], a[196:199], v[160:163], v[120:123]
ds_read_b64_tr_b16 a[210:211], v22 offset:18432
v_cvt_pk_bf16_f32 v93, v174, v175
v_mfma_f32_16x16x32_bf16 v[124:127], a[196:199], v[168:171], v[124:127]
s_waitcnt lgkmcnt(4)
ds_read_b64_tr_b16 a[212:213], v23 offset:16384
v_cvt_pk_bf16_f32 v94, v188, v189
v_mfma_f32_16x16x32_bf16 v[112:115], a[200:203], v[176:179], v[112:115]
ds_read_b64_tr_b16 a[214:215], v23 offset:18432
v_cvt_pk_bf16_f32 v95, v190, v191
v_mfma_f32_16x16x32_bf16 v[116:119], a[200:203], v[184:187], v[116:119]
s_waitcnt lgkmcnt(4)
ds_read_b64_tr_b16 a[216:217], v22 offset:20480
ds_read_b64_tr_b16 a[218:219], v22 offset:22528
v_mfma_f32_16x16x32_bf16 v[120:123], a[204:207], v[176:179], v[120:123]
s_mov_b32 s34, 97280
buffer_store_dwordx4 v[92:95], v4, s[28:31], s34 offen sc1
v_mfma_f32_16x16x32_bf16 v[124:127], a[204:207], v[184:187], v[124:127]
s_waitcnt lgkmcnt(4)
ds_read_b64_tr_b16 a[220:221], v23 offset:20480
v_mul_f32 v96, v96, v56
v_mfma_f32_16x16x32_bf16 v[112:115], a[208:211], v[192:195], v[112:115]
ds_read_b64_tr_b16 a[222:223], v23 offset:22528
v_mul_f32 v97, v97, v56
v_mfma_f32_16x16x32_bf16 v[116:119], a[208:211], v[200:203], v[116:119]
s_waitcnt lgkmcnt(4)
ds_read_b64_tr_b16 a[224:225], v22 offset:24576
v_mul_f32 v98, v98, v56
v_mfma_f32_16x16x32_bf16 v[120:123], a[212:215], v[192:195], v[120:123]
ds_read_b64_tr_b16 a[226:227], v22 offset:26624
v_mul_f32 v99, v99, v56
v_mfma_f32_16x16x32_bf16 v[124:127], a[212:215], v[200:203], v[124:127]
s_waitcnt lgkmcnt(4)
ds_read_b64_tr_b16 a[228:229], v23 offset:24576
v_mul_f32 v104, v104, v56
v_mfma_f32_16x16x32_bf16 v[112:115], a[216:219], v[208:211], v[112:115]
ds_read_b64_tr_b16 a[230:231], v23 offset:26624
v_mul_f32 v105, v105, v56
v_mfma_f32_16x16x32_bf16 v[116:119], a[216:219], v[216:219], v[116:119]
s_waitcnt lgkmcnt(4)
ds_read_b64_tr_b16 a[232:233], v22 offset:28672
v_mul_f32 v106, v106, v56
v_mfma_f32_16x16x32_bf16 v[120:123], a[220:223], v[208:211], v[120:123]
ds_read_b64_tr_b16 a[234:235], v22 offset:30720
v_mul_f32 v107, v107, v56
v_mfma_f32_16x16x32_bf16 v[124:127], a[220:223], v[216:219], v[124:127]
s_waitcnt lgkmcnt(4)
ds_read_b64_tr_b16 a[236:237], v23 offset:28672
v_cvt_pk_bf16_f32 v72, v96, v97
v_mfma_f32_16x16x32_bf16 v[112:115], a[224:227], v[224:227], v[112:115]
ds_read_b64_tr_b16 a[238:239], v23 offset:30720
v_cvt_pk_bf16_f32 v73, v98, v99
v_mfma_f32_16x16x32_bf16 v[116:119], a[224:227], v[232:235], v[116:119]
s_waitcnt lgkmcnt(4)
v_cvt_pk_bf16_f32 v74, v104, v105
v_cvt_pk_bf16_f32 v75, v106, v107
v_mfma_f32_16x16x32_bf16 v[120:123], a[228:231], v[224:227], v[120:123]
ds_write_b128 v16, v[72:75] offset:6144
v_mfma_f32_16x16x32_bf16 v[124:127], a[228:231], v[232:235], v[124:127]
s_waitcnt lgkmcnt(3)
v_mfma_f32_16x16x32_bf16 v[112:115], a[232:235], v[240:243], v[112:115]
s_add_u32 s34, s77, 110592
buffer_store_dwordx4 v[72:75], v4, s[28:31], s34 offen sc1
v_mfma_f32_16x16x32_bf16 v[116:119], a[232:235], v[248:251], v[116:119]
s_waitcnt lgkmcnt(1)
v_mul_f32 v100, v100, v57
v_mul_f32 v101, v101, v57
v_mfma_f32_16x16x32_bf16 v[120:123], a[236:239], v[240:243], v[120:123]
v_mul_f32 v102, v102, v57
v_mul_f32 v103, v103, v57
v_mfma_f32_16x16x32_bf16 v[124:127], a[236:239], v[248:251], v[124:127]
v_mul_f32 v108, v108, v57
v_mul_f32 v109, v109, v57
v_mul_f32 v110, v110, v57
v_mul_f32 v111, v111, v57
v_cvt_pk_bf16_f32 v76, v100, v101
v_cvt_pk_bf16_f32 v77, v102, v103
v_cvt_pk_bf16_f32 v78, v108, v109
v_cvt_pk_bf16_f32 v79, v110, v111
s_mov_b32 s34, 112640
buffer_store_dwordx4 v[76:79], v4, s[28:31], s34 offen sc1
v_mul_f32 v112, v112, v56
v_mul_f32 v113, v113, v56
v_mul_f32 v114, v114, v56
v_mul_f32 v115, v115, v56
v_mul_f32 v120, v120, v56
v_mul_f32 v121, v121, v56
v_mul_f32 v122, v122, v56
v_mul_f32 v123, v123, v56
v_cvt_pk_bf16_f32 v80, v112, v113
v_cvt_pk_bf16_f32 v81, v114, v115
v_cvt_pk_bf16_f32 v82, v120, v121
v_cvt_pk_bf16_f32 v83, v122, v123
s_mov_b32 s34, 111616
buffer_store_dwordx4 v[80:83], v4, s[28:31], s34 offen sc1
v_mul_f32 v116, v116, v57
v_mul_f32 v117, v117, v57
v_mul_f32 v118, v118, v57
v_mul_f32 v119, v119, v57
v_mul_f32 v124, v124, v57
v_mul_f32 v125, v125, v57
v_mul_f32 v126, v126, v57
v_mul_f32 v127, v127, v57
v_cvt_pk_bf16_f32 v84, v116, v117
v_cvt_pk_bf16_f32 v85, v118, v119
v_cvt_pk_bf16_f32 v86, v124, v125
v_cvt_pk_bf16_f32 v87, v126, v127
s_mov_b32 s34, 113664
buffer_store_dwordx4 v[84:87], v4, s[28:31], s34 offen sc1
buffer_load_dwordx2 v[2:3], v14, s[28:31], 0 offen offset:384 sc1
s_waitcnt vmcnt(1)
buffer_store_dwordx2 v[6:7], v13, s[28:31], 0 offen offset:768 sc1
s_waitcnt lgkmcnt(0)
s_barrier
v_accvgpr_read_b32 v13, a175
s_mov_b32 s55, 384
s_waitcnt vmcnt(1)
v_cmp_ne_u64 vcc, v[2:3], v[6:7]
s_cbranch_vccnz LA_spin0
LA_spun0:
ds_read_b128 a[0:3], v17 offset:0
s_xor_b32 s34, s75, 1
s_mul_i32 s34, s34, 114688
s_add_u32 s34, s34, 13312
buffer_load_dwordx4 a[4:7], v12, s[28:31], s34 offen offset:0 sc1
s_xor_b32 s34, s75, 2
s_mul_i32 s34, s34, 114688
s_add_u32 s34, s34, 14336
buffer_load_dwordx4 a[8:11], v12, s[28:31], s34 offen offset:0 sc1
s_xor_b32 s34, s75, 3
s_mul_i32 s34, s34, 114688
s_add_u32 s34, s34, 15360
buffer_load_dwordx4 a[12:15], v12, s[28:31], s34 offen offset:0 sc1
s_xor_b32 s34, s75, 4
s_mul_i32 s34, s34, 114688
s_add_u32 s34, s34, 16384
buffer_load_dwordx4 a[16:19], v12, s[28:31], s34 offen offset:0 sc1
s_xor_b32 s34, s75, 5
s_mul_i32 s34, s34, 114688
s_add_u32 s34, s34, 17408
buffer_load_dwordx4 a[20:23], v12, s[28:31], s34 offen offset:0 sc1
s_xor_b32 s34, s75, 6
s_mul_i32 s34, s34, 114688
s_add_u32 s34, s34, 18432
buffer_load_dwordx4 a[24:27], v12, s[28:31], s34 offen offset:0 sc1
s_xor_b32 s34, s75, 7
s_mul_i32 s34, s34, 114688
s_add_u32 s34, s34, 19456
buffer_load_dwordx4 a[28:31], v12, s[28:31], s34 offen offset:0 sc1
s_xor_b32 s34, s75, 8
s_mul_i32 s34, s34, 114688
s_add_u32 s34, s34, 20480
buffer_load_dwordx4 a[32:35], v12, s[28:31], s34 offen offset:0 sc1
s_xor_b32 s34, s75, 9
s_mul_i32 s34, s34, 114688
s_add_u32 s34, s34, 21504
buffer_load_dwordx4 a[36:39], v12, s[28:31], s34 offen offset:0 sc1
s_xor_b32 s34, s75, 10
s_mul_i32 s34, s34, 114688
s_add_u32 s34, s34, 22528
buffer_load_dwordx4 a[40:43], v12, s[28:31], s34 offen offset:0 sc1
s_xor_b32 s34, s75, 11
s_mul_i32 s34, s34, 114688
s_add_u32 s34, s34, 23552
buffer_load_dwordx4 a[44:47], v12, s[28:31], s34 offen offset:0 sc1
s_xor_b32 s34, s75, 12
s_mul_i32 s34, s34, 114688
s_add_u32 s34, s34, 24576
buffer_load_dwordx4 a[48:51], v12, s[28:31], s34 offen offset:0 sc1
s_xor_b32 s34, s75, 13
s_mul_i32 s34, s34, 114688
s_add_u32 s34, s34, 25600
buffer_load_dwordx4 a[52:55], v12, s[28:31], s34 offen offset:0 sc1
s_xor_b32 s34, s75, 14
s_mul_i32 s34, s34, 114688
s_add_u32 s34, s34, 26624
buffer_load_dwordx4 a[56:59], v12, s[28:31], s34 offen offset:0 sc1
s_xor_b32 s34, s75, 15
s_mul_i32 s34, s34, 114688
s_add_u32 s34, s34, 27648
buffer_load_dwordx4 a[60:63], v12, s[28:31], s34 offen offset:0 sc1
buffer_load_dwordx2 v[2:3], v14, s[28:31], 0 offen offset:768 sc1
s_waitcnt vmcnt(15)
s_waitcnt lgkmcnt(0)
v_mfma_f32_16x16x32_bf16 v[96:99], a[184:187], a[0:3], 0
v_mfma_f32_16x16x32_bf16 v[100:103], a[188:191], a[0:3], 0
v_mfma_f32_16x16x32_bf16 v[96:99], a[184:187], a[4:7], v[96:99]
v_mfma_f32_16x16x32_bf16 v[100:103], a[188:191], a[4:7], v[100:103]
s_waitcnt vmcnt(13)
v_mfma_f32_16x16x32_bf16 v[96:99], a[184:187], a[8:11], v[96:99]
v_mfma_f32_16x16x32_bf16 v[100:103], a[188:191], a[8:11], v[100:103]
v_mfma_f32_16x16x32_bf16 v[96:99], a[184:187], a[12:15], v[96:99]
v_mfma_f32_16x16x32_bf16 v[100:103], a[188:191], a[12:15], v[100:103]
s_waitcnt vmcnt(11)
v_mfma_f32_16x16x32_bf16 v[96:99], a[184:187], a[16:19], v[96:99]
v_mfma_f32_16x16x32_bf16 v[100:103], a[188:191], a[16:19], v[100:103]
v_mfma_f32_16x16x32_bf16 v[96:99], a[184:187], a[20:23], v[96:99]
v_mfma_f32_16x16x32_bf16 v[100:103], a[188:191], a[20:23], v[100:103]
s_waitcnt vmcnt(9)
v_mfma_f32_16x16x32_bf16 v[96:99], a[184:187], a[24:27], v[96:99]
v_mfma_f32_16x16x32_bf16 v[100:103], a[188:191], a[24:27], v[100:103]
v_mfma_f32_16x16x32_bf16 v[96:99], a[184:187], a[28:31], v[96:99]
v_mfma_f32_16x16x32_bf16 v[100:103], a[188:191], a[28:31], v[100:103]
s_waitcnt vmcnt(7)
v_mfma_f32_16x16x32_bf16 v[96:99], a[184:187], a[32:35], v[96:99]
v_mfma_f32_16x16x32_bf16 v[100:103], a[188:191], a[32:35], v[100:103]
v_mfma_f32_16x16x32_bf16 v[96:99], a[184:187], a[36:39], v[96:99]
v_mfma_f32_16x16x32_bf16 v[100:103], a[188:191], a[36:39], v[100:103]
s_waitcnt vmcnt(5)
v_mfma_f32_16x16x32_bf16 v[96:99], a[184:187], a[40:43], v[96:99]
v_mfma_f32_16x16x32_bf16 v[100:103], a[188:191], a[40:43], v[100:103]
v_mfma_f32_16x16x32_bf16 v[96:99], a[184:187], a[44:47], v[96:99]
v_mfma_f32_16x16x32_bf16 v[100:103], a[188:191], a[44:47], v[100:103]
s_waitcnt vmcnt(3)
v_mfma_f32_16x16x32_bf16 v[96:99], a[184:187], a[48:51], v[96:99]
v_mfma_f32_16x16x32_bf16 v[100:103], a[188:191], a[48:51], v[100:103]
v_mfma_f32_16x16x32_bf16 v[96:99], a[184:187], a[52:55], v[96:99]
v_mfma_f32_16x16x32_bf16 v[100:103], a[188:191], a[52:55], v[100:103]
s_waitcnt vmcnt(1)
v_mfma_f32_16x16x32_bf16 v[96:99], a[184:187], a[56:59], v[96:99]
v_mfma_f32_16x16x32_bf16 v[100:103], a[188:191], a[56:59], v[100:103]
v_mfma_f32_16x16x32_bf16 v[96:99], a[184:187], a[60:63], v[96:99]
v_mfma_f32_16x16x32_bf16 v[100:103], a[188:191], a[60:63], v[100:103]
s_nop 6
v_cvt_pk_bf16_f32 v96, v96, v97
v_cvt_pk_bf16_f32 v97, v98, v99
v_cvt_pk_bf16_f32 v98, v100, v101
v_cvt_pk_bf16_f32 v99, v102, v103
buffer_store_dwordx4 v[96:99], v15, s[68:71], s72 offen
s_mov_b32 s55, 768
s_waitcnt vmcnt(1)
v_cmp_ne_u64 vcc, v[2:3], v[6:7]
s_cbranch_vccnz LA_spin1
LA_spun1:
ds_read_b128 a[64:67], v17 offset:4096
s_xor_b32 s34, s75, 1
s_mul_i32 s34, s34, 114688
s_add_u32 s34, s34, 78848
buffer_load_dwordx4 a[68:71], v13, s[28:31], s34 offen offset:0 sc1
s_xor_b32 s34, s75, 2
s_mul_i32 s34, s34, 114688
s_add_u32 s34, s34, 79872
buffer_load_dwordx4 a[72:75], v13, s[28:31], s34 offen offset:0 sc1
s_xor_b32 s34, s75, 3
s_mul_i32 s34, s34, 114688
s_add_u32 s34, s34, 80896
buffer_load_dwordx4 a[76:79], v13, s[28:31], s34 offen offset:0 sc1
s_xor_b32 s34, s75, 4
s_mul_i32 s34, s34, 114688
s_add_u32 s34, s34, 81920
buffer_load_dwordx4 a[80:83], v13, s[28:31], s34 offen offset:0 sc1
s_xor_b32 s34, s75, 5
s_mul_i32 s34, s34, 114688
s_add_u32 s34, s34, 82944
buffer_load_dwordx4 a[84:87], v13, s[28:31], s34 offen offset:0 sc1
s_xor_b32 s34, s75, 6
s_mul_i32 s34, s34, 114688
s_add_u32 s34, s34, 83968
buffer_load_dwordx4 a[88:91], v13, s[28:31], s34 offen offset:0 sc1
s_xor_b32 s34, s75, 7
s_mul_i32 s34, s34, 114688
s_add_u32 s34, s34, 84992
buffer_load_dwordx4 a[92:95], v13, s[28:31], s34 offen offset:0 sc1
s_xor_b32 s34, s75, 8
s_mul_i32 s34, s34, 114688
s_add_u32 s34, s34, 86016
buffer_load_dwordx4 a[96:99], v13, s[28:31], s34 offen offset:0 sc1
s_xor_b32 s34, s75, 9
s_mul_i32 s34, s34, 114688
s_add_u32 s34, s34, 87040
buffer_load_dwordx4 a[100:103], v13, s[28:31], s34 offen offset:0 sc1
s_xor_b32 s34, s75, 10
s_mul_i32 s34, s34, 114688
s_add_u32 s34, s34, 88064
buffer_load_dwordx4 a[104:107], v13, s[28:31], s34 offen offset:0 sc1
s_xor_b32 s34, s75, 11
s_mul_i32 s34, s34, 114688
s_add_u32 s34, s34, 89088
buffer_load_dwordx4 a[108:111], v13, s[28:31], s34 offen offset:0 sc1
s_xor_b32 s34, s75, 12
s_mul_i32 s34, s34, 114688
s_add_u32 s34, s34, 90112
buffer_load_dwordx4 a[112:115], v13, s[28:31], s34 offen offset:0 sc1
s_xor_b32 s34, s75, 13
s_mul_i32 s34, s34, 114688
s_add_u32 s34, s34, 91136
buffer_load_dwordx4 a[116:119], v13, s[28:31], s34 offen offset:0 sc1
s_xor_b32 s34, s75, 14
s_mul_i32 s34, s34, 114688
s_add_u32 s34, s34, 92160
buffer_load_dwordx4 a[120:123], v13, s[28:31], s34 offen offset:0 sc1
s_xor_b32 s34, s75, 15
s_mul_i32 s34, s34, 114688
s_add_u32 s34, s34, 93184
buffer_load_dwordx4 a[124:127], v13, s[28:31], s34 offen offset:0 sc1
s_waitcnt vmcnt(14)
s_waitcnt lgkmcnt(0)
v_mfma_f32_16x16x32_bf16 v[104:107], a[184:187], a[64:67], 0
v_mfma_f32_16x16x32_bf16 v[108:111], a[188:191], a[64:67], 0
v_mfma_f32_16x16x32_bf16 v[104:107], a[184:187], a[68:71], v[104:107]
v_mfma_f32_16x16x32_bf16 v[108:111], a[188:191], a[68:71], v[108:111]
s_waitcnt vmcnt(12)
v_mfma_f32_16x16x32_bf16 v[104:107], a[184:187], a[72:75], v[104:107]
v_mfma_f32_16x16x32_bf16 v[108:111], a[188:191], a[72:75], v[108:111]
v_mfma_f32_16x16x32_bf16 v[104:107], a[184:187], a[76:79], v[104:107]
v_mfma_f32_16x16x32_bf16 v[108:111], a[188:191], a[76:79], v[108:111]
s_waitcnt vmcnt(10)
v_mfma_f32_16x16x32_bf16 v[104:107], a[184:187], a[80:83], v[104:107]
v_mfma_f32_16x16x32_bf16 v[108:111], a[188:191], a[80:83], v[108:111]
v_mfma_f32_16x16x32_bf16 v[104:107], a[184:187], a[84:87], v[104:107]
v_mfma_f32_16x16x32_bf16 v[108:111], a[188:191], a[84:87], v[108:111]
s_waitcnt vmcnt(8)
v_mfma_f32_16x16x32_bf16 v[104:107], a[184:187], a[88:91], v[104:107]
v_mfma_f32_16x16x32_bf16 v[108:111], a[188:191], a[88:91], v[108:111]
v_mfma_f32_16x16x32_bf16 v[104:107], a[184:187], a[92:95], v[104:107]
v_mfma_f32_16x16x32_bf16 v[108:111], a[188:191], a[92:95], v[108:111]
s_waitcnt vmcnt(6)
v_mfma_f32_16x16x32_bf16 v[104:107], a[184:187], a[96:99], v[104:107]
v_mfma_f32_16x16x32_bf16 v[108:111], a[188:191], a[96:99], v[108:111]
v_mfma_f32_16x16x32_bf16 v[104:107], a[184:187], a[100:103], v[104:107]
v_mfma_f32_16x16x32_bf16 v[108:111], a[188:191], a[100:103], v[108:111]
s_waitcnt vmcnt(4)
v_mfma_f32_16x16x32_bf16 v[104:107], a[184:187], a[104:107], v[104:107]
v_mfma_f32_16x16x32_bf16 v[108:111], a[188:191], a[104:107], v[108:111]
v_mfma_f32_16x16x32_bf16 v[104:107], a[184:187], a[108:111], v[104:107]
v_mfma_f32_16x16x32_bf16 v[108:111], a[188:191], a[108:111], v[108:111]
s_waitcnt vmcnt(2)
v_mfma_f32_16x16x32_bf16 v[104:107], a[184:187], a[112:115], v[104:107]
v_mfma_f32_16x16x32_bf16 v[108:111], a[188:191], a[112:115], v[108:111]
v_mfma_f32_16x16x32_bf16 v[104:107], a[184:187], a[116:119], v[104:107]
v_mfma_f32_16x16x32_bf16 v[108:111], a[188:191], a[116:119], v[108:111]
s_waitcnt vmcnt(0)
v_mfma_f32_16x16x32_bf16 v[104:107], a[184:187], a[120:123], v[104:107]
v_mfma_f32_16x16x32_bf16 v[108:111], a[188:191], a[120:123], v[108:111]
v_mfma_f32_16x16x32_bf16 v[104:107], a[184:187], a[124:127], v[104:107]
v_mfma_f32_16x16x32_bf16 v[108:111], a[188:191], a[124:127], v[108:111]
s_nop 6
v_cvt_pk_bf16_f32 v104, v104, v105
v_cvt_pk_bf16_f32 v105, v106, v107
v_cvt_pk_bf16_f32 v106, v108, v109
v_cvt_pk_bf16_f32 v107, v110, v111
buffer_store_dwordx4 v[104:107], v15, s[68:71], s73 offen
LA_end:
s_endpgm
LA_stub1:
s_call_b64 s[38:39], LA_rescale1
s_branch LA_back1
LA_stub2:
s_call_b64 s[38:39], LA_rescale0
s_branch LA_back2
LA_stub3:
s_call_b64 s[38:39], LA_rescale1
s_branch LA_back3
LA_stub4:
s_call_b64 s[38:39], LA_rescale0
s_branch LA_back4
LA_stub5:
s_call_b64 s[38:39], LA_rescale1
s_branch LA_back5
LA_stub6:
s_call_b64 s[38:39], LA_rescale0
s_branch LA_back6
LA_stub7:
s_call_b64 s[38:39], LA_rescale1
s_branch LA_back7
LA_stub8:
s_call_b64 s[38:39], LA_rescale0
s_branch LA_back8
LA_stub9:
s_call_b64 s[38:39], LA_rescale1
s_branch LA_back9
LA_stub10:
s_call_b64 s[38:39], LA_rescale0
s_branch LA_back10
LA_stub11:
s_call_b64 s[38:39], LA_rescale1
s_branch LA_back11
LA_stub12:
s_call_b64 s[38:39], LA_rescale0
s_branch LA_back12
LA_stub13:
s_call_b64 s[38:39], LA_rescale1
s_branch LA_back13
LA_stub14:
s_call_b64 s[38:39], LA_rescale0
s_branch LA_back14
LA_stub15:
s_call_b64 s[38:39], LA_rescale1
s_branch LA_back15
LA_spin0:
s_call_b64 s[38:39], LA_wait
s_branch LA_spun0
LA_spin1:
s_call_b64 s[38:39], LA_wait
s_branch LA_spun1
LA_renonce:
s_mov_b32 s47, 0
LA_renonce1:
buffer_load_dwordx2 v[6:7], off, s[64:67], 0 sc1
s_add_u32 s47, s47, 1
s_cmp_gt_u32 s47, 0x40000
s_cbranch_scc1 LA_end
s_waitcnt vmcnt(0)
v_cmp_eq_u64 vcc, 0, v[6:7]
s_cbranch_vccnz LA_renonce1
s_branch LA_nonced
LA_wait:
s_mov_b32 s47, 0
buffer_load_dwordx2 v[62:63], v14, s[28:31], s55 offen sc1
LA_wait1:
s_waitcnt vmcnt(0)
v_cmp_ne_u64 vcc, v[62:63], v[6:7]
s_cbranch_vccz LA_wait2
s_sleep 4
buffer_load_dwordx2 v[62:63], v14, s[28:31], s55 offen sc1
s_add_u32 s47, s47, 1
s_cmp_gt_u32 s47, 0x40000
s_cbranch_scc0 LA_wait1
s_branch LA_end
LA_wait2:
s_setpc_b64 s[38:39]
LA_rescale0:
s_nop 15
v_max3_f32 v56, v96, v97, v98
v_max3_f32 v57, v104, v105, v106
v_max3_f32 v56, v56, v99, v100
v_max3_f32 v57, v57, v107, v108
v_max3_f32 v56, v56, v101, v102
v_max3_f32 v57, v57, v109, v110
v_max_f32 v56, v56, v103
v_max_f32 v57, v57, v111
v_mov_b32 v58, v56
v_mov_b32 v59, v57
s_nop 0
v_permlane32_swap_b32 v56, v58
v_permlane32_swap_b32 v57, v59
v_max_f32 v56, v56, v58
v_max_f32 v57, v57, v59
v_mov_b32 v58, v56
v_mov_b32 v59, v57
s_nop 0
v_permlane16_swap_b32 v56, v58
v_permlane16_swap_b32 v57, v59
v_max_f32 v56, v56, v58
v_max_f32 v57, v57, v59
v_fma_f32 v56, v56, s35, v72
v_fma_f32 v57, v57, s35, v76
v_subrev_f32 v56, s37, v56
v_subrev_f32 v57, s37, v57
v_max_f32 v56, 0, v56
v_max_f32 v57, 0, v57
v_sub_f32 v72, v72, v56
v_sub_f32 v76, v76, v57
v_exp_f32 v56, -v56
v_exp_f32 v57, -v57
v_mul_f32 v64, v64, v56
v_mul_f32 v65, v65, v56
v_mul_f32 v66, v66, v56
v_mul_f32 v67, v67, v56
v_mul_f32 v128, v128, v56
v_mul_f32 v129, v129, v56
v_mul_f32 v130, v130, v56
v_mul_f32 v131, v131, v56
v_mul_f32 v132, v132, v56
v_mul_f32 v133, v133, v56
v_mul_f32 v134, v134, v56
v_mul_f32 v135, v135, v56
v_mul_f32 v144, v144, v56
v_mul_f32 v145, v145, v56
v_mul_f32 v146, v146, v56
v_mul_f32 v147, v147, v56
v_mul_f32 v148, v148, v56
v_mul_f32 v149, v149, v56
v_mul_f32 v150, v150, v56
v_mul_f32 v151, v151, v56
v_mul_f32 v160, v160, v56
v_mul_f32 v161, v161, v56
v_mul_f32 v162, v162, v56
v_mul_f32 v163, v163, v56
v_mul_f32 v164, v164, v56
v_mul_f32 v165, v165, v56
v_mul_f32 v166, v166, v56
v_mul_f32 v167, v167, v56
v_mul_f32 v176, v176, v56
v_mul_f32 v177, v177, v56
v_mul_f32 v178, v178, v56
v_mul_f32 v179, v179, v56
v_mul_f32 v180, v180, v56
v_mul_f32 v181, v181, v56
v_mul_f32 v182, v182, v56
v_mul_f32 v183, v183, v56
v_mul_f32 v192, v192, v56
v_mul_f32 v193, v193, v56
v_mul_f32 v194, v194, v56
v_mul_f32 v195, v195, v56
v_mul_f32 v196, v196, v56
v_mul_f32 v197, v197, v56
v_mul_f32 v198, v198, v56
v_mul_f32 v199, v199, v56
v_mul_f32 v208, v208, v56
v_mul_f32 v209, v209, v56
v_mul_f32 v210, v210, v56
v_mul_f32 v211, v211, v56
v_mul_f32 v212, v212, v56
v_mul_f32 v213, v213, v56
v_mul_f32 v214, v214, v56
v_mul_f32 v215, v215, v56
v_mul_f32 v224, v224, v56
v_mul_f32 v225, v225, v56
v_mul_f32 v226, v226, v56
v_mul_f32 v227, v227, v56
v_mul_f32 v228, v228, v56
v_mul_f32 v229, v229, v56
v_mul_f32 v230, v230, v56
v_mul_f32 v231, v231, v56
v_mul_f32 v240, v240, v56
v_mul_f32 v241, v241, v56
v_mul_f32 v242, v242, v56
v_mul_f32 v243, v243, v56
v_mul_f32 v244, v244, v56
v_mul_f32 v245, v245, v56
v_mul_f32 v246, v246, v56
v_mul_f32 v247, v247, v56
v_mul_f32 v68, v68, v57
v_mul_f32 v69, v69, v57
v_mul_f32 v70, v70, v57
v_mul_f32 v71, v71, v57
v_mul_f32 v136, v136, v57
v_mul_f32 v137, v137, v57
v_mul_f32 v138, v138, v57
v_mul_f32 v139, v139, v57
v_mul_f32 v140, v140, v57
v_mul_f32 v141, v141, v57
v_mul_f32 v142, v142, v57
v_mul_f32 v143, v143, v57
v_mul_f32 v152, v152, v57
v_mul_f32 v153, v153, v57
v_mul_f32 v154, v154, v57
v_mul_f32 v155, v155, v57
v_mul_f32 v156, v156, v57
v_mul_f32 v157, v157, v57
v_mul_f32 v158, v158, v57
v_mul_f32 v159, v159, v57
v_mul_f32 v168, v168, v57
v_mul_f32 v169, v169, v57
v_mul_f32 v170, v170, v57
v_mul_f32 v171, v171, v57
v_mul_f32 v172, v172, v57
v_mul_f32 v173, v173, v57
v_mul_f32 v174, v174, v57
v_mul_f32 v175, v175, v57
v_mul_f32 v184, v184, v57
v_mul_f32 v185, v185, v57
v_mul_f32 v186, v186, v57
v_mul_f32 v187, v187, v57
v_mul_f32 v188, v188, v57
v_mul_f32 v189, v189, v57
v_mul_f32 v190, v190, v57
v_mul_f32 v191, v191, v57
v_mul_f32 v200, v200, v57
v_mul_f32 v201, v201, v57
v_mul_f32 v202, v202, v57
v_mul_f32 v203, v203, v57
v_mul_f32 v204, v204, v57
v_mul_f32 v205, v205, v57
v_mul_f32 v206, v206, v57
v_mul_f32 v207, v207, v57
v_mul_f32 v216, v216, v57
v_mul_f32 v217, v217, v57
v_mul_f32 v218, v218, v57
v_mul_f32 v219, v219, v57
v_mul_f32 v220, v220, v57
v_mul_f32 v221, v221, v57
v_mul_f32 v222, v222, v57
v_mul_f32 v223, v223, v57
v_mul_f32 v232, v232, v57
v_mul_f32 v233, v233, v57
v_mul_f32 v234, v234, v57
v_mul_f32 v235, v235, v57
v_mul_f32 v236, v236, v57
v_mul_f32 v237, v237, v57
v_mul_f32 v238, v238, v57
v_mul_f32 v239, v239, v57
v_mul_f32 v248, v248, v57
v_mul_f32 v249, v249, v57
v_mul_f32 v250, v250, v57
v_mul_f32 v251, v251, v57
v_mul_f32 v252, v252, v57
v_mul_f32 v253, v253, v57
v_mul_f32 v254, v254, v57
v_mul_f32 v255, v255, v57
v_fma_f32 v56, v96, s35, v72
v_fma_f32 v57, v97, s35, v72
v_exp_f32 v56, v56
v_fma_f32 v58, v98, s35, v72
v_exp_f32 v57, v57
v_fma_f32 v59, v99, s35, v72
v_exp_f32 v58, v58
v_fma_f32 v60, v100, s35, v72
v_exp_f32 v59, v59
v_fma_f32 v61, v101, s35, v72
v_cvt_pk_bf16_f32 v80, v56, v57
v_exp_f32 v60, v60
v_fma_f32 v62, v102, s35, v72
v_exp_f32 v61, v61
v_fma_f32 v63, v103, s35, v72
v_cvt_pk_bf16_f32 v81, v58, v59
v_exp_f32 v62, v62
v_fma_f32 v56, v104, s35, v76
v_exp_f32 v63, v63
v_fma_f32 v57, v105, s35, v76
v_cvt_pk_bf16_f32 v82, v60, v61
v_exp_f32 v56, v56
v_fma_f32 v58, v106, s35, v76
v_exp_f32 v57, v57
v_fma_f32 v59, v107, s35, v76
v_cvt_pk_bf16_f32 v83, v62, v63
v_exp_f32 v58, v58
v_fma_f32 v60, v108, s35, v76
v_exp_f32 v59, v59
v_fma_f32 v61, v109, s35, v76
v_cvt_pk_bf16_f32 v84, v56, v57
v_exp_f32 v60, v60
v_fma_f32 v62, v110, s35, v76
v_exp_f32 v61, v61
v_fma_f32 v63, v111, s35, v76
v_cvt_pk_bf16_f32 v85, v58, v59
v_exp_f32 v62, v62
v_exp_f32 v63, v63
v_cvt_pk_bf16_f32 v86, v60, v61
v_cvt_pk_bf16_f32 v87, v62, v63
s_nop 3
s_setpc_b64 s[38:39]
LA_rescale1:
s_nop 15
v_max3_f32 v56, v112, v113, v114
v_max3_f32 v57, v120, v121, v122
v_max3_f32 v56, v56, v115, v116
v_max3_f32 v57, v57, v123, v124
v_max3_f32 v56, v56, v117, v118
v_max3_f32 v57, v57, v125, v126
v_max_f32 v56, v56, v119
v_max_f32 v57, v57, v127
v_mov_b32 v58, v56
v_mov_b32 v59, v57
s_nop 0
v_permlane32_swap_b32 v56, v58
v_permlane32_swap_b32 v57, v59
v_max_f32 v56, v56, v58
v_max_f32 v57, v57, v59
v_mov_b32 v58, v56
v_mov_b32 v59, v57
s_nop 0
v_permlane16_swap_b32 v56, v58
v_permlane16_swap_b32 v57, v59
v_max_f32 v56, v56, v58
v_max_f32 v57, v57, v59
v_fma_f32 v56, v56, s35, v72
v_fma_f32 v57, v57, s35, v76
v_subrev_f32 v56, s37, v56
v_subrev_f32 v57, s37, v57
v_max_f32 v56, 0, v56
v_max_f32 v57, 0, v57
v_sub_f32 v72, v72, v56
v_sub_f32 v76, v76, v57
v_exp_f32 v56, -v56
v_exp_f32 v57, -v57
v_mul_f32 v64, v64, v56
v_mul_f32 v65, v65, v56
v_mul_f32 v66, v66, v56
v_mul_f32 v67, v67, v56
v_mul_f32 v128, v128, v56
v_mul_f32 v129, v129, v56
v_mul_f32 v130, v130, v56
v_mul_f32 v131, v131, v56
v_mul_f32 v132, v132, v56
v_mul_f32 v133, v133, v56
v_mul_f32 v134, v134, v56
v_mul_f32 v135, v135, v56
v_mul_f32 v144, v144, v56
v_mul_f32 v145, v145, v56
v_mul_f32 v146, v146, v56
v_mul_f32 v147, v147, v56
v_mul_f32 v148, v148, v56
v_mul_f32 v149, v149, v56
v_mul_f32 v150, v150, v56
v_mul_f32 v151, v151, v56
v_mul_f32 v160, v160, v56
v_mul_f32 v161, v161, v56
v_mul_f32 v162, v162, v56
v_mul_f32 v163, v163, v56
v_mul_f32 v164, v164, v56
v_mul_f32 v165, v165, v56
v_mul_f32 v166, v166, v56
v_mul_f32 v167, v167, v56
v_mul_f32 v176, v176, v56
v_mul_f32 v177, v177, v56
v_mul_f32 v178, v178, v56
v_mul_f32 v179, v179, v56
v_mul_f32 v180, v180, v56
v_mul_f32 v181, v181, v56
v_mul_f32 v182, v182, v56
v_mul_f32 v183, v183, v56
v_mul_f32 v192, v192, v56
v_mul_f32 v193, v193, v56
v_mul_f32 v194, v194, v56
v_mul_f32 v195, v195, v56
v_mul_f32 v196, v196, v56
v_mul_f32 v197, v197, v56
v_mul_f32 v198, v198, v56
v_mul_f32 v199, v199, v56
v_mul_f32 v208, v208, v56
v_mul_f32 v209, v209, v56
v_mul_f32 v210, v210, v56
v_mul_f32 v211, v211, v56
v_mul_f32 v212, v212, v56
v_mul_f32 v213, v213, v56
v_mul_f32 v214, v214, v56
v_mul_f32 v215, v215, v56
v_mul_f32 v224, v224, v56
v_mul_f32 v225, v225, v56
v_mul_f32 v226, v226, v56
v_mul_f32 v227, v227, v56
v_mul_f32 v228, v228, v56
v_mul_f32 v229, v229, v56
v_mul_f32 v230, v230, v56
v_mul_f32 v231, v231, v56
v_mul_f32 v240, v240, v56
v_mul_f32 v241, v241, v56
v_mul_f32 v242, v242, v56
v_mul_f32 v243, v243, v56
v_mul_f32 v244, v244, v56
v_mul_f32 v245, v245, v56
v_mul_f32 v246, v246, v56
v_mul_f32 v247, v247, v56
v_mul_f32 v68, v68, v57
v_mul_f32 v69, v69, v57
v_mul_f32 v70, v70, v57
v_mul_f32 v71, v71, v57
v_mul_f32 v136, v136, v57
v_mul_f32 v137, v137, v57
v_mul_f32 v138, v138, v57
v_mul_f32 v139, v139, v57
v_mul_f32 v140, v140, v57
v_mul_f32 v141, v141, v57
v_mul_f32 v142, v142, v57
v_mul_f32 v143, v143, v57
v_mul_f32 v152, v152, v57
v_mul_f32 v153, v153, v57
v_mul_f32 v154, v154, v57
v_mul_f32 v155, v155, v57
v_mul_f32 v156, v156, v57
v_mul_f32 v157, v157, v57
v_mul_f32 v158, v158, v57
v_mul_f32 v159, v159, v57
v_mul_f32 v168, v168, v57
v_mul_f32 v169, v169, v57
v_mul_f32 v170, v170, v57
v_mul_f32 v171, v171, v57
v_mul_f32 v172, v172, v57
v_mul_f32 v173, v173, v57
v_mul_f32 v174, v174, v57
v_mul_f32 v175, v175, v57
v_mul_f32 v184, v184, v57
v_mul_f32 v185, v185, v57
v_mul_f32 v186, v186, v57
v_mul_f32 v187, v187, v57
v_mul_f32 v188, v188, v57
v_mul_f32 v189, v189, v57
v_mul_f32 v190, v190, v57
v_mul_f32 v191, v191, v57
v_mul_f32 v200, v200, v57
v_mul_f32 v201, v201, v57
v_mul_f32 v202, v202, v57
v_mul_f32 v203, v203, v57
v_mul_f32 v204, v204, v57
v_mul_f32 v205, v205, v57
v_mul_f32 v206, v206, v57
v_mul_f32 v207, v207, v57
v_mul_f32 v216, v216, v57
v_mul_f32 v217, v217, v57
v_mul_f32 v218, v218, v57
v_mul_f32 v219, v219, v57
v_mul_f32 v220, v220, v57
v_mul_f32 v221, v221, v57
v_mul_f32 v222, v222, v57
v_mul_f32 v223, v223, v57
v_mul_f32 v232, v232, v57
v_mul_f32 v233, v233, v57
v_mul_f32 v234, v234, v57
v_mul_f32 v235, v235, v57
v_mul_f32 v236, v236, v57
v_mul_f32 v237, v237, v57
v_mul_f32 v238, v238, v57
v_mul_f32 v239, v239, v57
v_mul_f32 v248, v248, v57
v_mul_f32 v249, v249, v57
v_mul_f32 v250, v250, v57
v_mul_f32 v251, v251, v57
v_mul_f32 v252, v252, v57
v_mul_f32 v253, v253, v57
v_mul_f32 v254, v254, v57
v_mul_f32 v255, v255, v57
v_fma_f32 v56, v112, s35, v72
v_fma_f32 v57, v113, s35, v72
v_exp_f32 v56, v56
v_fma_f32 v58, v114, s35, v72
v_exp_f32 v57, v57
v_fma_f32 v59, v115, s35, v72
v_exp_f32 v58, v58
v_fma_f32 v60, v116, s35, v72
v_exp_f32 v59, v59
v_fma_f32 v61, v117, s35, v72
v_cvt_pk_bf16_f32 v88, v56, v57
v_exp_f32 v60, v60
v_fma_f32 v62, v118, s35, v72
v_exp_f32 v61, v61
v_fma_f32 v63, v119, s35, v72
v_cvt_pk_bf16_f32 v89, v58, v59
v_exp_f32 v62, v62
v_fma_f32 v56, v120, s35, v76
v_exp_f32 v63, v63
v_fma_f32 v57, v121, s35, v76
v_cvt_pk_bf16_f32 v90, v60, v61
v_exp_f32 v56, v56
v_fma_f32 v58, v122, s35, v76
v_exp_f32 v57, v57
v_fma_f32 v59, v123, s35, v76
v_cvt_pk_bf16_f32 v91, v62, v63
v_exp_f32 v58, v58
v_fma_f32 v60, v124, s35, v76
v_exp_f32 v59, v59
v_fma_f32 v61, v125, s35, v76
v_cvt_pk_bf16_f32 v92, v56, v57
v_exp_f32 v60, v60
v_fma_f32 v62, v126, s35, v76
v_exp_f32 v61, v61
v_fma_f32 v63, v127, s35, v76
v_cvt_pk_bf16_f32 v93, v58, v59
v_exp_f32 v62, v62
v_exp_f32 v63, v63
v_cvt_pk_bf16_f32 v94, v60, v61
v_cvt_pk_bf16_f32 v95, v62, v63
s_nop 3
s_setpc_b64 s[38:39]
LA_text_end:
.section .rodata,"a"
.p2align 6
.amdhsa_kernel concat_heads__gqa_block_cached__mha_block_cached__near_ridge_kernel
  .amdhsa_next_free_vgpr 512
  .amdhsa_next_free_sgpr 102
  .amdhsa_accum_offset 256
  .amdhsa_group_segment_fixed_size 0
  .amdhsa_kernarg_size 104
  .amdhsa_user_sgpr_count 2
  .amdhsa_user_sgpr_kernarg_segment_ptr 1
  .amdhsa_system_sgpr_workgroup_id_x 1
.end_amdhsa_kernel
```
